```python
import torch

def _softmax(x, axis=-1):
    return torch.softmax(x, dim=axis)
def _gelu(x):
    return torch.nn.functional.gelu(x, approximate="tanh")
def _silu(x):
    return torch.nn.functional.silu(x)
def _sigmoid(x):
    return torch.sigmoid(x)
def _layernorm(x, axis=-1, eps=1e-5):
    m = x.mean(dim=axis, keepdim=True)
    v = x.var(dim=axis, keepdim=True, unbiased=False)
    return (x - m) / torch.sqrt(v + eps)
def _scatter_add(tgt, idx, src, axis=0):
    return tgt.clone().index_add_(axis, idx, src)
def _segment_sum(src, seg, n):
    out = torch.zeros((n,) + src.shape[1:], dtype=src.dtype)
    return out.index_add_(0, seg, src)
def _pad(x, pw):
    flat = tuple(v for pair in reversed(pw) for v in pair)
    return torch.nn.functional.pad(x, flat)

kernel_name = 'interleave_layers__gqa_block_cached__glu_gated_swiglu__decode'

def setup_inputs():

    _w = (lambda a: (lambda t: t.to(torch.bfloat16) if t.is_floating_point() else t)(torch.as_tensor(a)))
    def _A_setup():
        B, Sq, D = 1, 1, 512
        Hq, Hkv, Sk, Dh = 32, 8, 65536, 128
        assert Hq % Hkv == 0, (Hq, Hkv)
        return {
            "x": _w((lambda *s: torch.randn(*s, dtype=torch.bfloat16) * 0.05)(B, Sq, D)),
            "k_cache": _w((lambda *s: torch.randn(*s, dtype=torch.bfloat16) * 0.8)(B, Hkv, Sk, Dh)),
            "v_cache": _w((lambda *s: torch.randn(*s, dtype=torch.bfloat16) * 1.6)(B, Hkv, Sk, Dh)),
            "wq": _w((lambda *s: torch.randn(*s, dtype=torch.bfloat16) * 0.8)(D, Hq * Dh) * (D ** -0.5)),
            "wo": _w((lambda *s: torch.randn(*s, dtype=torch.bfloat16) * 1.6)(Hq * Dh, D) * ((Hq * Dh) ** -0.5)),
        }
    _A_in = _A_setup()

    def _B_setup():
        B, S, D, F = 1, 1, 512, 1792
        return {
            "x": _w((lambda *s: torch.randn(*s, dtype=torch.bfloat16) * 0.05)(B, S, D)),
            "w1": _w((lambda *s: torch.randn(*s, dtype=torch.bfloat16) * 0.4)(D, F) * (2.0 / D) ** 0.5),
            "w3": _w((lambda *s: torch.randn(*s, dtype=torch.bfloat16) * 0.4)(D, F) * (2.0 / D) ** 0.5),
            "w2": _w((lambda *s: torch.randn(*s, dtype=torch.bfloat16) * 0.4)(F, D) * (2.0 / F) ** 0.5),
        }
    _B_in = _B_setup()

    return {
        "A_x": _A_in["x"],
        "A_k_cache": _A_in["k_cache"],
        "A_v_cache": _A_in["v_cache"],
        "A_wq": _A_in["wq"],
        "A_wo": _A_in["wo"],
        "B_x": _B_in["x"],
        "B_w1": _B_in["w1"],
        "B_w3": _B_in["w3"],
        "B_w2": _B_in["w2"],
    }

def reference(A_x, A_k_cache, A_v_cache, A_wq, A_wo, B_x, B_w1, B_w3, B_w2):
    def _A_ref(x, k_cache, v_cache, wq, wo):
        B, Sq, D = x.shape
        Hq, Dh = 32, 128
        Hkv = k_cache.shape[1]
        rep = Hq // Hkv
        q = (lambda x, *d: x.permute(*d))((x @ wq).reshape(B, Sq, Hq, Dh), 0, 2, 1, 3)
        k = (lambda x, n, axis: torch.repeat_interleave(x, n, dim=axis))(k_cache, rep, axis=1)
        v = (lambda x, n, axis: torch.repeat_interleave(x, n, dim=axis))(v_cache, rep, axis=1)
        scores = torch.einsum("bhqd,bhkd->bhqk", q, k) * (Dh ** -0.5)
        p = _softmax(scores, axis=-1)
        o = torch.einsum("bhqk,bhkd->bhqd", p, v)
        return (lambda x, *d: x.permute(*d))(o, 0, 2, 1, 3).reshape(B, Sq, Hq * Dh) @ wo

    def _B_ref(x, w1, w3, w2):
        gate = torch.einsum("bsd,df->bsf", x, w1)
        up = torch.einsum("bsd,df->bsf", x, w3)
        h = _silu(gate) * up
        out = torch.einsum("bsf,fd->bsd", h, w2)
        return out

    x = A_x
    x = x + _A_ref(_layernorm(x, axis=-1), A_k_cache, A_v_cache, A_wq, A_wo)
    x = x + _B_ref(_layernorm(x, axis=-1), B_w1, B_w3, B_w2)
    x = x + _A_ref(_layernorm(x, axis=-1), A_k_cache, A_v_cache, A_wq, A_wo)
    x = x + _B_ref(_layernorm(x, axis=-1), B_w1, B_w3, B_w2)
    return x
```

```asm
; @launch grid=(256,1,1) block=(256,1,1) lds=163840
.amdgcn_target "amdgcn-amd-amdhsa--gfx950"
.text
.globl interleave_layers__gqa_block_cached__glu_gated_swiglu__decode_kernel
.p2align 8
.type interleave_layers__gqa_block_cached__glu_gated_swiglu__decode_kernel,@function
interleave_layers__gqa_block_cached__glu_gated_swiglu__decode_kernel:
  s_cmp_ge_u32 s2, 256
  s_cbranch_scc1 L_end
  s_load_dwordx16 s[72:87], s[0:1], 0
  s_load_dwordx8 s[88:95], s[0:1], 64
  v_and_b32 v1, 63, v0
  v_lshrrev_b32 v26, 6, v0
  s_nop 0
  v_readfirstlane_b32 s52, v26
  s_and_b32 s53, s2, 7
  s_lshr_b32 s54, s2, 3
  s_mov_b32 s58, 2000000
  s_and_b32 s62, s2, 7
  s_mul_i32 s62, s62, 7
  s_lshr_b32 s55, s54, 2
  s_add_u32 s62, s62, s55
  s_and_b32 s100, s54, 3
  s_and_b32 s63, s2, 7
  s_mov_b32 s64, s54
  s_mov_b32 s96, 0x3e0293ee
  s_mov_b32 s67, 0
  s_getreg_b32 s99, hwreg(HW_REG_XCC_ID)
  s_lshl_b32 s55, s53, 24
  s_lshl_b32 s56, s54, 19
  s_add_u32 s55, s55, s56
  s_lshl_b32 s56, s52, 17
  s_add_u32 s55, s55, s56
  v_lshlrev_b32 v3, 4, v1
  s_mul_i32 s56, s52, 39936
  s_add_u32 s56, s56, 4096
  v_add_u32 v25, s56, v3
  v_add_u32 v3, s55, v3
  v_bfe_u32 v26, v1, 2, 2
  v_lshlrev_b32 v2, 8, v26
  v_lshrrev_b32 v27, 4, v1
  v_lshl_add_u32 v2, v27, 6, v2
  v_and_b32 v28, 3, v1
  v_lshl_add_u32 v2, v28, 4, v2
  v_add_u32 v2, s55, v2
  v_and_b32 v24, 48, v1
  v_lshl_add_u32 v24, v28, 2, v24
  v_add_u32 v24, v24, v26
  v_lshlrev_b32 v24, 2, v24
  v_and_b32 v29, 1, v1
  v_lshlrev_b32 v29, 4, v29
  v_mov_b32 v30, 0xffff
  v_lshlrev_b32 v30, v29, v30
  v_and_b32 v29, 2, v1
  v_cmp_eq_u32 vcc, 0, v29
  v_mov_b32 v31, 0
  s_nop 1
  v_cndmask_b32 v20, v31, v30, vcc
  v_cndmask_b32 v21, v30, v31, vcc
  s_waitcnt lgkmcnt(0)
  s_mov_b32 s8, s74
  s_and_b32 s9, s75, 0xffff
  s_mov_b32 s10, 0x8000000
  s_mov_b32 s11, 0x00020000
  s_load_dword s70, s[72:73], 0
  s_mov_b32 s59, 0x0
  s_bitcmp1_b32 s99, 0
  s_cbranch_scc1 L_th_1
  s_waitcnt vmcnt(5)
L_th_1:
  s_waitcnt vmcnt(5)
  buffer_load_dwordx4 a[0:3], v2, s[8:11], s59 offen offset:0 nt
  s_bitcmp1_b32 s99, 0
  s_cbranch_scc1 L_th_3
  s_waitcnt vmcnt(5)
L_th_3:
  s_waitcnt vmcnt(6)
  buffer_load_dwordx4 a[4:7], v2, s[8:11], s59 offen offset:1024 nt
  s_bitcmp1_b32 s99, 0
  s_cbranch_scc1 L_th_5
  s_waitcnt vmcnt(5)
L_th_5:
  s_waitcnt vmcnt(5)
  buffer_load_dwordx4 a[8:11], v2, s[8:11], s59 offen offset:2048 nt
  s_bitcmp1_b32 s99, 0
  s_cbranch_scc1 L_th_7
  s_waitcnt vmcnt(5)
L_th_7:
  s_waitcnt vmcnt(6)
  buffer_load_dwordx4 a[12:15], v2, s[8:11], s59 offen offset:3072 nt
  s_mov_b32 s59, 0x1000
  s_bitcmp1_b32 s99, 0
  s_cbranch_scc1 L_th_9
  s_waitcnt vmcnt(5)
L_th_9:
  s_waitcnt vmcnt(5)
  buffer_load_dwordx4 a[16:19], v2, s[8:11], s59 offen offset:0 nt
  s_bitcmp1_b32 s99, 0
  s_cbranch_scc1 L_th_11
  s_waitcnt vmcnt(5)
L_th_11:
  s_waitcnt vmcnt(6)
  buffer_load_dwordx4 a[20:23], v2, s[8:11], s59 offen offset:1024 nt
  s_mov_b32 s36, s72
  s_and_b32 s37, s73, 0xffff
  s_mov_b32 s38, 0x400
  s_mov_b32 s39, 0x00020000
  s_mov_b32 s16, s78
  s_and_b32 s17, s79, 0xffff
  s_mov_b32 s18, 0x400000
  s_mov_b32 s19, 0x00020000
  s_mov_b32 s48, s94
  s_and_b32 s49, s95, 0xffff
  s_mov_b32 s50, 0x20000000
  s_mov_b32 s51, 0x00020000
  s_mov_b32 s12, s76
  s_and_b32 s13, s77, 0xffff
  s_mov_b32 s14, 0x8000000
  s_mov_b32 s15, 0x00020000
  s_mov_b32 s20, s80
  s_and_b32 s21, s81, 0xffff
  s_mov_b32 s22, 0x400000
  s_mov_b32 s23, 0x00020000
  s_mov_b32 s24, s84
  s_and_b32 s25, s85, 0xffff
  s_mov_b32 s26, 0x1c0000
  s_mov_b32 s27, 0x00020000
  s_mov_b32 s28, s86
  s_and_b32 s29, s87, 0xffff
  s_mov_b32 s30, 0x1c0000
  s_mov_b32 s31, 0x00020000
  s_mov_b32 s32, s88
  s_and_b32 s33, s89, 0xffff
  s_mov_b32 s34, 0x1c0000
  s_mov_b32 s35, 0x00020000
  s_mov_b32 s40, s90
  s_and_b32 s41, s91, 0xffff
  s_mov_b32 s42, 0x400
  s_mov_b32 s43, 0x00020000
  s_mov_b32 s44, s92
  s_and_b32 s45, s93, 0xffff
  s_mov_b32 s46, 0x100
  s_mov_b32 s47, 0x00020000
  v_lshlrev_b32 v85, 2, v0
  buffer_load_dword v22, v85, s[36:39], 0 offen
  v_mov_b32 v80, -1
  v_mov_b32 v81, -1
  v_mov_b32 v82, -1
  v_mov_b32 v83, -1
  v_lshlrev_b32 v84, 4, v0
  s_mul_i32 s55, s2, 10240
  buffer_store_dwordx4 v[80:83], v84, s[48:51], s55 offen sc1
  s_add_u32 s55, s55, 4096
  buffer_store_dwordx4 v[80:83], v84, s[48:51], s55 offen sc1
  s_add_u32 s55, s55, 4096
  s_cmp_ge_u32 s52, 2
  s_cbranch_scc1 L_clr0
  buffer_store_dwordx4 v[80:83], v84, s[48:51], s55 offen sc1
L_clr0:
  v_lshrrev_b32 v26, 1, v1
  v_lshlrev_b32 v26, 15, v26
  v_and_b32 v27, 1, v1
  v_lshl_add_u32 v26, v27, 4, v26
  s_lshl_b32 s55, s52, 20
  s_lshl_b32 s56, s53, 10
  s_add_u32 s55, s55, s56
  s_lshl_b32 s56, s54, 5
  s_add_u32 s55, s55, s56
  buffer_load_dwordx4 v[88:91], v26, s[16:19], s55 offen
  s_add_u32 s55, s55, 8192
  buffer_load_dwordx4 v[92:95], v26, s[16:19], s55 offen
  s_add_u32 s55, s55, 8192
  buffer_load_dwordx4 v[96:99], v26, s[16:19], s55 offen
  s_add_u32 s55, s55, 8192
  buffer_load_dwordx4 v[100:103], v26, s[16:19], s55 offen
  s_bitcmp1_b32 s99, 0
  s_cbranch_scc1 L_th_13
  s_waitcnt vmcnt(5)
L_th_13:
  s_waitcnt vmcnt(5)
  buffer_load_dwordx4 a[24:27], v2, s[8:11], s59 offen offset:2048 nt
  s_bitcmp1_b32 s99, 0
  s_cbranch_scc1 L_th_15
  s_waitcnt vmcnt(5)
L_th_15:
  s_waitcnt vmcnt(6)
  buffer_load_dwordx4 a[28:31], v2, s[8:11], s59 offen offset:3072 nt
  s_mov_b32 s59, 0x2000
  s_bitcmp1_b32 s99, 0
  s_cbranch_scc1 L_th_17
  s_waitcnt vmcnt(5)
L_th_17:
  s_waitcnt vmcnt(5)
  buffer_load_dwordx4 a[32:35], v2, s[8:11], s59 offen offset:0 nt
  s_bitcmp1_b32 s99, 0
  s_cbranch_scc1 L_th_19
  s_waitcnt vmcnt(5)
L_th_19:
  s_waitcnt vmcnt(6)
  buffer_load_dwordx4 a[36:39], v2, s[8:11], s59 offen offset:1024 nt
  s_bitcmp1_b32 s99, 0
  s_cbranch_scc1 L_th_21
  s_waitcnt vmcnt(5)
L_th_21:
  s_waitcnt vmcnt(5)
  buffer_load_dwordx4 a[40:43], v2, s[8:11], s59 offen offset:2048 nt
  s_bitcmp1_b32 s99, 0
  s_cbranch_scc1 L_th_23
  s_waitcnt vmcnt(5)
L_th_23:
  s_waitcnt vmcnt(6)
  buffer_load_dwordx4 a[44:47], v2, s[8:11], s59 offen offset:3072 nt
  s_mov_b32 s59, 0x3000
  s_bitcmp1_b32 s99, 0
  s_cbranch_scc1 L_th_25
  s_waitcnt vmcnt(5)
L_th_25:
  s_waitcnt vmcnt(5)
  buffer_load_dwordx4 a[48:51], v2, s[8:11], s59 offen offset:0 nt
  s_bitcmp1_b32 s99, 0
  s_cbranch_scc1 L_th_27
  s_waitcnt vmcnt(5)
L_th_27:
  s_waitcnt vmcnt(6)
  buffer_load_dwordx4 a[52:55], v2, s[8:11], s59 offen offset:1024 nt
  s_bitcmp1_b32 s99, 0
  s_cbranch_scc1 L_th_29
  s_waitcnt vmcnt(5)
L_th_29:
  s_waitcnt vmcnt(5)
  buffer_load_dwordx4 a[56:59], v2, s[8:11], s59 offen offset:2048 nt
  s_bitcmp1_b32 s99, 0
  s_cbranch_scc1 L_th_31
  s_waitcnt vmcnt(5)
L_th_31:
  s_waitcnt vmcnt(6)
  buffer_load_dwordx4 a[60:63], v2, s[8:11], s59 offen offset:3072 nt
  s_mov_b32 s59, 0x4000
  s_bitcmp1_b32 s99, 0
  s_cbranch_scc1 L_th_33
  s_waitcnt vmcnt(5)
L_th_33:
  s_waitcnt vmcnt(5)
  buffer_load_dwordx4 a[64:67], v2, s[8:11], s59 offen offset:0 nt
  s_bitcmp1_b32 s99, 0
  s_cbranch_scc1 L_th_35
  s_waitcnt vmcnt(5)
L_th_35:
  s_waitcnt vmcnt(6)
  buffer_load_dwordx4 a[68:71], v2, s[8:11], s59 offen offset:1024 nt
  s_bitcmp1_b32 s99, 0
  s_cbranch_scc1 L_th_37
  s_waitcnt vmcnt(5)
L_th_37:
  s_waitcnt vmcnt(5)
  buffer_load_dwordx4 a[72:75], v2, s[8:11], s59 offen offset:2048 nt
  s_bitcmp1_b32 s99, 0
  s_cbranch_scc1 L_th_39
  s_waitcnt vmcnt(5)
L_th_39:
  s_waitcnt vmcnt(6)
  buffer_load_dwordx4 a[76:79], v2, s[8:11], s59 offen offset:3072 nt
  s_mov_b32 s59, 0x5000
  s_bitcmp1_b32 s99, 0
  s_cbranch_scc1 L_th_41
  s_waitcnt vmcnt(5)
L_th_41:
  s_waitcnt vmcnt(5)
  buffer_load_dwordx4 a[80:83], v2, s[8:11], s59 offen offset:0 nt
  s_bitcmp1_b32 s99, 0
  s_cbranch_scc1 L_th_43
  s_waitcnt vmcnt(5)
L_th_43:
  s_waitcnt vmcnt(6)
  buffer_load_dwordx4 a[84:87], v2, s[8:11], s59 offen offset:1024 nt
  s_bitcmp1_b32 s99, 0
  s_cbranch_scc1 L_th_45
  s_waitcnt vmcnt(5)
L_th_45:
  s_waitcnt vmcnt(5)
  buffer_load_dwordx4 a[88:91], v2, s[8:11], s59 offen offset:2048 nt
  s_bitcmp1_b32 s99, 0
  s_cbranch_scc1 L_th_47
  s_waitcnt vmcnt(5)
L_th_47:
  s_waitcnt vmcnt(6)
  buffer_load_dwordx4 a[92:95], v2, s[8:11], s59 offen offset:3072 nt
  s_mov_b32 s59, 0x6000
  s_bitcmp1_b32 s99, 0
  s_cbranch_scc1 L_th_49
  s_waitcnt vmcnt(5)
L_th_49:
  s_waitcnt vmcnt(5)
  buffer_load_dwordx4 a[96:99], v2, s[8:11], s59 offen offset:0 nt
  s_bitcmp1_b32 s99, 0
  s_cbranch_scc1 L_th_51
  s_waitcnt vmcnt(5)
L_th_51:
  s_waitcnt vmcnt(6)
  buffer_load_dwordx4 a[100:103], v2, s[8:11], s59 offen offset:1024 nt
  s_bitcmp1_b32 s99, 0
  s_cbranch_scc1 L_th_53
  s_waitcnt vmcnt(5)
L_th_53:
  s_waitcnt vmcnt(5)
  buffer_load_dwordx4 a[104:107], v2, s[8:11], s59 offen offset:2048 nt
  s_bitcmp1_b32 s99, 0
  s_cbranch_scc1 L_th_55
  s_waitcnt vmcnt(5)
L_th_55:
  s_waitcnt vmcnt(6)
  buffer_load_dwordx4 a[108:111], v2, s[8:11], s59 offen offset:3072 nt
  s_mov_b32 s59, 0x7000
  s_bitcmp1_b32 s99, 0
  s_cbranch_scc1 L_th_57
  s_waitcnt vmcnt(5)
L_th_57:
  s_waitcnt vmcnt(5)
  buffer_load_dwordx4 a[112:115], v2, s[8:11], s59 offen offset:0 nt
  s_bitcmp1_b32 s99, 0
  s_cbranch_scc1 L_th_59
  s_waitcnt vmcnt(5)
L_th_59:
  s_waitcnt vmcnt(6)
  buffer_load_dwordx4 a[116:119], v2, s[8:11], s59 offen offset:1024 nt
  s_waitcnt vmcnt(24)
  v_and_b32 v23, 0xffff0000, v22
  v_lshlrev_b32 v22, 16, v22
  s_waitcnt lgkmcnt(0)
  s_lshl_b32 s70, s70, 16
  v_lshlrev_b32 v30, 3, v0
  ds_write_b64 v30, v[22:23] offset:0
  v_subrev_f32 v26, s70, v22
  v_subrev_f32 v27, s70, v23
  v_add_f32 v28, v26, v27
  v_mul_f32 v29, v26, v26
  v_fmac_f32 v29, v27, v27
  v_lshrrev_b32 v30, 4, v0
  v_lshlrev_b32 v30, 3, v30
  s_nop 0
  v_add_f32_dpp v28, v28, v28 row_ror:8 row_mask:0xf bank_mask:0xf
  v_add_f32_dpp v29, v29, v29 row_ror:8 row_mask:0xf bank_mask:0xf
  s_nop 0
  v_add_f32_dpp v28, v28, v28 row_ror:4 row_mask:0xf bank_mask:0xf
  v_add_f32_dpp v29, v29, v29 row_ror:4 row_mask:0xf bank_mask:0xf
  s_nop 0
  v_add_f32_dpp v28, v28, v28 row_ror:2 row_mask:0xf bank_mask:0xf
  v_add_f32_dpp v29, v29, v29 row_ror:2 row_mask:0xf bank_mask:0xf
  s_nop 0
  v_add_f32_dpp v28, v28, v28 row_ror:1 row_mask:0xf bank_mask:0xf
  v_add_f32_dpp v29, v29, v29 row_ror:1 row_mask:0xf bank_mask:0xf
  ds_write_b64 v30, v[28:29] offset:2816
  s_waitcnt lgkmcnt(0)
  s_barrier
  v_and_b32 v26, 15, v1
  v_lshlrev_b32 v26, 3, v26
  ds_read_b64 v[80:81], v26 offset:2816
  v_lshrrev_b32 v27, 1, v1
  v_lshlrev_b32 v27, 4, v27
  s_lshl_b32 s55, s52, 9
  v_add_u32 v27, s55, v27
  ds_read_b128 v[16:19], v27 offset:0
  v_and_b32 v28, 1, v1
  v_lshlrev_b32 v28, 5, v28
  v_lshrrev_b32 v29, 4, v1
  v_lshl_add_u32 v28, v29, 3, v28
  s_lshl_b32 s55, s52, 6
  v_add_u32 v28, s55, v28
  v_and_b32 v29, 7, v1
  v_lshlrev_b32 v29, 3, v29
  s_waitcnt lgkmcnt(0)
  s_nop 0
  v_add_f32_dpp v80, v80, v80 row_ror:8 row_mask:0xf bank_mask:0xf
  v_add_f32_dpp v81, v81, v81 row_ror:8 row_mask:0xf bank_mask:0xf
  s_nop 0
  v_add_f32_dpp v80, v80, v80 row_ror:4 row_mask:0xf bank_mask:0xf
  v_add_f32_dpp v81, v81, v81 row_ror:4 row_mask:0xf bank_mask:0xf
  s_nop 0
  v_add_f32_dpp v80, v80, v80 row_ror:2 row_mask:0xf bank_mask:0xf
  v_add_f32_dpp v81, v81, v81 row_ror:2 row_mask:0xf bank_mask:0xf
  s_nop 0
  v_add_f32_dpp v80, v80, v80 row_ror:1 row_mask:0xf bank_mask:0xf
  v_add_f32_dpp v81, v81, v81 row_ror:1 row_mask:0xf bank_mask:0xf
  v_mul_f32 v80, 0x3b000000, v80
  v_mul_f32 v81, 0x3b000000, v81
  v_fma_f32 v81, -v80, v80, v81
  v_max_f32 v81, 0, v81
  v_add_f32 v80, s70, v80
  v_cvt_pk_bf16_f32 v82, v80, v81
  v_lshlrev_b32 v80, 16, v82
  v_and_b32 v81, 0xffff0000, v82
  v_add_f32 v81, 0x3727c5ac, v81
  v_cvt_pk_bf16_f32 v82, v81, v81
  v_lshlrev_b32 v81, 16, v82
  v_sqrt_f32 v81, v81
  v_sub_f32 v16, v16, v80
  v_sub_f32 v17, v17, v80
  v_sub_f32 v18, v18, v80
  v_sub_f32 v19, v19, v80
  v_cvt_pk_bf16_f32 v82, v81, v81
  v_lshlrev_b32 v81, 16, v82
  v_rcp_f32 v81, v81
  v_cvt_pk_bf16_f32 v82, v16, v17
  v_lshlrev_b32 v16, 16, v82
  v_and_b32 v17, 0xffff0000, v82
  v_cvt_pk_bf16_f32 v82, v18, v19
  v_lshlrev_b32 v18, 16, v82
  v_and_b32 v19, 0xffff0000, v82
  v_mul_f32 v16, v16, v81
  v_mul_f32 v17, v17, v81
  v_mul_f32 v18, v18, v81
  v_mul_f32 v19, v19, v81
  v_cvt_pk_bf16_f32 v82, v16, v17
  v_lshlrev_b32 v16, 16, v82
  v_and_b32 v17, 0xffff0000, v82
  v_cvt_pk_bf16_f32 v82, v18, v19
  v_lshlrev_b32 v18, 16, v82
  v_and_b32 v19, 0xffff0000, v82
  v_lshrrev_b32 v32, 16, v16
  v_lshrrev_b32 v33, 16, v17
  v_lshrrev_b32 v34, 16, v18
  v_lshrrev_b32 v35, 16, v19
  v_dot2_f32_bf16 v8, v88, v32, 0
  v_dot2_f32_bf16 v9, v88, v16, 0
  v_dot2_f32_bf16 v10, v89, v32, 0
  v_dot2_f32_bf16 v11, v89, v16, 0
  v_dot2_f32_bf16 v12, v90, v32, 0
  v_dot2_f32_bf16 v13, v90, v16, 0
  v_dot2_f32_bf16 v14, v91, v32, 0
  v_dot2_f32_bf16 v15, v91, v16, 0
  v_dot2c_f32_bf16 v8, v92, v33
  v_dot2c_f32_bf16 v9, v92, v17
  v_dot2c_f32_bf16 v10, v93, v33
  v_dot2c_f32_bf16 v11, v93, v17
  v_dot2c_f32_bf16 v12, v94, v33
  v_dot2c_f32_bf16 v13, v94, v17
  v_dot2c_f32_bf16 v14, v95, v33
  v_dot2c_f32_bf16 v15, v95, v17
  v_dot2c_f32_bf16 v8, v96, v34
  v_dot2c_f32_bf16 v9, v96, v18
  v_dot2c_f32_bf16 v10, v97, v34
  v_dot2c_f32_bf16 v11, v97, v18
  v_dot2c_f32_bf16 v12, v98, v34
  v_dot2c_f32_bf16 v13, v98, v18
  v_dot2c_f32_bf16 v14, v99, v34
  v_dot2c_f32_bf16 v15, v99, v18
  v_dot2c_f32_bf16 v8, v100, v35
  v_dot2c_f32_bf16 v9, v100, v19
  v_dot2c_f32_bf16 v10, v101, v35
  v_dot2c_f32_bf16 v11, v101, v19
  v_dot2c_f32_bf16 v12, v102, v35
  v_dot2c_f32_bf16 v13, v102, v19
  v_dot2c_f32_bf16 v14, v103, v35
  v_dot2c_f32_bf16 v15, v103, v19
  s_nop 2
  v_permlane32_swap_b32 v8, v12
  v_permlane32_swap_b32 v9, v13
  v_permlane32_swap_b32 v10, v14
  v_permlane32_swap_b32 v11, v15
  s_nop 0
  v_add_f32 v8, v8, v12
  v_add_f32 v9, v9, v13
  v_add_f32 v10, v10, v14
  v_add_f32 v11, v11, v15
  s_nop 0
  v_permlane16_swap_b32 v8, v10
  v_permlane16_swap_b32 v9, v11
  s_nop 0
  v_add_f32 v8, v8, v10
  v_add_f32 v9, v9, v11
  s_nop 0
  v_add_f32_dpp v8, v8, v8 row_ror:8 row_mask:0xf bank_mask:0xf
  v_add_f32_dpp v9, v9, v9 row_ror:8 row_mask:0xf bank_mask:0xf
  s_nop 0
  v_add_f32_dpp v8, v8, v8 row_ror:4 row_mask:0xf bank_mask:0xf
  v_add_f32_dpp v9, v9, v9 row_ror:4 row_mask:0xf bank_mask:0xf
  s_nop 0
  v_add_f32_dpp v8, v8, v8 row_ror:2 row_mask:0xf bank_mask:0xf
  v_add_f32_dpp v9, v9, v9 row_ror:2 row_mask:0xf bank_mask:0xf
  ds_write_b64 v28, v[8:9] offset:2048
  s_waitcnt lgkmcnt(0)
  s_barrier
  ds_read_b64 v[8:9], v29 offset:2048
  ds_read_b64 v[10:11], v29 offset:2112
  ds_read_b64 v[12:13], v29 offset:2176
  ds_read_b64 v[14:15], v29 offset:2240
  s_waitcnt lgkmcnt(0)
  v_pk_add_f32 v[8:9], v[8:9], v[10:11]
  v_pk_add_f32 v[12:13], v[12:13], v[14:15]
  v_pk_add_f32 v[80:81], v[8:9], v[12:13]
  v_cvt_pk_bf16_f32 v82, v80, v81
  v_min_u32 v82, -2, v82
  v_lshlrev_b32 v83, 2, v1
  s_lshl_b32 s97, s53, 10
  s_lshl_b32 s56, s54, 5
  s_add_u32 s97, s97, s56
  s_add_u32 s97, s97, 0x600000
  s_cmp_lg_u32 s52, 0
  s_cbranch_scc1 L_w0_61
  s_mov_b64 exec, 0xff
  buffer_store_dword v82, v83, s[48:51], s97 offen sc1
  s_mov_b64 exec, -1
L_w0_61:
  v_and_b32 v30, 3, v1
  v_lshlrev_b32 v30, 8, v30
  v_lshrrev_b32 v31, 2, v1
  v_lshl_add_u32 v30, v31, 4, v30
  s_lshl_b32 s65, s53, 10
  s_add_u32 s65, s65, 0x600000
  v_and_b32 v28, 7, v1
  v_lshlrev_b32 v28, 2, v28
  s_lshl_b32 s57, s53, 5
  s_add_u32 s97, s57, s54
  s_mov_b32 s66, 0x01010101
  v_mov_b32 v84, 1
  v_mov_b32 v85, 0
  s_waitcnt vmcnt(16)
  s_bitcmp1_b32 s99, 0
  s_cbranch_scc1 L_th_62
  s_waitcnt vmcnt(5)
L_th_62:
  s_waitcnt vmcnt(5)
  buffer_load_dwordx4 a[120:123], v2, s[8:11], s59 offen offset:2048 nt
  s_bitcmp1_b32 s99, 0
  s_cbranch_scc1 L_th_64
  s_waitcnt vmcnt(5)
L_th_64:
  s_waitcnt vmcnt(6)
  buffer_load_dwordx4 a[124:127], v2, s[8:11], s59 offen offset:3072 nt
  s_mov_b32 s59, 0x8000
  s_bitcmp1_b32 s99, 0
  s_cbranch_scc1 L_th_66
  s_waitcnt vmcnt(5)
L_th_66:
  s_waitcnt vmcnt(5)
  buffer_load_dwordx4 a[128:131], v2, s[8:11], s59 offen offset:0 nt
  s_bitcmp1_b32 s99, 0
  s_cbranch_scc1 L_th_68
  s_waitcnt vmcnt(5)
L_th_68:
  s_waitcnt vmcnt(6)
  buffer_load_dwordx4 a[132:135], v2, s[8:11], s59 offen offset:1024 nt
  s_bitcmp1_b32 s99, 0
  s_cbranch_scc1 L_th_70
  s_waitcnt vmcnt(5)
L_th_70:
  s_waitcnt vmcnt(5)
  buffer_load_dwordx4 a[136:139], v2, s[8:11], s59 offen offset:2048 nt
  s_bitcmp1_b32 s99, 0
  s_cbranch_scc1 L_th_72
  s_waitcnt vmcnt(5)
L_th_72:
  s_waitcnt vmcnt(6)
  buffer_load_dwordx4 a[140:143], v2, s[8:11], s59 offen offset:3072 nt
  s_mov_b32 s59, 0x9000
  s_bitcmp1_b32 s99, 0
  s_cbranch_scc1 L_th_74
  s_waitcnt vmcnt(5)
L_th_74:
  s_waitcnt vmcnt(5)
  buffer_load_dwordx4 a[144:147], v2, s[8:11], s59 offen offset:0 nt
  s_bitcmp1_b32 s99, 0
  s_cbranch_scc1 L_th_76
  s_waitcnt vmcnt(5)
L_th_76:
  s_waitcnt vmcnt(6)
  buffer_load_dwordx4 a[148:151], v2, s[8:11], s59 offen offset:1024 nt
  s_waitcnt vmcnt(16)
  s_bitcmp1_b32 s99, 0
  s_cbranch_scc1 L_th_78
  s_waitcnt vmcnt(5)
L_th_78:
  s_waitcnt vmcnt(5)
  buffer_load_dwordx4 a[152:155], v2, s[8:11], s59 offen offset:2048 nt
  s_bitcmp1_b32 s99, 0
  s_cbranch_scc1 L_th_80
  s_waitcnt vmcnt(5)
L_th_80:
  s_waitcnt vmcnt(6)
  buffer_load_dwordx4 a[156:159], v2, s[8:11], s59 offen offset:3072 nt
  s_mov_b32 s59, 0xa000
  s_bitcmp1_b32 s99, 0
  s_cbranch_scc1 L_th_82
  s_waitcnt vmcnt(5)
L_th_82:
  s_waitcnt vmcnt(5)
  buffer_load_dwordx4 a[160:163], v2, s[8:11], s59 offen offset:0 nt
  s_bitcmp1_b32 s99, 0
  s_cbranch_scc1 L_th_84
  s_waitcnt vmcnt(5)
L_th_84:
  s_waitcnt vmcnt(6)
  buffer_load_dwordx4 a[164:167], v2, s[8:11], s59 offen offset:1024 nt
  s_bitcmp1_b32 s99, 0
  s_cbranch_scc1 L_th_86
  s_waitcnt vmcnt(5)
L_th_86:
  s_waitcnt vmcnt(5)
  buffer_load_dwordx4 a[168:171], v2, s[8:11], s59 offen offset:2048 nt
  s_bitcmp1_b32 s99, 0
  s_cbranch_scc1 L_th_88
  s_waitcnt vmcnt(5)
L_th_88:
  s_waitcnt vmcnt(6)
  buffer_load_dwordx4 a[172:175], v2, s[8:11], s59 offen offset:3072 nt
  s_mov_b32 s59, 0xb000
  s_bitcmp1_b32 s99, 0
  s_cbranch_scc1 L_th_90
  s_waitcnt vmcnt(5)
L_th_90:
  s_waitcnt vmcnt(5)
  buffer_load_dwordx4 a[176:179], v2, s[8:11], s59 offen offset:0 nt
  s_bitcmp1_b32 s99, 0
  s_cbranch_scc1 L_th_92
  s_waitcnt vmcnt(5)
L_th_92:
  s_waitcnt vmcnt(6)
  buffer_load_dwordx4 a[180:183], v2, s[8:11], s59 offen offset:1024 nt
  s_waitcnt vmcnt(15)
  s_cmp_lg_u32 s52, 0
  s_cbranch_scc1 L_w0_94
  s_mov_b64 exec, 0x1
  buffer_store_byte v84, v85, s[44:47], s97 offen sc1
  s_mov_b64 exec, -1
L_w0_94:
  s_bitcmp1_b32 s99, 0
  s_cbranch_scc1 L_th_95
  s_waitcnt vmcnt(5)
L_th_95:
  s_waitcnt vmcnt(5)
  buffer_load_dwordx4 a[184:187], v2, s[8:11], s59 offen offset:2048 nt
  s_bitcmp1_b32 s99, 0
  s_cbranch_scc1 L_th_97
  s_waitcnt vmcnt(5)
L_th_97:
  s_waitcnt vmcnt(6)
  buffer_load_dwordx4 a[188:191], v2, s[8:11], s59 offen offset:3072 nt
  s_mov_b32 s59, 0xc000
  s_bitcmp1_b32 s99, 0
  s_cbranch_scc1 L_th_99
  s_waitcnt vmcnt(5)
L_th_99:
  s_waitcnt vmcnt(5)
  buffer_load_dwordx4 a[192:195], v2, s[8:11], s59 offen offset:0 nt
  s_bitcmp1_b32 s99, 0
  s_cbranch_scc1 L_th_101
  s_waitcnt vmcnt(5)
L_th_101:
  s_waitcnt vmcnt(6)
  buffer_load_dwordx4 a[196:199], v2, s[8:11], s59 offen offset:1024 nt
  s_bitcmp1_b32 s99, 0
  s_cbranch_scc1 L_th_103
  s_waitcnt vmcnt(5)
L_th_103:
  s_waitcnt vmcnt(5)
  buffer_load_dwordx4 a[200:203], v2, s[8:11], s59 offen offset:2048 nt
  s_bitcmp1_b32 s99, 0
  s_cbranch_scc1 L_th_105
  s_waitcnt vmcnt(5)
L_th_105:
  s_waitcnt vmcnt(6)
  buffer_load_dwordx4 a[204:207], v2, s[8:11], s59 offen offset:3072 nt
  s_mov_b32 s59, 0xd000
  s_bitcmp1_b32 s99, 0
  s_cbranch_scc1 L_th_107
  s_waitcnt vmcnt(5)
L_th_107:
  s_waitcnt vmcnt(5)
  buffer_load_dwordx4 a[208:211], v2, s[8:11], s59 offen offset:0 nt
  s_bitcmp1_b32 s99, 0
  s_cbranch_scc1 L_th_109
  s_waitcnt vmcnt(5)
L_th_109:
  s_waitcnt vmcnt(6)
  buffer_load_dwordx4 a[212:215], v2, s[8:11], s59 offen offset:1024 nt
  s_waitcnt vmcnt(16)
  s_bitcmp1_b32 s99, 0
  s_cbranch_scc1 L_th_111
  s_waitcnt vmcnt(5)
L_th_111:
  s_waitcnt vmcnt(5)
  buffer_load_dwordx4 a[216:219], v2, s[8:11], s59 offen offset:2048 nt
  s_bitcmp1_b32 s99, 0
  s_cbranch_scc1 L_th_113
  s_waitcnt vmcnt(5)
L_th_113:
  s_waitcnt vmcnt(6)
  buffer_load_dwordx4 a[220:223], v2, s[8:11], s59 offen offset:3072 nt
  s_mov_b32 s59, 0xe000
  s_bitcmp1_b32 s99, 0
  s_cbranch_scc1 L_th_115
  s_waitcnt vmcnt(5)
L_th_115:
  s_waitcnt vmcnt(5)
  buffer_load_dwordx4 a[224:227], v2, s[8:11], s59 offen offset:0 nt
  s_bitcmp1_b32 s99, 0
  s_cbranch_scc1 L_th_117
  s_waitcnt vmcnt(5)
L_th_117:
  s_waitcnt vmcnt(6)
  buffer_load_dwordx4 a[228:231], v2, s[8:11], s59 offen offset:1024 nt
  s_bitcmp1_b32 s99, 0
  s_cbranch_scc1 L_th_119
  s_waitcnt vmcnt(5)
L_th_119:
  s_waitcnt vmcnt(5)
  buffer_load_dwordx4 a[232:235], v2, s[8:11], s59 offen offset:2048 nt
  s_bitcmp1_b32 s99, 0
  s_cbranch_scc1 L_th_121
  s_waitcnt vmcnt(5)
L_th_121:
  s_waitcnt vmcnt(6)
  buffer_load_dwordx4 a[236:239], v2, s[8:11], s59 offen offset:3072 nt
  s_mov_b32 s59, 0xf000
  s_bitcmp1_b32 s99, 0
  s_cbranch_scc1 L_th_123
  s_waitcnt vmcnt(5)
L_th_123:
  s_waitcnt vmcnt(5)
  buffer_load_dwordx4 a[240:243], v2, s[8:11], s59 offen offset:0 nt
  s_bitcmp1_b32 s99, 0
  s_cbranch_scc1 L_th_125
  s_waitcnt vmcnt(5)
L_th_125:
  s_waitcnt vmcnt(6)
  buffer_load_dwordx4 a[244:247], v2, s[8:11], s59 offen offset:1024 nt
  s_waitcnt vmcnt(16)
  s_bitcmp1_b32 s99, 0
  s_cbranch_scc1 L_th_127
  s_waitcnt vmcnt(5)
L_th_127:
  s_waitcnt vmcnt(5)
  buffer_load_dwordx4 a[248:251], v2, s[8:11], s59 offen offset:2048 nt
  s_bitcmp1_b32 s99, 0
  s_cbranch_scc1 L_th_129
  s_waitcnt vmcnt(5)
L_th_129:
  s_waitcnt vmcnt(6)
  buffer_load_dwordx4 a[252:255], v2, s[8:11], s59 offen offset:3072 nt
  s_mov_b32 s59, 0x10000
  s_bitcmp1_b32 s99, 0
  s_cbranch_scc1 L_th_131
  s_waitcnt vmcnt(5)
L_th_131:
  s_waitcnt vmcnt(5)
  buffer_load_dwordx4 v[144:147], v2, s[8:11], s59 offen offset:0 nt
  s_bitcmp1_b32 s99, 0
  s_cbranch_scc1 L_th_133
  s_waitcnt vmcnt(5)
L_th_133:
  s_waitcnt vmcnt(6)
  buffer_load_dwordx4 v[148:151], v2, s[8:11], s59 offen offset:1024 nt
  s_bitcmp1_b32 s99, 0
  s_cbranch_scc1 L_th_135
  s_waitcnt vmcnt(5)
L_th_135:
  s_waitcnt vmcnt(5)
  buffer_load_dwordx4 v[152:155], v2, s[8:11], s59 offen offset:2048 nt
  s_bitcmp1_b32 s99, 0
  s_cbranch_scc1 L_th_137
  s_waitcnt vmcnt(5)
L_th_137:
  s_waitcnt vmcnt(6)
  buffer_load_dwordx4 v[156:159], v2, s[8:11], s59 offen offset:3072 nt
  s_mov_b32 s59, 0x11000
  s_bitcmp1_b32 s99, 0
  s_cbranch_scc1 L_th_139
  s_waitcnt vmcnt(5)
L_th_139:
  s_waitcnt vmcnt(5)
  buffer_load_dwordx4 v[160:163], v2, s[8:11], s59 offen offset:0 nt
  s_bitcmp1_b32 s99, 0
  s_cbranch_scc1 L_th_141
  s_waitcnt vmcnt(5)
L_th_141:
  s_waitcnt vmcnt(6)
  buffer_load_dwordx4 v[164:167], v2, s[8:11], s59 offen offset:1024 nt
  s_waitcnt vmcnt(16)
  s_cmp_eq_u32 s67, 2
  s_cbranch_scc1 L_att_143_k
  s_cmp_eq_u32 s67, 1
  s_cbranch_scc1 L_att_143_q
  v_mov_b32 v29, 0
  buffer_load_dword v29, v28, s[44:47], s57 offen sc1
  s_branch L_att_143_k
L_att_143_q:
  v_mov_b32 v4, -1
  v_mov_b32 v5, -1
  v_mov_b32 v6, -1
  v_mov_b32 v7, -1
  buffer_load_dwordx4 v[4:7], v30, s[48:51], s65 offen sc1
L_att_143_k:
  s_bitcmp1_b32 s99, 0
  s_cbranch_scc1 L_th_144
  s_waitcnt vmcnt(5)
L_th_144:
  s_waitcnt vmcnt(5)
  buffer_load_dwordx4 v[168:171], v2, s[8:11], s59 offen offset:2048 nt
  s_bitcmp1_b32 s99, 0
  s_cbranch_scc1 L_th_146
  s_waitcnt vmcnt(5)
L_th_146:
  s_waitcnt vmcnt(6)
  buffer_load_dwordx4 v[172:175], v2, s[8:11], s59 offen offset:3072 nt
  s_mov_b32 s59, 0x12000
  s_bitcmp1_b32 s99, 0
  s_cbranch_scc1 L_th_148
  s_waitcnt vmcnt(5)
L_th_148:
  s_waitcnt vmcnt(5)
  buffer_load_dwordx4 v[176:179], v2, s[8:11], s59 offen offset:0 nt
  s_bitcmp1_b32 s99, 0
  s_cbranch_scc1 L_th_150
  s_waitcnt vmcnt(5)
L_th_150:
  s_waitcnt vmcnt(6)
  buffer_load_dwordx4 v[180:183], v2, s[8:11], s59 offen offset:1024 nt
  s_bitcmp1_b32 s99, 0
  s_cbranch_scc1 L_th_152
  s_waitcnt vmcnt(5)
L_th_152:
  s_waitcnt vmcnt(5)
  buffer_load_dwordx4 v[184:187], v2, s[8:11], s59 offen offset:2048 nt
  s_bitcmp1_b32 s99, 0
  s_cbranch_scc1 L_th_154
  s_waitcnt vmcnt(5)
L_th_154:
  s_waitcnt vmcnt(6)
  buffer_load_dwordx4 v[188:191], v2, s[8:11], s59 offen offset:3072 nt
  s_mov_b32 s59, 0x13000
  s_bitcmp1_b32 s99, 0
  s_cbranch_scc1 L_th_156
  s_waitcnt vmcnt(5)
L_th_156:
  s_waitcnt vmcnt(5)
  buffer_load_dwordx4 v[192:195], v2, s[8:11], s59 offen offset:0 nt
  s_bitcmp1_b32 s99, 0
  s_cbranch_scc1 L_th_158
  s_waitcnt vmcnt(5)
L_th_158:
  s_waitcnt vmcnt(6)
  buffer_load_dwordx4 v[196:199], v2, s[8:11], s59 offen offset:1024 nt
  s_cmp_eq_u32 s67, 2
  s_cbranch_scc1 L_att_143_n
  s_waitcnt vmcnt(8)
  s_cmp_eq_u32 s67, 1
  s_cbranch_scc1 L_att_143_cq
  v_cmp_ne_u32 vcc, s66, v29
  s_cbranch_vccnz L_att_143_n
  s_mov_b32 s67, 1
  s_branch L_att_143_n
L_att_143_cq:
  v_max3_u32 v26, v4, v5, v6
  v_max_u32 v26, v26, v7
  v_cmp_eq_u32 vcc, -1, v26
  s_cbranch_vccnz L_att_143_n
  s_mov_b32 s67, 2
L_att_143_n:
  s_waitcnt vmcnt(16)
  s_cmp_eq_u32 s67, 2
  s_cbranch_scc1 L_att_160_k
  s_cmp_eq_u32 s67, 1
  s_cbranch_scc1 L_att_160_q
  v_mov_b32 v29, 0
  buffer_load_dword v29, v28, s[44:47], s57 offen sc1
  s_branch L_att_160_k
L_att_160_q:
  v_mov_b32 v4, -1
  v_mov_b32 v5, -1
  v_mov_b32 v6, -1
  v_mov_b32 v7, -1
  buffer_load_dwordx4 v[4:7], v30, s[48:51], s65 offen sc1
L_att_160_k:
  s_bitcmp1_b32 s99, 0
  s_cbranch_scc1 L_th_161
  s_waitcnt vmcnt(5)
L_th_161:
  s_waitcnt vmcnt(5)
  buffer_load_dwordx4 v[200:203], v2, s[8:11], s59 offen offset:2048 nt
  s_bitcmp1_b32 s99, 0
  s_cbranch_scc1 L_th_163
  s_waitcnt vmcnt(5)
L_th_163:
  s_waitcnt vmcnt(6)
  buffer_load_dwordx4 v[204:207], v2, s[8:11], s59 offen offset:3072 nt
  s_mov_b32 s59, 0x14000
  s_bitcmp1_b32 s99, 0
  s_cbranch_scc1 L_th_165
  s_waitcnt vmcnt(5)
L_th_165:
  s_waitcnt vmcnt(5)
  buffer_load_dwordx4 v[208:211], v2, s[8:11], s59 offen offset:0 nt
  s_bitcmp1_b32 s99, 0
  s_cbranch_scc1 L_th_167
  s_waitcnt vmcnt(5)
L_th_167:
  s_waitcnt vmcnt(6)
  buffer_load_dwordx4 v[212:215], v2, s[8:11], s59 offen offset:1024 nt
  s_bitcmp1_b32 s99, 0
  s_cbranch_scc1 L_th_169
  s_waitcnt vmcnt(5)
L_th_169:
  s_waitcnt vmcnt(5)
  buffer_load_dwordx4 v[216:219], v2, s[8:11], s59 offen offset:2048 nt
  s_bitcmp1_b32 s99, 0
  s_cbranch_scc1 L_th_171
  s_waitcnt vmcnt(5)
L_th_171:
  s_waitcnt vmcnt(6)
  buffer_load_dwordx4 v[220:223], v2, s[8:11], s59 offen offset:3072 nt
  s_mov_b32 s59, 0x15000
  s_bitcmp1_b32 s99, 0
  s_cbranch_scc1 L_th_173
  s_waitcnt vmcnt(5)
L_th_173:
  s_waitcnt vmcnt(5)
  buffer_load_dwordx4 v[224:227], v2, s[8:11], s59 offen offset:0 nt
  s_bitcmp1_b32 s99, 0
  s_cbranch_scc1 L_th_175
  s_waitcnt vmcnt(5)
L_th_175:
  s_waitcnt vmcnt(6)
  buffer_load_dwordx4 v[228:231], v2, s[8:11], s59 offen offset:1024 nt
  s_cmp_eq_u32 s67, 2
  s_cbranch_scc1 L_att_160_n
  s_waitcnt vmcnt(8)
  s_cmp_eq_u32 s67, 1
  s_cbranch_scc1 L_att_160_cq
  v_cmp_ne_u32 vcc, s66, v29
  s_cbranch_vccnz L_att_160_n
  s_mov_b32 s67, 1
  s_branch L_att_160_n
L_att_160_cq:
  v_max3_u32 v26, v4, v5, v6
  v_max_u32 v26, v26, v7
  v_cmp_eq_u32 vcc, -1, v26
  s_cbranch_vccnz L_att_160_n
  s_mov_b32 s67, 2
L_att_160_n:
L_fb_177:
  s_cmp_eq_u32 s67, 2
  s_cbranch_scc1 L_fb_177_done
  s_sleep 4
  s_cmp_eq_u32 s67, 2
  s_cbranch_scc1 L_att_178_k
  s_cmp_eq_u32 s67, 1
  s_cbranch_scc1 L_att_178_q
  v_mov_b32 v29, 0
  buffer_load_dword v29, v28, s[44:47], s57 offen sc1
  s_branch L_att_178_k
L_att_178_q:
  v_mov_b32 v4, -1
  v_mov_b32 v5, -1
  v_mov_b32 v6, -1
  v_mov_b32 v7, -1
  buffer_load_dwordx4 v[4:7], v30, s[48:51], s65 offen sc1
L_att_178_k:
  s_cmp_eq_u32 s67, 2
  s_cbranch_scc1 L_att_178_n
  s_waitcnt vmcnt(0)
  s_cmp_eq_u32 s67, 1
  s_cbranch_scc1 L_att_178_cq
  v_cmp_ne_u32 vcc, s66, v29
  s_cbranch_vccnz L_att_178_n
  s_mov_b32 s67, 1
  s_branch L_att_178_n
L_att_178_cq:
  v_max3_u32 v26, v4, v5, v6
  v_max_u32 v26, v26, v7
  v_cmp_eq_u32 vcc, -1, v26
  s_cbranch_vccnz L_att_178_n
  s_mov_b32 s67, 2
L_att_178_n:
  s_sub_u32 s58, s58, 1
  s_cmp_gt_i32 s58, 0
  s_cbranch_scc1 L_fb_177
L_fb_177_done:
  v_lshlrev_b32 v84, 2, v1
  s_mov_b32 s67, 0x01010101
  s_lshl_b32 s92, s53, 7
  s_add_u32 s92, s92, 0x34000
  s_lshl_b32 s93, s54, 2
  s_add_u32 s93, s93, s92
  s_lshl_b32 s101, s53, 2
  s_add_u32 s101, s101, 0x34400
  s_mov_b32 s94, 0
  s_mov_b32 s95, -1
  v_mfma_f32_16x16x32_bf16 v[64:67], a[0:3], v[4:7], 0
  ds_write_b128 v25, a[0:3] offset:0
  s_nop 2
  v_mfma_f32_16x16x32_bf16 v[68:71], a[4:7], v[4:7], 0
  ds_write_b128 v25, a[4:7] offset:1024
  s_nop 2
  v_mfma_f32_16x16x32_bf16 v[72:75], a[8:11], v[4:7], 0
  ds_write_b128 v25, a[8:11] offset:2048
  v_mov_b32 v85, 0
  buffer_load_dword v85, v84, s[44:47], 0 offen sc1
  v_add_f32_dpp v32, v65, v64 row_ror:12 row_mask:0xf bank_mask:0x1
  v_add_f32_dpp v32, v66, v32 row_ror:8 row_mask:0xf bank_mask:0x1
  v_add_f32_dpp v32, v67, v32 row_ror:4 row_mask:0xf bank_mask:0x1
  v_mfma_f32_16x16x32_bf16 v[76:79], a[12:15], v[4:7], 0
  ds_write_b128 v25, a[12:15] offset:3072
  v_add_f32_dpp v32, v68, v69 row_ror:4 row_mask:0xf bank_mask:0x2
  v_add_f32_dpp v32, v70, v32 row_ror:12 row_mask:0xf bank_mask:0x2
  v_add_f32_dpp v32, v71, v32 row_ror:8 row_mask:0xf bank_mask:0x2
  v_mfma_f32_16x16x32_bf16 v[64:67], a[16:19], v[4:7], 0
  ds_write_b128 v25, a[16:19] offset:4096
  v_add_f32_dpp v32, v72, v74 row_ror:8 row_mask:0xf bank_mask:0x4
  v_add_f32_dpp v32, v73, v32 row_ror:4 row_mask:0xf bank_mask:0x4
  v_add_f32_dpp v32, v75, v32 row_ror:12 row_mask:0xf bank_mask:0x4
  v_mfma_f32_16x16x32_bf16 v[68:71], a[20:23], v[4:7], 0
  ds_write_b128 v25, a[20:23] offset:5120
  v_add_f32_dpp v32, v76, v79 row_ror:12 row_mask:0xf bank_mask:0x8
  v_add_f32_dpp v32, v77, v32 row_ror:8 row_mask:0xf bank_mask:0x8
  v_add_f32_dpp v32, v78, v32 row_ror:4 row_mask:0xf bank_mask:0x8
  v_mfma_f32_16x16x32_bf16 v[72:75], a[24:27], v[4:7], 0
  ds_write_b128 v25, a[24:27] offset:6144
  v_add_f32_dpp v33, v65, v64 row_ror:12 row_mask:0xf bank_mask:0x1
  v_add_f32_dpp v33, v66, v33 row_ror:8 row_mask:0xf bank_mask:0x1
  v_add_f32_dpp v33, v67, v33 row_ror:4 row_mask:0xf bank_mask:0x1
  v_mfma_f32_16x16x32_bf16 v[76:79], a[28:31], v[4:7], 0
  ds_write_b128 v25, a[28:31] offset:7168
  v_add_f32_dpp v33, v68, v69 row_ror:4 row_mask:0xf bank_mask:0x2
  v_add_f32_dpp v33, v70, v33 row_ror:12 row_mask:0xf bank_mask:0x2
  v_add_f32_dpp v33, v71, v33 row_ror:8 row_mask:0xf bank_mask:0x2
  v_mfma_f32_16x16x32_bf16 v[64:67], a[32:35], v[4:7], 0
  ds_write_b128 v25, a[32:35] offset:8192
  v_lshrrev_b32 v26, 4, v1
  v_lshlrev_b32 v26, 15, v26
  v_bfe_u32 v27, v1, 1, 3
  v_lshl_add_u32 v26, v27, 10, v26
  v_and_b32 v27, 1, v1
  v_lshl_add_u32 v26, v27, 4, v26
  s_lshl_b32 s55, s52, 17
  s_lshl_b32 s56, s53, 19
  s_add_u32 s55, s55, s56
  s_lshl_b32 s56, s54, 5
  s_add_u32 s55, s55, s56
  buffer_load_dwordx4 v[104:107], v26, s[20:23], s55 offen
  s_add_u32 s55, s55, 8192
  buffer_load_dwordx4 v[108:111], v26, s[20:23], s55 offen
  s_add_u32 s55, s55, 8192
  buffer_load_dwordx4 v[112:115], v26, s[20:23], s55 offen
  s_add_u32 s55, s55, 8192
  buffer_load_dwordx4 v[116:119], v26, s[20:23], s55 offen
  v_add_f32_dpp v33, v72, v74 row_ror:8 row_mask:0xf bank_mask:0x4
  v_add_f32_dpp v33, v73, v33 row_ror:4 row_mask:0xf bank_mask:0x4
  v_add_f32_dpp v33, v75, v33 row_ror:12 row_mask:0xf bank_mask:0x4
  v_mfma_f32_16x16x32_bf16 v[68:71], a[36:39], v[4:7], 0
  ds_write_b128 v25, a[36:39] offset:9216
  v_add_f32_dpp v33, v76, v79 row_ror:12 row_mask:0xf bank_mask:0x8
  v_add_f32_dpp v33, v77, v33 row_ror:8 row_mask:0xf bank_mask:0x8
  v_add_f32_dpp v33, v78, v33 row_ror:4 row_mask:0xf bank_mask:0x8
  v_mfma_f32_16x16x32_bf16 v[72:75], a[40:43], v[4:7], 0
  ds_write_b128 v25, a[40:43] offset:10240
  v_add_f32_dpp v34, v65, v64 row_ror:12 row_mask:0xf bank_mask:0x1
  v_add_f32_dpp v34, v66, v34 row_ror:8 row_mask:0xf bank_mask:0x1
  v_add_f32_dpp v34, v67, v34 row_ror:4 row_mask:0xf bank_mask:0x1
  v_mfma_f32_16x16x32_bf16 v[76:79], a[44:47], v[4:7], 0
  ds_write_b128 v25, a[44:47] offset:11264
  v_add_f32_dpp v34, v68, v69 row_ror:4 row_mask:0xf bank_mask:0x2
  v_add_f32_dpp v34, v70, v34 row_ror:12 row_mask:0xf bank_mask:0x2
  v_add_f32_dpp v34, v71, v34 row_ror:8 row_mask:0xf bank_mask:0x2
  v_mfma_f32_16x16x32_bf16 v[64:67], a[48:51], v[4:7], 0
  ds_write_b128 v25, a[48:51] offset:12288
  v_add_f32_dpp v34, v72, v74 row_ror:8 row_mask:0xf bank_mask:0x4
  v_add_f32_dpp v34, v73, v34 row_ror:4 row_mask:0xf bank_mask:0x4
  v_add_f32_dpp v34, v75, v34 row_ror:12 row_mask:0xf bank_mask:0x4
  v_mfma_f32_16x16x32_bf16 v[68:71], a[52:55], v[4:7], 0
  ds_write_b128 v25, a[52:55] offset:13312
  v_add_f32_dpp v34, v76, v79 row_ror:12 row_mask:0xf bank_mask:0x8
  v_add_f32_dpp v34, v77, v34 row_ror:8 row_mask:0xf bank_mask:0x8
  v_add_f32_dpp v34, v78, v34 row_ror:4 row_mask:0xf bank_mask:0x8
  v_mfma_f32_16x16x32_bf16 v[72:75], a[56:59], v[4:7], 0
  ds_write_b128 v25, a[56:59] offset:14336
  v_add_f32_dpp v35, v65, v64 row_ror:12 row_mask:0xf bank_mask:0x1
  v_add_f32_dpp v35, v66, v35 row_ror:8 row_mask:0xf bank_mask:0x1
  v_add_f32_dpp v35, v67, v35 row_ror:4 row_mask:0xf bank_mask:0x1
  v_mfma_f32_16x16x32_bf16 v[76:79], a[60:63], v[4:7], 0
  ds_write_b128 v25, a[60:63] offset:15360
  v_add_f32_dpp v35, v68, v69 row_ror:4 row_mask:0xf bank_mask:0x2
  v_add_f32_dpp v35, v70, v35 row_ror:12 row_mask:0xf bank_mask:0x2
  v_add_f32_dpp v35, v71, v35 row_ror:8 row_mask:0xf bank_mask:0x2
  v_mfma_f32_16x16x32_bf16 v[64:67], a[64:67], v[4:7], 0
  ds_write_b128 v25, a[64:67] offset:16384
  v_add_f32_dpp v35, v72, v74 row_ror:8 row_mask:0xf bank_mask:0x4
  v_add_f32_dpp v35, v73, v35 row_ror:4 row_mask:0xf bank_mask:0x4
  v_add_f32_dpp v35, v75, v35 row_ror:12 row_mask:0xf bank_mask:0x4
  v_mfma_f32_16x16x32_bf16 v[68:71], a[68:71], v[4:7], 0
  ds_write_b128 v25, a[68:71] offset:17408
  v_add_f32_dpp v35, v76, v79 row_ror:12 row_mask:0xf bank_mask:0x8
  v_add_f32_dpp v35, v77, v35 row_ror:8 row_mask:0xf bank_mask:0x8
  v_add_f32_dpp v35, v78, v35 row_ror:4 row_mask:0xf bank_mask:0x8
  v_mfma_f32_16x16x32_bf16 v[72:75], a[72:75], v[4:7], 0
  ds_write_b128 v25, a[72:75] offset:18432
  v_add_f32_dpp v36, v65, v64 row_ror:12 row_mask:0xf bank_mask:0x1
  v_add_f32_dpp v36, v66, v36 row_ror:8 row_mask:0xf bank_mask:0x1
  v_add_f32_dpp v36, v67, v36 row_ror:4 row_mask:0xf bank_mask:0x1
  v_mfma_f32_16x16x32_bf16 v[76:79], a[76:79], v[4:7], 0
  ds_write_b128 v25, a[76:79] offset:19456
  v_add_f32_dpp v36, v68, v69 row_ror:4 row_mask:0xf bank_mask:0x2
  v_add_f32_dpp v36, v70, v36 row_ror:12 row_mask:0xf bank_mask:0x2
  v_add_f32_dpp v36, v71, v36 row_ror:8 row_mask:0xf bank_mask:0x2
  v_mfma_f32_16x16x32_bf16 v[64:67], a[80:83], v[4:7], 0
  ds_write_b128 v25, a[80:83] offset:20480
  v_lshrrev_b32 v26, 2, v1
  v_mul_u32_u24 v26, 7168, v26
  v_and_b32 v27, 3, v1
  v_lshl_add_u32 v26, v27, 4, v26
  s_lshl_b32 s55, s100, 2
  s_add_u32 s55, s55, s52
  s_mul_i32 s55, s55, 114688
  s_lshl_b32 s56, s62, 6
  s_add_u32 s55, s55, s56
  buffer_load_dwordx4 v[120:123], v26, s[24:27], s55 offen offset:0
  buffer_load_dwordx4 v[124:127], v26, s[24:27], s55 offen offset:3584
  buffer_load_dwordx4 v[128:131], v26, s[28:31], s55 offen offset:0
  buffer_load_dwordx4 v[132:135], v26, s[28:31], s55 offen offset:3584
  v_add_f32_dpp v36, v72, v74 row_ror:8 row_mask:0xf bank_mask:0x4
  v_add_f32_dpp v36, v73, v36 row_ror:4 row_mask:0xf bank_mask:0x4
  v_add_f32_dpp v36, v75, v36 row_ror:12 row_mask:0xf bank_mask:0x4
  v_mfma_f32_16x16x32_bf16 v[68:71], a[84:87], v[4:7], 0
  ds_write_b128 v25, a[84:87] offset:21504
  v_add_f32_dpp v36, v76, v79 row_ror:12 row_mask:0xf bank_mask:0x8
  v_add_f32_dpp v36, v77, v36 row_ror:8 row_mask:0xf bank_mask:0x8
  v_add_f32_dpp v36, v78, v36 row_ror:4 row_mask:0xf bank_mask:0x8
  v_mfma_f32_16x16x32_bf16 v[72:75], a[88:91], v[4:7], 0
  ds_write_b128 v25, a[88:91] offset:22528
  v_add_f32_dpp v37, v65, v64 row_ror:12 row_mask:0xf bank_mask:0x1
  v_add_f32_dpp v37, v66, v37 row_ror:8 row_mask:0xf bank_mask:0x1
  v_add_f32_dpp v37, v67, v37 row_ror:4 row_mask:0xf bank_mask:0x1
  v_mfma_f32_16x16x32_bf16 v[76:79], a[92:95], v[4:7], 0
  ds_write_b128 v25, a[92:95] offset:23552
  v_add_f32_dpp v37, v68, v69 row_ror:4 row_mask:0xf bank_mask:0x2
  v_add_f32_dpp v37, v70, v37 row_ror:12 row_mask:0xf bank_mask:0x2
  v_add_f32_dpp v37, v71, v37 row_ror:8 row_mask:0xf bank_mask:0x2
  v_mfma_f32_16x16x32_bf16 v[64:67], a[96:99], v[4:7], 0
  ds_write_b128 v25, a[96:99] offset:24576
  v_add_f32_dpp v37, v72, v74 row_ror:8 row_mask:0xf bank_mask:0x4
  v_add_f32_dpp v37, v73, v37 row_ror:4 row_mask:0xf bank_mask:0x4
  v_add_f32_dpp v37, v75, v37 row_ror:12 row_mask:0xf bank_mask:0x4
  v_mfma_f32_16x16x32_bf16 v[68:71], a[100:103], v[4:7], 0
  ds_write_b128 v25, a[100:103] offset:25600
  v_add_f32_dpp v37, v76, v79 row_ror:12 row_mask:0xf bank_mask:0x8
  v_add_f32_dpp v37, v77, v37 row_ror:8 row_mask:0xf bank_mask:0x8
  v_add_f32_dpp v37, v78, v37 row_ror:4 row_mask:0xf bank_mask:0x8
  v_mfma_f32_16x16x32_bf16 v[72:75], a[104:107], v[4:7], 0
  ds_write_b128 v25, a[104:107] offset:26624
  v_add_f32_dpp v38, v65, v64 row_ror:12 row_mask:0xf bank_mask:0x1
  v_add_f32_dpp v38, v66, v38 row_ror:8 row_mask:0xf bank_mask:0x1
  v_add_f32_dpp v38, v67, v38 row_ror:4 row_mask:0xf bank_mask:0x1
  v_mfma_f32_16x16x32_bf16 v[76:79], a[108:111], v[4:7], 0
  ds_write_b128 v25, a[108:111] offset:27648
  v_add_f32_dpp v38, v68, v69 row_ror:4 row_mask:0xf bank_mask:0x2
  v_add_f32_dpp v38, v70, v38 row_ror:12 row_mask:0xf bank_mask:0x2
  v_add_f32_dpp v38, v71, v38 row_ror:8 row_mask:0xf bank_mask:0x2
  v_mfma_f32_16x16x32_bf16 v[64:67], a[112:115], v[4:7], 0
  ds_write_b128 v25, a[112:115] offset:28672
  v_add_f32_dpp v38, v72, v74 row_ror:8 row_mask:0xf bank_mask:0x4
  v_add_f32_dpp v38, v73, v38 row_ror:4 row_mask:0xf bank_mask:0x4
  v_add_f32_dpp v38, v75, v38 row_ror:12 row_mask:0xf bank_mask:0x4
  v_mfma_f32_16x16x32_bf16 v[68:71], a[116:119], v[4:7], 0
  ds_write_b128 v25, a[116:119] offset:29696
  v_add_f32_dpp v38, v76, v79 row_ror:12 row_mask:0xf bank_mask:0x8
  v_add_f32_dpp v38, v77, v38 row_ror:8 row_mask:0xf bank_mask:0x8
  v_add_f32_dpp v38, v78, v38 row_ror:4 row_mask:0xf bank_mask:0x8
  v_mfma_f32_16x16x32_bf16 v[72:75], a[120:123], v[4:7], 0
  ds_write_b128 v25, a[120:123] offset:30720
  s_bitcmp1_b32 s99, 0
  s_cbranch_scc1 L_th_179
  s_waitcnt vmcnt(5)
L_th_179:
  s_waitcnt vmcnt(5)
  buffer_load_dwordx4 v[232:235], v2, s[8:11], s59 offen offset:2048 nt
  v_add_f32_dpp v39, v65, v64 row_ror:12 row_mask:0xf bank_mask:0x1
  v_add_f32_dpp v39, v66, v39 row_ror:8 row_mask:0xf bank_mask:0x1
  v_add_f32_dpp v39, v67, v39 row_ror:4 row_mask:0xf bank_mask:0x1
  v_mfma_f32_16x16x32_bf16 v[76:79], a[124:127], v[4:7], 0
  ds_write_b128 v25, a[124:127] offset:31744
  s_bitcmp1_b32 s99, 0
  s_cbranch_scc1 L_th_181
  s_waitcnt vmcnt(5)
L_th_181:
  s_waitcnt vmcnt(6)
  buffer_load_dwordx4 v[236:239], v2, s[8:11], s59 offen offset:3072 nt
  v_add_f32_dpp v39, v68, v69 row_ror:4 row_mask:0xf bank_mask:0x2
  v_add_f32_dpp v39, v70, v39 row_ror:12 row_mask:0xf bank_mask:0x2
  v_add_f32_dpp v39, v71, v39 row_ror:8 row_mask:0xf bank_mask:0x2
  v_mfma_f32_16x16x32_bf16 v[64:67], a[128:131], v[4:7], 0
  ds_write_b128 v25, a[128:131] offset:32768
  v_lshrrev_b32 v26, 1, v1
  v_lshlrev_b32 v26, 11, v26
  v_and_b32 v27, 1, v1
  v_lshl_add_u32 v26, v27, 4, v26
  s_mul_i32 s55, s52, 57344
  s_mul_i32 s56, s63, 229376
  s_add_u32 s55, s55, s56
  s_lshl_b32 s56, s64, 5
  s_add_u32 s55, s55, s56
  buffer_load_dwordx4 v[136:139], v26, s[32:35], s55 offen offset:0
  buffer_load_dwordx4 v[140:143], v26, s[32:35], s55 offen offset:1024
  s_mov_b32 s59, 0x16000
  s_bitcmp1_b32 s99, 0
  s_cbranch_scc1 L_th_183
  s_waitcnt vmcnt(5)
L_th_183:
  s_waitcnt vmcnt(5)
  buffer_load_dwordx4 v[240:243], v2, s[8:11], s59 offen offset:0 nt
  v_add_f32_dpp v39, v72, v74 row_ror:8 row_mask:0xf bank_mask:0x4
  v_add_f32_dpp v39, v73, v39 row_ror:4 row_mask:0xf bank_mask:0x4
  v_add_f32_dpp v39, v75, v39 row_ror:12 row_mask:0xf bank_mask:0x4
  v_mfma_f32_16x16x32_bf16 v[68:71], a[132:135], v[4:7], 0
  ds_write_b128 v25, a[132:135] offset:33792
  s_bitcmp1_b32 s99, 0
  s_cbranch_scc1 L_th_185
  s_waitcnt vmcnt(5)
L_th_185:
  s_waitcnt vmcnt(6)
  buffer_load_dwordx4 a[0:3], v2, s[8:11], s59 offen offset:1024 nt
  v_add_f32_dpp v39, v76, v79 row_ror:12 row_mask:0xf bank_mask:0x8
  v_add_f32_dpp v39, v77, v39 row_ror:8 row_mask:0xf bank_mask:0x8
  v_add_f32_dpp v39, v78, v39 row_ror:4 row_mask:0xf bank_mask:0x8
  v_mfma_f32_16x16x32_bf16 v[72:75], a[136:139], v[4:7], 0
  ds_write_b128 v25, a[136:139] offset:34816
  s_bitcmp1_b32 s99, 0
  s_cbranch_scc1 L_th_187
  s_waitcnt vmcnt(5)
L_th_187:
  s_waitcnt vmcnt(5)
  buffer_load_dwordx4 a[4:7], v2, s[8:11], s59 offen offset:2048 nt
  v_add_f32_dpp v40, v65, v64 row_ror:12 row_mask:0xf bank_mask:0x1
  v_add_f32_dpp v40, v66, v40 row_ror:8 row_mask:0xf bank_mask:0x1
  v_add_f32_dpp v40, v67, v40 row_ror:4 row_mask:0xf bank_mask:0x1
  v_mfma_f32_16x16x32_bf16 v[76:79], a[140:143], v[4:7], 0
  ds_write_b128 v25, a[140:143] offset:35840
  s_waitcnt vmcnt(15)
  v_cmp_ne_u32 vcc, s67, v85
  s_cbranch_vccz L_clr_189_ok
L_clr_189:
  s_sleep 8
  buffer_load_dword v85, v84, s[44:47], 0 offen sc1
  s_waitcnt vmcnt(0)
  v_cmp_ne_u32 vcc, s67, v85
  s_cbranch_vccz L_clr_189_ok
  s_sub_u32 s58, s58, 1
  s_cmp_gt_i32 s58, 0
  s_cbranch_scc1 L_clr_189
L_clr_189_ok:
  s_bitcmp1_b32 s99, 0
  s_cbranch_scc1 L_th_190
  s_waitcnt vmcnt(5)
L_th_190:
  s_waitcnt vmcnt(6)
  buffer_load_dwordx4 a[8:11], v2, s[8:11], s59 offen offset:3072 nt
  v_add_f32_dpp v40, v68, v69 row_ror:4 row_mask:0xf bank_mask:0x2
  v_add_f32_dpp v40, v70, v40 row_ror:12 row_mask:0xf bank_mask:0x2
  v_add_f32_dpp v40, v71, v40 row_ror:8 row_mask:0xf bank_mask:0x2
  v_mfma_f32_16x16x32_bf16 v[64:67], a[144:147], v[4:7], 0
  ds_write_b128 v25, a[144:147] offset:36864
  s_mov_b32 s59, 0x17000
  s_bitcmp1_b32 s99, 0
  s_cbranch_scc1 L_th_192
  s_waitcnt vmcnt(5)
L_th_192:
  s_waitcnt vmcnt(5)
  buffer_load_dwordx4 a[12:15], v2, s[8:11], s59 offen offset:0 nt
  v_and_b32 v31, 31, v1
  v_lshl_add_u32 v31, v31, 2, s92
  v_mov_b32 v30, 0x5d
  s_cmp_lg_u32 s52, 0
  s_cbranch_scc1 L_w0_194
  s_mov_b64 exec, 0x1
  buffer_store_dword v30, v1, s[48:51], s93 offen
  s_mov_b64 exec, -1
L_w0_194:
  buffer_load_dword v31, v31, s[48:51], 0 offen sc1
  v_add_f32_dpp v40, v72, v74 row_ror:8 row_mask:0xf bank_mask:0x4
  v_add_f32_dpp v40, v73, v40 row_ror:4 row_mask:0xf bank_mask:0x4
  v_add_f32_dpp v40, v75, v40 row_ror:12 row_mask:0xf bank_mask:0x4
  v_mfma_f32_16x16x32_bf16 v[68:71], a[148:151], v[4:7], 0
  ds_write_b128 v25, a[148:151] offset:37888
  s_bitcmp1_b32 s99, 4
  s_cbranch_scc1 L_td_196
  s_bitcmp1_b32 s99, 0
  s_cbranch_scc1 L_th_195
  s_waitcnt vmcnt(5)
L_th_195:
  s_waitcnt vmcnt(6)
L_td_196:
  buffer_load_dwordx4 a[16:19], v2, s[8:11], s59 offen offset:1024 nt
  v_add_f32_dpp v40, v76, v79 row_ror:12 row_mask:0xf bank_mask:0x8
  v_add_f32_dpp v40, v77, v40 row_ror:8 row_mask:0xf bank_mask:0x8
  v_add_f32_dpp v40, v78, v40 row_ror:4 row_mask:0xf bank_mask:0x8
  v_mfma_f32_16x16x32_bf16 v[72:75], a[152:155], v[4:7], 0
  ds_write_b128 v25, a[152:155] offset:38912
  s_bitcmp1_b32 s99, 4
  s_cbranch_scc1 L_td_198
  s_bitcmp1_b32 s99, 0
  s_cbranch_scc1 L_th_197
  s_waitcnt vmcnt(5)
L_th_197:
  s_waitcnt vmcnt(5)
L_td_198:
  buffer_load_dwordx4 a[20:23], v2, s[8:11], s59 offen offset:2048 nt
  v_add_f32_dpp v41, v65, v64 row_ror:12 row_mask:0xf bank_mask:0x1
  v_add_f32_dpp v41, v66, v41 row_ror:8 row_mask:0xf bank_mask:0x1
  v_add_f32_dpp v41, v67, v41 row_ror:4 row_mask:0xf bank_mask:0x1
  v_mfma_f32_16x16x32_bf16 v[76:79], a[156:159], v[4:7], 0
  s_bitcmp1_b32 s99, 4
  s_cbranch_scc1 L_td_200
  s_bitcmp1_b32 s99, 0
  s_cbranch_scc1 L_th_199
  s_waitcnt vmcnt(5)
L_th_199:
  s_waitcnt vmcnt(6)
L_td_200:
  buffer_load_dwordx4 a[24:27], v2, s[8:11], s59 offen offset:3072 nt
  v_add_f32_dpp v41, v68, v69 row_ror:4 row_mask:0xf bank_mask:0x2
  v_add_f32_dpp v41, v70, v41 row_ror:12 row_mask:0xf bank_mask:0x2
  v_add_f32_dpp v41, v71, v41 row_ror:8 row_mask:0xf bank_mask:0x2
  v_mfma_f32_16x16x32_bf16 v[64:67], a[160:163], v[4:7], 0
  s_mov_b32 s59, 0x18000
  s_bitcmp1_b32 s99, 4
  s_cbranch_scc1 L_td_202
  s_bitcmp1_b32 s99, 0
  s_cbranch_scc1 L_th_201
  s_waitcnt vmcnt(5)
L_th_201:
  s_waitcnt vmcnt(5)
L_td_202:
  buffer_load_dwordx4 a[28:31], v2, s[8:11], s59 offen offset:0 nt
  v_add_f32_dpp v41, v72, v74 row_ror:8 row_mask:0xf bank_mask:0x4
  v_add_f32_dpp v41, v73, v41 row_ror:4 row_mask:0xf bank_mask:0x4
  v_add_f32_dpp v41, v75, v41 row_ror:12 row_mask:0xf bank_mask:0x4
  v_mfma_f32_16x16x32_bf16 v[68:71], a[164:167], v[4:7], 0
  s_bitcmp1_b32 s99, 4
  s_cbranch_scc1 L_td_204
  s_bitcmp1_b32 s99, 0
  s_cbranch_scc1 L_th_203
  s_waitcnt vmcnt(5)
L_th_203:
  s_waitcnt vmcnt(6)
L_td_204:
  buffer_load_dwordx4 a[32:35], v2, s[8:11], s59 offen offset:1024 nt
  v_add_f32_dpp v41, v76, v79 row_ror:12 row_mask:0xf bank_mask:0x8
  v_add_f32_dpp v41, v77, v41 row_ror:8 row_mask:0xf bank_mask:0x8
  v_add_f32_dpp v41, v78, v41 row_ror:4 row_mask:0xf bank_mask:0x8
  v_mfma_f32_16x16x32_bf16 v[72:75], a[168:171], v[4:7], 0
  s_bitcmp1_b32 s99, 4
  s_cbranch_scc1 L_td_206
  s_bitcmp1_b32 s99, 0
  s_cbranch_scc1 L_th_205
  s_waitcnt vmcnt(5)
L_th_205:
  s_waitcnt vmcnt(5)
L_td_206:
  buffer_load_dwordx4 a[36:39], v2, s[8:11], s59 offen offset:2048 nt
  v_add_f32_dpp v42, v65, v64 row_ror:12 row_mask:0xf bank_mask:0x1
  v_add_f32_dpp v42, v66, v42 row_ror:8 row_mask:0xf bank_mask:0x1
  v_add_f32_dpp v42, v67, v42 row_ror:4 row_mask:0xf bank_mask:0x1
  v_mfma_f32_16x16x32_bf16 v[76:79], a[172:175], v[4:7], 0
  s_bitcmp1_b32 s99, 4
  s_cbranch_scc1 L_td_208
  s_bitcmp1_b32 s99, 0
  s_cbranch_scc1 L_th_207
  s_waitcnt vmcnt(5)
L_th_207:
  s_waitcnt vmcnt(6)
L_td_208:
  buffer_load_dwordx4 a[40:43], v2, s[8:11], s59 offen offset:3072 nt
  v_add_f32_dpp v42, v68, v69 row_ror:4 row_mask:0xf bank_mask:0x2
  v_add_f32_dpp v42, v70, v42 row_ror:12 row_mask:0xf bank_mask:0x2
  v_add_f32_dpp v42, v71, v42 row_ror:8 row_mask:0xf bank_mask:0x2
  v_mfma_f32_16x16x32_bf16 v[64:67], a[176:179], v[4:7], 0
  s_mov_b32 s59, 0x19000
  s_bitcmp1_b32 s99, 4
  s_cbranch_scc1 L_td_210
  s_bitcmp1_b32 s99, 0
  s_cbranch_scc1 L_th_209
  s_waitcnt vmcnt(5)
L_th_209:
  s_waitcnt vmcnt(5)
L_td_210:
  buffer_load_dwordx4 a[44:47], v2, s[8:11], s59 offen offset:0 nt
  s_waitcnt vmcnt(8)
  s_bitset0_b32 s99, 4
  v_cmp_lt_i32 vcc, 0x55, v31
  s_bcnt1_i32_b32 s55, vcc_lo
  s_cmp_lt_u32 s55, 22
  s_cbranch_scc1 L_ck_211
  s_bitset1_b32 s99, 4
L_ck_211:
  v_and_b32 v31, 31, v1
  v_lshl_add_u32 v31, v31, 2, s92
  v_mov_b32 v30, 0x65
  s_cmp_lg_u32 s52, 0
  s_cbranch_scc1 L_w0_212
  s_mov_b64 exec, 0x1
  buffer_store_dword v30, v1, s[48:51], s93 offen
  s_mov_b64 exec, -1
L_w0_212:
  buffer_load_dword v31, v31, s[48:51], 0 offen sc1
  v_add_f32_dpp v42, v72, v74 row_ror:8 row_mask:0xf bank_mask:0x4
  v_add_f32_dpp v42, v73, v42 row_ror:4 row_mask:0xf bank_mask:0x4
  v_add_f32_dpp v42, v75, v42 row_ror:12 row_mask:0xf bank_mask:0x4
  v_mfma_f32_16x16x32_bf16 v[68:71], a[180:183], v[4:7], 0
  s_bitcmp1_b32 s99, 4
  s_cbranch_scc1 L_td_214
  s_bitcmp1_b32 s99, 0
  s_cbranch_scc1 L_th_213
  s_waitcnt vmcnt(5)
L_th_213:
  s_waitcnt vmcnt(6)
L_td_214:
  buffer_load_dwordx4 a[48:51], v2, s[8:11], s59 offen offset:1024 nt
  v_add_f32_dpp v42, v76, v79 row_ror:12 row_mask:0xf bank_mask:0x8
  v_add_f32_dpp v42, v77, v42 row_ror:8 row_mask:0xf bank_mask:0x8
  v_add_f32_dpp v42, v78, v42 row_ror:4 row_mask:0xf bank_mask:0x8
  v_mfma_f32_16x16x32_bf16 v[72:75], a[184:187], v[4:7], 0
  s_bitcmp1_b32 s99, 4
  s_cbranch_scc1 L_td_216
  s_bitcmp1_b32 s99, 0
  s_cbranch_scc1 L_th_215
  s_waitcnt vmcnt(5)
L_th_215:
  s_waitcnt vmcnt(5)
L_td_216:
  buffer_load_dwordx4 a[52:55], v2, s[8:11], s59 offen offset:2048 nt
  v_add_f32_dpp v43, v65, v64 row_ror:12 row_mask:0xf bank_mask:0x1
  v_add_f32_dpp v43, v66, v43 row_ror:8 row_mask:0xf bank_mask:0x1
  v_add_f32_dpp v43, v67, v43 row_ror:4 row_mask:0xf bank_mask:0x1
  v_mfma_f32_16x16x32_bf16 v[76:79], a[188:191], v[4:7], 0
  s_bitcmp1_b32 s99, 4
  s_cbranch_scc1 L_td_218
  s_bitcmp1_b32 s99, 0
  s_cbranch_scc1 L_th_217
  s_waitcnt vmcnt(5)
L_th_217:
  s_waitcnt vmcnt(6)
L_td_218:
  buffer_load_dwordx4 a[56:59], v2, s[8:11], s59 offen offset:3072 nt
  v_add_f32_dpp v43, v68, v69 row_ror:4 row_mask:0xf bank_mask:0x2
  v_add_f32_dpp v43, v70, v43 row_ror:12 row_mask:0xf bank_mask:0x2
  v_add_f32_dpp v43, v71, v43 row_ror:8 row_mask:0xf bank_mask:0x2
  v_mfma_f32_16x16x32_bf16 v[64:67], a[192:195], v[4:7], 0
  s_mov_b32 s59, 0x1a000
  s_bitcmp1_b32 s99, 4
  s_cbranch_scc1 L_td_220
  s_bitcmp1_b32 s99, 0
  s_cbranch_scc1 L_th_219
  s_waitcnt vmcnt(5)
L_th_219:
  s_waitcnt vmcnt(5)
L_td_220:
  buffer_load_dwordx4 a[60:63], v2, s[8:11], s59 offen offset:0 nt
  v_add_f32_dpp v43, v72, v74 row_ror:8 row_mask:0xf bank_mask:0x4
  v_add_f32_dpp v43, v73, v43 row_ror:4 row_mask:0xf bank_mask:0x4
  v_add_f32_dpp v43, v75, v43 row_ror:12 row_mask:0xf bank_mask:0x4
  v_mfma_f32_16x16x32_bf16 v[68:71], a[196:199], v[4:7], 0
  s_bitcmp1_b32 s99, 4
  s_cbranch_scc1 L_td_222
  s_bitcmp1_b32 s99, 0
  s_cbranch_scc1 L_th_221
  s_waitcnt vmcnt(5)
L_th_221:
  s_waitcnt vmcnt(6)
L_td_222:
  buffer_load_dwordx4 a[64:67], v2, s[8:11], s59 offen offset:1024 nt
  v_add_f32_dpp v43, v76, v79 row_ror:12 row_mask:0xf bank_mask:0x8
  v_add_f32_dpp v43, v77, v43 row_ror:8 row_mask:0xf bank_mask:0x8
  v_add_f32_dpp v43, v78, v43 row_ror:4 row_mask:0xf bank_mask:0x8
  v_mfma_f32_16x16x32_bf16 v[72:75], a[200:203], v[4:7], 0
  s_bitcmp1_b32 s99, 4
  s_cbranch_scc1 L_td_224
  s_bitcmp1_b32 s99, 0
  s_cbranch_scc1 L_th_223
  s_waitcnt vmcnt(5)
L_th_223:
  s_waitcnt vmcnt(5)
L_td_224:
  buffer_load_dwordx4 a[68:71], v2, s[8:11], s59 offen offset:2048 nt
  v_add_f32_dpp v44, v65, v64 row_ror:12 row_mask:0xf bank_mask:0x1
  v_add_f32_dpp v44, v66, v44 row_ror:8 row_mask:0xf bank_mask:0x1
  v_add_f32_dpp v44, v67, v44 row_ror:4 row_mask:0xf bank_mask:0x1
  v_mfma_f32_16x16x32_bf16 v[76:79], a[204:207], v[4:7], 0
  s_bitcmp1_b32 s99, 4
  s_cbranch_scc1 L_td_226
  s_bitcmp1_b32 s99, 0
  s_cbranch_scc1 L_th_225
  s_waitcnt vmcnt(5)
L_th_225:
  s_waitcnt vmcnt(6)
L_td_226:
  buffer_load_dwordx4 a[72:75], v2, s[8:11], s59 offen offset:3072 nt
  v_add_f32_dpp v44, v68, v69 row_ror:4 row_mask:0xf bank_mask:0x2
  v_add_f32_dpp v44, v70, v44 row_ror:12 row_mask:0xf bank_mask:0x2
  v_add_f32_dpp v44, v71, v44 row_ror:8 row_mask:0xf bank_mask:0x2
  v_mfma_f32_16x16x32_bf16 v[64:67], a[208:211], v[4:7], 0
  s_waitcnt vmcnt(55)
  s_mov_b32 s59, 0x1b000
  s_bitcmp1_b32 s99, 4
  s_cbranch_scc1 L_td_228
  s_bitcmp1_b32 s99, 0
  s_cbranch_scc1 L_th_227
  s_waitcnt vmcnt(5)
L_th_227:
  s_waitcnt vmcnt(5)
L_td_228:
  buffer_load_dwordx4 a[76:79], v2, s[8:11], s59 offen offset:0 nt
  s_waitcnt vmcnt(8)
  s_bitset0_b32 s99, 4
  v_cmp_lt_i32 vcc, 0x5d, v31
  s_bcnt1_i32_b32 s55, vcc_lo
  s_cmp_lt_u32 s55, 22
  s_cbranch_scc1 L_ck_229
  s_bitset1_b32 s99, 4
L_ck_229:
  v_and_b32 v31, 31, v1
  v_lshl_add_u32 v31, v31, 2, s92
  v_mov_b32 v30, 0x6d
  s_cmp_lg_u32 s52, 0
  s_cbranch_scc1 L_w0_230
  s_mov_b64 exec, 0x1
  buffer_store_dword v30, v1, s[48:51], s93 offen
  s_mov_b64 exec, -1
L_w0_230:
  buffer_load_dword v31, v31, s[48:51], 0 offen sc1
  v_add_f32_dpp v44, v72, v74 row_ror:8 row_mask:0xf bank_mask:0x4
  v_add_f32_dpp v44, v73, v44 row_ror:4 row_mask:0xf bank_mask:0x4
  v_add_f32_dpp v44, v75, v44 row_ror:12 row_mask:0xf bank_mask:0x4
  v_mfma_f32_16x16x32_bf16 v[68:71], a[212:215], v[4:7], 0
  s_waitcnt vmcnt(55)
  s_bitcmp1_b32 s99, 4
  s_cbranch_scc1 L_td_232
  s_bitcmp1_b32 s99, 0
  s_cbranch_scc1 L_th_231
  s_waitcnt vmcnt(5)
L_th_231:
  s_waitcnt vmcnt(6)
L_td_232:
  buffer_load_dwordx4 a[80:83], v2, s[8:11], s59 offen offset:1024 nt
  v_add_f32_dpp v44, v76, v79 row_ror:12 row_mask:0xf bank_mask:0x8
  v_add_f32_dpp v44, v77, v44 row_ror:8 row_mask:0xf bank_mask:0x8
  v_add_f32_dpp v44, v78, v44 row_ror:4 row_mask:0xf bank_mask:0x8
  v_mfma_f32_16x16x32_bf16 v[72:75], a[216:219], v[4:7], 0
  s_waitcnt vmcnt(55)
  s_bitcmp1_b32 s99, 4
  s_cbranch_scc1 L_td_234
  s_bitcmp1_b32 s99, 0
  s_cbranch_scc1 L_th_233
  s_waitcnt vmcnt(5)
L_th_233:
  s_waitcnt vmcnt(5)
L_td_234:
  buffer_load_dwordx4 a[84:87], v2, s[8:11], s59 offen offset:2048 nt
  v_add_f32_dpp v45, v65, v64 row_ror:12 row_mask:0xf bank_mask:0x1
  v_add_f32_dpp v45, v66, v45 row_ror:8 row_mask:0xf bank_mask:0x1
  v_add_f32_dpp v45, v67, v45 row_ror:4 row_mask:0xf bank_mask:0x1
  v_mfma_f32_16x16x32_bf16 v[76:79], a[220:223], v[4:7], 0
  s_waitcnt vmcnt(55)
  s_bitcmp1_b32 s99, 4
  s_cbranch_scc1 L_td_236
  s_bitcmp1_b32 s99, 0
  s_cbranch_scc1 L_th_235
  s_waitcnt vmcnt(5)
L_th_235:
  s_waitcnt vmcnt(6)
L_td_236:
  buffer_load_dwordx4 a[88:91], v2, s[8:11], s59 offen offset:3072 nt
  v_add_f32_dpp v45, v68, v69 row_ror:4 row_mask:0xf bank_mask:0x2
  v_add_f32_dpp v45, v70, v45 row_ror:12 row_mask:0xf bank_mask:0x2
  v_add_f32_dpp v45, v71, v45 row_ror:8 row_mask:0xf bank_mask:0x2
  v_mfma_f32_16x16x32_bf16 v[64:67], a[224:227], v[4:7], 0
  s_waitcnt vmcnt(55)
  s_mov_b32 s59, 0x1c000
  s_bitcmp1_b32 s99, 4
  s_cbranch_scc1 L_td_238
  s_bitcmp1_b32 s99, 0
  s_cbranch_scc1 L_th_237
  s_waitcnt vmcnt(5)
L_th_237:
  s_waitcnt vmcnt(5)
L_td_238:
  buffer_load_dwordx4 a[92:95], v2, s[8:11], s59 offen offset:0 nt
  v_add_f32_dpp v45, v72, v74 row_ror:8 row_mask:0xf bank_mask:0x4
  v_add_f32_dpp v45, v73, v45 row_ror:4 row_mask:0xf bank_mask:0x4
  v_add_f32_dpp v45, v75, v45 row_ror:12 row_mask:0xf bank_mask:0x4
  v_mfma_f32_16x16x32_bf16 v[68:71], a[228:231], v[4:7], 0
  s_waitcnt vmcnt(55)
  s_bitcmp1_b32 s99, 4
  s_cbranch_scc1 L_td_240
  s_bitcmp1_b32 s99, 0
  s_cbranch_scc1 L_th_239
  s_waitcnt vmcnt(5)
L_th_239:
  s_waitcnt vmcnt(6)
L_td_240:
  buffer_load_dwordx4 a[96:99], v2, s[8:11], s59 offen offset:1024 nt
  v_add_f32_dpp v45, v76, v79 row_ror:12 row_mask:0xf bank_mask:0x8
  v_add_f32_dpp v45, v77, v45 row_ror:8 row_mask:0xf bank_mask:0x8
  v_add_f32_dpp v45, v78, v45 row_ror:4 row_mask:0xf bank_mask:0x8
  v_mfma_f32_16x16x32_bf16 v[72:75], a[232:235], v[4:7], 0
  s_waitcnt vmcnt(55)
  s_bitcmp1_b32 s99, 4
  s_cbranch_scc1 L_td_242
  s_bitcmp1_b32 s99, 0
  s_cbranch_scc1 L_th_241
  s_waitcnt vmcnt(5)
L_th_241:
  s_waitcnt vmcnt(5)
L_td_242:
  buffer_load_dwordx4 a[100:103], v2, s[8:11], s59 offen offset:2048 nt
  v_add_f32_dpp v46, v65, v64 row_ror:12 row_mask:0xf bank_mask:0x1
  v_add_f32_dpp v46, v66, v46 row_ror:8 row_mask:0xf bank_mask:0x1
  v_add_f32_dpp v46, v67, v46 row_ror:4 row_mask:0xf bank_mask:0x1
  v_mfma_f32_16x16x32_bf16 v[76:79], a[236:239], v[4:7], 0
  s_waitcnt vmcnt(55)
  s_bitcmp1_b32 s99, 4
  s_cbranch_scc1 L_td_244
  s_bitcmp1_b32 s99, 0
  s_cbranch_scc1 L_th_243
  s_waitcnt vmcnt(5)
L_th_243:
  s_waitcnt vmcnt(6)
L_td_244:
  buffer_load_dwordx4 a[104:107], v2, s[8:11], s59 offen offset:3072 nt
  v_add_f32_dpp v46, v68, v69 row_ror:4 row_mask:0xf bank_mask:0x2
  v_add_f32_dpp v46, v70, v46 row_ror:12 row_mask:0xf bank_mask:0x2
  v_add_f32_dpp v46, v71, v46 row_ror:8 row_mask:0xf bank_mask:0x2
  v_mfma_f32_16x16x32_bf16 v[64:67], a[240:243], v[4:7], 0
  s_waitcnt vmcnt(55)
  s_mov_b32 s59, 0x1d000
  s_bitcmp1_b32 s99, 4
  s_cbranch_scc1 L_td_246
  s_bitcmp1_b32 s99, 0
  s_cbranch_scc1 L_th_245
  s_waitcnt vmcnt(5)
L_th_245:
  s_waitcnt vmcnt(5)
L_td_246:
  buffer_load_dwordx4 a[108:111], v2, s[8:11], s59 offen offset:0 nt
  s_waitcnt vmcnt(8)
  s_bitset0_b32 s99, 4
  v_cmp_lt_i32 vcc, 0x65, v31
  s_bcnt1_i32_b32 s55, vcc_lo
  s_cmp_lt_u32 s55, 22
  s_cbranch_scc1 L_ck_247
  s_bitset1_b32 s99, 4
L_ck_247:
  v_and_b32 v31, 31, v1
  v_lshl_add_u32 v31, v31, 2, s92
  v_mov_b32 v30, 0x75
  s_cmp_lg_u32 s52, 0
  s_cbranch_scc1 L_w0_248
  s_mov_b64 exec, 0x1
  buffer_store_dword v30, v1, s[48:51], s93 offen
  s_mov_b64 exec, -1
L_w0_248:
  buffer_load_dword v31, v31, s[48:51], 0 offen sc1
  v_add_f32_dpp v46, v72, v74 row_ror:8 row_mask:0xf bank_mask:0x4
  v_add_f32_dpp v46, v73, v46 row_ror:4 row_mask:0xf bank_mask:0x4
  v_add_f32_dpp v46, v75, v46 row_ror:12 row_mask:0xf bank_mask:0x4
  v_mfma_f32_16x16x32_bf16 v[68:71], a[244:247], v[4:7], 0
  s_waitcnt vmcnt(55)
  s_bitcmp1_b32 s99, 4
  s_cbranch_scc1 L_td_250
  s_bitcmp1_b32 s99, 0
  s_cbranch_scc1 L_th_249
  s_waitcnt vmcnt(5)
L_th_249:
  s_waitcnt vmcnt(6)
L_td_250:
  buffer_load_dwordx4 a[112:115], v2, s[8:11], s59 offen offset:1024 nt
  v_add_f32_dpp v46, v76, v79 row_ror:12 row_mask:0xf bank_mask:0x8
  v_add_f32_dpp v46, v77, v46 row_ror:8 row_mask:0xf bank_mask:0x8
  v_add_f32_dpp v46, v78, v46 row_ror:4 row_mask:0xf bank_mask:0x8
  v_mfma_f32_16x16x32_bf16 v[72:75], a[248:251], v[4:7], 0
  s_waitcnt vmcnt(55)
  s_bitcmp1_b32 s99, 4
  s_cbranch_scc1 L_td_252
  s_bitcmp1_b32 s99, 0
  s_cbranch_scc1 L_th_251
  s_waitcnt vmcnt(5)
L_th_251:
  s_waitcnt vmcnt(5)
L_td_252:
  buffer_load_dwordx4 a[116:119], v2, s[8:11], s59 offen offset:2048 nt
  v_add_f32_dpp v47, v65, v64 row_ror:12 row_mask:0xf bank_mask:0x1
  v_add_f32_dpp v47, v66, v47 row_ror:8 row_mask:0xf bank_mask:0x1
  v_add_f32_dpp v47, v67, v47 row_ror:4 row_mask:0xf bank_mask:0x1
  v_mfma_f32_16x16x32_bf16 v[76:79], a[252:255], v[4:7], 0
  s_waitcnt vmcnt(55)
  s_bitcmp1_b32 s99, 4
  s_cbranch_scc1 L_td_254
  s_bitcmp1_b32 s99, 0
  s_cbranch_scc1 L_th_253
  s_waitcnt vmcnt(5)
L_th_253:
  s_waitcnt vmcnt(6)
L_td_254:
  buffer_load_dwordx4 a[120:123], v2, s[8:11], s59 offen offset:3072 nt
  v_add_f32_dpp v47, v68, v69 row_ror:4 row_mask:0xf bank_mask:0x2
  v_add_f32_dpp v47, v70, v47 row_ror:12 row_mask:0xf bank_mask:0x2
  v_add_f32_dpp v47, v71, v47 row_ror:8 row_mask:0xf bank_mask:0x2
  v_mfma_f32_16x16x32_bf16 v[64:67], v[144:147], v[4:7], 0
  s_waitcnt vmcnt(55)
  s_mov_b32 s59, 0x1e000
  s_bitcmp1_b32 s99, 4
  s_cbranch_scc1 L_td_256
  s_bitcmp1_b32 s99, 0
  s_cbranch_scc1 L_th_255
  s_waitcnt vmcnt(5)
L_th_255:
  s_waitcnt vmcnt(5)
L_td_256:
  buffer_load_dwordx4 a[124:127], v2, s[8:11], s59 offen offset:0 nt
  v_add_f32_dpp v47, v72, v74 row_ror:8 row_mask:0xf bank_mask:0x4
  v_add_f32_dpp v47, v73, v47 row_ror:4 row_mask:0xf bank_mask:0x4
  v_add_f32_dpp v47, v75, v47 row_ror:12 row_mask:0xf bank_mask:0x4
  v_mfma_f32_16x16x32_bf16 v[68:71], v[148:151], v[4:7], 0
  s_waitcnt vmcnt(55)
  s_bitcmp1_b32 s99, 4
  s_cbranch_scc1 L_td_258
  s_bitcmp1_b32 s99, 0
  s_cbranch_scc1 L_th_257
  s_waitcnt vmcnt(5)
L_th_257:
  s_waitcnt vmcnt(6)
L_td_258:
  buffer_load_dwordx4 a[128:131], v2, s[8:11], s59 offen offset:1024 nt
  v_add_f32_dpp v47, v76, v79 row_ror:12 row_mask:0xf bank_mask:0x8
  v_add_f32_dpp v47, v77, v47 row_ror:8 row_mask:0xf bank_mask:0x8
  v_add_f32_dpp v47, v78, v47 row_ror:4 row_mask:0xf bank_mask:0x8
  v_mfma_f32_16x16x32_bf16 v[72:75], v[152:155], v[4:7], 0
  s_waitcnt vmcnt(55)
  s_bitcmp1_b32 s99, 4
  s_cbranch_scc1 L_td_260
  s_bitcmp1_b32 s99, 0
  s_cbranch_scc1 L_th_259
  s_waitcnt vmcnt(5)
L_th_259:
  s_waitcnt vmcnt(5)
L_td_260:
  buffer_load_dwordx4 a[132:135], v2, s[8:11], s59 offen offset:2048 nt
  v_add_f32_dpp v48, v65, v64 row_ror:12 row_mask:0xf bank_mask:0x1
  v_add_f32_dpp v48, v66, v48 row_ror:8 row_mask:0xf bank_mask:0x1
  v_add_f32_dpp v48, v67, v48 row_ror:4 row_mask:0xf bank_mask:0x1
  v_mfma_f32_16x16x32_bf16 v[76:79], v[156:159], v[4:7], 0
  s_waitcnt vmcnt(55)
  s_bitcmp1_b32 s99, 4
  s_cbranch_scc1 L_td_262
  s_bitcmp1_b32 s99, 0
  s_cbranch_scc1 L_th_261
  s_waitcnt vmcnt(5)
L_th_261:
  s_waitcnt vmcnt(6)
L_td_262:
  buffer_load_dwordx4 a[136:139], v2, s[8:11], s59 offen offset:3072 nt
  v_add_f32_dpp v48, v68, v69 row_ror:4 row_mask:0xf bank_mask:0x2
  v_add_f32_dpp v48, v70, v48 row_ror:12 row_mask:0xf bank_mask:0x2
  v_add_f32_dpp v48, v71, v48 row_ror:8 row_mask:0xf bank_mask:0x2
  v_mfma_f32_16x16x32_bf16 v[64:67], v[160:163], v[4:7], 0
  s_waitcnt vmcnt(55)
  s_mov_b32 s59, 0x1f000
  s_bitcmp1_b32 s99, 4
  s_cbranch_scc1 L_td_264
  s_bitcmp1_b32 s99, 0
  s_cbranch_scc1 L_th_263
  s_waitcnt vmcnt(5)
L_th_263:
  s_waitcnt vmcnt(5)
L_td_264:
  buffer_load_dwordx4 a[140:143], v2, s[8:11], s59 offen offset:0 nt
  s_waitcnt vmcnt(8)
  s_bitset0_b32 s99, 4
  v_cmp_lt_i32 vcc, 0x6d, v31
  s_bcnt1_i32_b32 s55, vcc_lo
  s_cmp_lt_u32 s55, 22
  s_cbranch_scc1 L_ck_265
  s_bitset1_b32 s99, 4
L_ck_265:
  v_and_b32 v31, 31, v1
  v_lshl_add_u32 v31, v31, 2, s92
  v_mov_b32 v30, 0x7d
  s_cmp_lg_u32 s52, 0
  s_cbranch_scc1 L_w0_266
  s_mov_b64 exec, 0x1
  buffer_store_dword v30, v1, s[48:51], s93 offen
  s_mov_b64 exec, -1
L_w0_266:
  buffer_load_dword v31, v31, s[48:51], 0 offen sc1
  v_add_f32_dpp v48, v72, v74 row_ror:8 row_mask:0xf bank_mask:0x4
  v_add_f32_dpp v48, v73, v48 row_ror:4 row_mask:0xf bank_mask:0x4
  v_add_f32_dpp v48, v75, v48 row_ror:12 row_mask:0xf bank_mask:0x4
  v_mfma_f32_16x16x32_bf16 v[68:71], v[164:167], v[4:7], 0
  s_waitcnt vmcnt(55)
  s_bitcmp1_b32 s99, 4
  s_cbranch_scc1 L_td_268
  s_bitcmp1_b32 s99, 0
  s_cbranch_scc1 L_th_267
  s_waitcnt vmcnt(5)
L_th_267:
  s_waitcnt vmcnt(6)
L_td_268:
  buffer_load_dwordx4 a[144:147], v2, s[8:11], s59 offen offset:1024 nt
  v_add_f32_dpp v48, v76, v79 row_ror:12 row_mask:0xf bank_mask:0x8
  v_add_f32_dpp v48, v77, v48 row_ror:8 row_mask:0xf bank_mask:0x8
  v_add_f32_dpp v48, v78, v48 row_ror:4 row_mask:0xf bank_mask:0x8
  v_mfma_f32_16x16x32_bf16 v[72:75], v[168:171], v[4:7], 0
  s_waitcnt vmcnt(55)
  s_bitcmp1_b32 s99, 4
  s_cbranch_scc1 L_td_270
  s_bitcmp1_b32 s99, 0
  s_cbranch_scc1 L_th_269
  s_waitcnt vmcnt(5)
L_th_269:
  s_waitcnt vmcnt(5)
L_td_270:
  buffer_load_dwordx4 a[148:151], v2, s[8:11], s59 offen offset:2048 nt
  v_add_f32_dpp v49, v65, v64 row_ror:12 row_mask:0xf bank_mask:0x1
  v_add_f32_dpp v49, v66, v49 row_ror:8 row_mask:0xf bank_mask:0x1
  v_add_f32_dpp v49, v67, v49 row_ror:4 row_mask:0xf bank_mask:0x1
  v_mfma_f32_16x16x32_bf16 v[76:79], v[172:175], v[4:7], 0
  s_waitcnt vmcnt(55)
  s_bitcmp1_b32 s99, 4
  s_cbranch_scc1 L_td_272
  s_bitcmp1_b32 s99, 0
  s_cbranch_scc1 L_th_271
  s_waitcnt vmcnt(5)
L_th_271:
  s_waitcnt vmcnt(6)
L_td_272:
  buffer_load_dwordx4 a[152:155], v2, s[8:11], s59 offen offset:3072 nt
  v_add_f32_dpp v49, v68, v69 row_ror:4 row_mask:0xf bank_mask:0x2
  v_add_f32_dpp v49, v70, v49 row_ror:12 row_mask:0xf bank_mask:0x2
  v_add_f32_dpp v49, v71, v49 row_ror:8 row_mask:0xf bank_mask:0x2
  v_mfma_f32_16x16x32_bf16 v[64:67], v[176:179], v[4:7], 0
  s_waitcnt vmcnt(55)
  s_mov_b32 s59, 0x0
  s_bitcmp1_b32 s99, 4
  s_cbranch_scc1 L_td_274
  s_bitcmp1_b32 s99, 0
  s_cbranch_scc1 L_th_273
  s_waitcnt vmcnt(5)
L_th_273:
  s_waitcnt vmcnt(5)
L_td_274:
  buffer_load_dwordx4 v[244:247], v3, s[12:15], s59 offen offset:0
  v_add_f32_dpp v49, v72, v74 row_ror:8 row_mask:0xf bank_mask:0x4
  v_add_f32_dpp v49, v73, v49 row_ror:4 row_mask:0xf bank_mask:0x4
  v_add_f32_dpp v49, v75, v49 row_ror:12 row_mask:0xf bank_mask:0x4
  v_mfma_f32_16x16x32_bf16 v[68:71], v[180:183], v[4:7], 0
  s_waitcnt vmcnt(55)
  s_bitcmp1_b32 s99, 4
  s_cbranch_scc1 L_td_276
  s_bitcmp1_b32 s99, 0
  s_cbranch_scc1 L_th_275
  s_waitcnt vmcnt(5)
L_th_275:
  s_waitcnt vmcnt(6)
L_td_276:
  buffer_load_dwordx4 v[248:251], v3, s[12:15], s59 offen offset:1024
  v_add_f32_dpp v49, v76, v79 row_ror:12 row_mask:0xf bank_mask:0x8
  v_add_f32_dpp v49, v77, v49 row_ror:8 row_mask:0xf bank_mask:0x8
  v_add_f32_dpp v49, v78, v49 row_ror:4 row_mask:0xf bank_mask:0x8
  v_mfma_f32_16x16x32_bf16 v[72:75], v[184:187], v[4:7], 0
  s_waitcnt vmcnt(55)
  s_bitcmp1_b32 s99, 4
  s_cbranch_scc1 L_td_278
  s_bitcmp1_b32 s99, 0
  s_cbranch_scc1 L_th_277
  s_waitcnt vmcnt(5)
L_th_277:
  s_waitcnt vmcnt(5)
L_td_278:
  buffer_load_dwordx4 v[252:255], v3, s[12:15], s59 offen offset:2048
  v_add_f32_dpp v50, v65, v64 row_ror:12 row_mask:0xf bank_mask:0x1
  v_add_f32_dpp v50, v66, v50 row_ror:8 row_mask:0xf bank_mask:0x1
  v_add_f32_dpp v50, v67, v50 row_ror:4 row_mask:0xf bank_mask:0x1
  v_mfma_f32_16x16x32_bf16 v[76:79], v[188:191], v[4:7], 0
  v_add_f32_dpp v50, v68, v69 row_ror:4 row_mask:0xf bank_mask:0x2
  v_add_f32_dpp v50, v70, v50 row_ror:12 row_mask:0xf bank_mask:0x2
  v_add_f32_dpp v50, v71, v50 row_ror:8 row_mask:0xf bank_mask:0x2
  v_mfma_f32_16x16x32_bf16 v[64:67], v[192:195], v[4:7], 0
  v_add_f32_dpp v50, v72, v74 row_ror:8 row_mask:0xf bank_mask:0x4
  v_add_f32_dpp v50, v73, v50 row_ror:4 row_mask:0xf bank_mask:0x4
  v_add_f32_dpp v50, v75, v50 row_ror:12 row_mask:0xf bank_mask:0x4
  v_mfma_f32_16x16x32_bf16 v[68:71], v[196:199], v[4:7], 0
  v_add_f32_dpp v50, v76, v79 row_ror:12 row_mask:0xf bank_mask:0x8
  v_add_f32_dpp v50, v77, v50 row_ror:8 row_mask:0xf bank_mask:0x8
  v_add_f32_dpp v50, v78, v50 row_ror:4 row_mask:0xf bank_mask:0x8
  v_mfma_f32_16x16x32_bf16 v[72:75], v[200:203], v[4:7], 0
  v_add_f32_dpp v51, v65, v64 row_ror:12 row_mask:0xf bank_mask:0x1
  v_add_f32_dpp v51, v66, v51 row_ror:8 row_mask:0xf bank_mask:0x1
  v_add_f32_dpp v51, v67, v51 row_ror:4 row_mask:0xf bank_mask:0x1
  v_mfma_f32_16x16x32_bf16 v[76:79], v[204:207], v[4:7], 0
  v_add_f32_dpp v51, v68, v69 row_ror:4 row_mask:0xf bank_mask:0x2
  v_add_f32_dpp v51, v70, v51 row_ror:12 row_mask:0xf bank_mask:0x2
  v_add_f32_dpp v51, v71, v51 row_ror:8 row_mask:0xf bank_mask:0x2
  v_mfma_f32_16x16x32_bf16 v[64:67], v[208:211], v[4:7], 0
  v_add_f32_dpp v51, v72, v74 row_ror:8 row_mask:0xf bank_mask:0x4
  v_add_f32_dpp v51, v73, v51 row_ror:4 row_mask:0xf bank_mask:0x4
  v_add_f32_dpp v51, v75, v51 row_ror:12 row_mask:0xf bank_mask:0x4
  v_mfma_f32_16x16x32_bf16 v[68:71], v[212:215], v[4:7], 0
  v_add_f32_dpp v51, v76, v79 row_ror:12 row_mask:0xf bank_mask:0x8
  v_add_f32_dpp v51, v77, v51 row_ror:8 row_mask:0xf bank_mask:0x8
  v_add_f32_dpp v51, v78, v51 row_ror:4 row_mask:0xf bank_mask:0x8
  v_mfma_f32_16x16x32_bf16 v[72:75], v[216:219], v[4:7], 0
  v_add_f32_dpp v52, v65, v64 row_ror:12 row_mask:0xf bank_mask:0x1
  v_add_f32_dpp v52, v66, v52 row_ror:8 row_mask:0xf bank_mask:0x1
  v_add_f32_dpp v52, v67, v52 row_ror:4 row_mask:0xf bank_mask:0x1
  v_mfma_f32_16x16x32_bf16 v[76:79], v[220:223], v[4:7], 0
  v_add_f32_dpp v52, v68, v69 row_ror:4 row_mask:0xf bank_mask:0x2
  v_add_f32_dpp v52, v70, v52 row_ror:12 row_mask:0xf bank_mask:0x2
  v_add_f32_dpp v52, v71, v52 row_ror:8 row_mask:0xf bank_mask:0x2
  v_mfma_f32_16x16x32_bf16 v[64:67], v[224:227], v[4:7], 0
  v_add_f32_dpp v52, v72, v74 row_ror:8 row_mask:0xf bank_mask:0x4
  v_add_f32_dpp v52, v73, v52 row_ror:4 row_mask:0xf bank_mask:0x4
  v_add_f32_dpp v52, v75, v52 row_ror:12 row_mask:0xf bank_mask:0x4
  s_waitcnt vmcnt(55)
  v_mfma_f32_16x16x32_bf16 v[68:71], v[228:231], v[4:7], 0
  v_add_f32_dpp v52, v76, v79 row_ror:12 row_mask:0xf bank_mask:0x8
  v_add_f32_dpp v52, v77, v52 row_ror:8 row_mask:0xf bank_mask:0x8
  v_add_f32_dpp v52, v78, v52 row_ror:4 row_mask:0xf bank_mask:0x8
  s_waitcnt vmcnt(46)
  v_mfma_f32_16x16x32_bf16 v[72:75], v[232:235], v[4:7], 0
  v_add_f32_dpp v53, v65, v64 row_ror:12 row_mask:0xf bank_mask:0x1
  v_add_f32_dpp v53, v66, v53 row_ror:8 row_mask:0xf bank_mask:0x1
  v_add_f32_dpp v53, v67, v53 row_ror:4 row_mask:0xf bank_mask:0x1
  s_waitcnt vmcnt(45)
  v_mfma_f32_16x16x32_bf16 v[76:79], v[236:239], v[4:7], 0
  v_add_f32_dpp v53, v68, v69 row_ror:4 row_mask:0xf bank_mask:0x2
  v_add_f32_dpp v53, v70, v53 row_ror:12 row_mask:0xf bank_mask:0x2
  v_add_f32_dpp v53, v71, v53 row_ror:8 row_mask:0xf bank_mask:0x2
  s_waitcnt vmcnt(42)
  v_mfma_f32_16x16x32_bf16 v[64:67], v[240:243], v[4:7], 0
  v_add_f32_dpp v53, v72, v74 row_ror:8 row_mask:0xf bank_mask:0x4
  v_add_f32_dpp v53, v73, v53 row_ror:4 row_mask:0xf bank_mask:0x4
  v_add_f32_dpp v53, v75, v53 row_ror:12 row_mask:0xf bank_mask:0x4
  s_waitcnt vmcnt(41)
  v_mfma_f32_16x16x32_bf16 v[68:71], a[0:3], v[4:7], 0
  v_add_f32_dpp v53, v76, v79 row_ror:12 row_mask:0xf bank_mask:0x8
  v_add_f32_dpp v53, v77, v53 row_ror:8 row_mask:0xf bank_mask:0x8
  v_add_f32_dpp v53, v78, v53 row_ror:4 row_mask:0xf bank_mask:0x8
  s_waitcnt vmcnt(40)
  v_mfma_f32_16x16x32_bf16 v[72:75], a[4:7], v[4:7], 0
  v_add_f32_dpp v54, v65, v64 row_ror:12 row_mask:0xf bank_mask:0x1
  v_add_f32_dpp v54, v66, v54 row_ror:8 row_mask:0xf bank_mask:0x1
  v_add_f32_dpp v54, v67, v54 row_ror:4 row_mask:0xf bank_mask:0x1
  s_waitcnt vmcnt(39)
  v_mfma_f32_16x16x32_bf16 v[76:79], a[8:11], v[4:7], 0
  v_add_f32_dpp v54, v68, v69 row_ror:4 row_mask:0xf bank_mask:0x2
  v_add_f32_dpp v54, v70, v54 row_ror:12 row_mask:0xf bank_mask:0x2
  v_add_f32_dpp v54, v71, v54 row_ror:8 row_mask:0xf bank_mask:0x2
  s_waitcnt vmcnt(38)
  v_mfma_f32_16x16x32_bf16 v[64:67], a[12:15], v[4:7], 0
  v_add_f32_dpp v54, v72, v74 row_ror:8 row_mask:0xf bank_mask:0x4
  v_add_f32_dpp v54, v73, v54 row_ror:4 row_mask:0xf bank_mask:0x4
  v_add_f32_dpp v54, v75, v54 row_ror:12 row_mask:0xf bank_mask:0x4
  s_waitcnt vmcnt(37)
  v_mfma_f32_16x16x32_bf16 v[68:71], a[16:19], v[4:7], 0
  v_add_f32_dpp v54, v76, v79 row_ror:12 row_mask:0xf bank_mask:0x8
  v_add_f32_dpp v54, v77, v54 row_ror:8 row_mask:0xf bank_mask:0x8
  v_add_f32_dpp v54, v78, v54 row_ror:4 row_mask:0xf bank_mask:0x8
  s_waitcnt vmcnt(36)
  v_mfma_f32_16x16x32_bf16 v[72:75], a[20:23], v[4:7], 0
  v_add_f32_dpp v55, v65, v64 row_ror:12 row_mask:0xf bank_mask:0x1
  v_add_f32_dpp v55, v66, v55 row_ror:8 row_mask:0xf bank_mask:0x1
  v_add_f32_dpp v55, v67, v55 row_ror:4 row_mask:0xf bank_mask:0x1
  s_waitcnt vmcnt(35)
  v_mfma_f32_16x16x32_bf16 v[76:79], a[24:27], v[4:7], 0
  v_add_f32_dpp v55, v68, v69 row_ror:4 row_mask:0xf bank_mask:0x2
  v_add_f32_dpp v55, v70, v55 row_ror:12 row_mask:0xf bank_mask:0x2
  v_add_f32_dpp v55, v71, v55 row_ror:8 row_mask:0xf bank_mask:0x2
  s_waitcnt vmcnt(34)
  v_mfma_f32_16x16x32_bf16 v[64:67], a[28:31], v[4:7], 0
  v_add_f32_dpp v55, v72, v74 row_ror:8 row_mask:0xf bank_mask:0x4
  v_add_f32_dpp v55, v73, v55 row_ror:4 row_mask:0xf bank_mask:0x4
  v_add_f32_dpp v55, v75, v55 row_ror:12 row_mask:0xf bank_mask:0x4
  s_waitcnt vmcnt(33)
  v_mfma_f32_16x16x32_bf16 v[68:71], a[32:35], v[4:7], 0
  v_add_f32_dpp v55, v76, v79 row_ror:12 row_mask:0xf bank_mask:0x8
  v_add_f32_dpp v55, v77, v55 row_ror:8 row_mask:0xf bank_mask:0x8
  v_add_f32_dpp v55, v78, v55 row_ror:4 row_mask:0xf bank_mask:0x8
  s_waitcnt vmcnt(32)
  v_mfma_f32_16x16x32_bf16 v[72:75], a[36:39], v[4:7], 0
  v_add_f32_dpp v56, v65, v64 row_ror:12 row_mask:0xf bank_mask:0x1
  v_add_f32_dpp v56, v66, v56 row_ror:8 row_mask:0xf bank_mask:0x1
  v_add_f32_dpp v56, v67, v56 row_ror:4 row_mask:0xf bank_mask:0x1
  s_waitcnt vmcnt(31)
  v_mfma_f32_16x16x32_bf16 v[76:79], a[40:43], v[4:7], 0
  v_add_f32_dpp v56, v68, v69 row_ror:4 row_mask:0xf bank_mask:0x2
  v_add_f32_dpp v56, v70, v56 row_ror:12 row_mask:0xf bank_mask:0x2
  v_add_f32_dpp v56, v71, v56 row_ror:8 row_mask:0xf bank_mask:0x2
  s_waitcnt vmcnt(30)
  v_mfma_f32_16x16x32_bf16 v[64:67], a[44:47], v[4:7], 0
  v_add_f32_dpp v56, v72, v74 row_ror:8 row_mask:0xf bank_mask:0x4
  v_add_f32_dpp v56, v73, v56 row_ror:4 row_mask:0xf bank_mask:0x4
  v_add_f32_dpp v56, v75, v56 row_ror:12 row_mask:0xf bank_mask:0x4
  s_waitcnt vmcnt(29)
  v_mfma_f32_16x16x32_bf16 v[68:71], a[48:51], v[4:7], 0
  v_add_f32_dpp v56, v76, v79 row_ror:12 row_mask:0xf bank_mask:0x8
  v_add_f32_dpp v56, v77, v56 row_ror:8 row_mask:0xf bank_mask:0x8
  v_add_f32_dpp v56, v78, v56 row_ror:4 row_mask:0xf bank_mask:0x8
  s_waitcnt vmcnt(28)
  v_mfma_f32_16x16x32_bf16 v[72:75], a[52:55], v[4:7], 0
  v_add_f32_dpp v57, v65, v64 row_ror:12 row_mask:0xf bank_mask:0x1
  v_add_f32_dpp v57, v66, v57 row_ror:8 row_mask:0xf bank_mask:0x1
  v_add_f32_dpp v57, v67, v57 row_ror:4 row_mask:0xf bank_mask:0x1
  s_waitcnt vmcnt(27)
  v_mfma_f32_16x16x32_bf16 v[76:79], a[56:59], v[4:7], 0
  v_add_f32_dpp v57, v68, v69 row_ror:4 row_mask:0xf bank_mask:0x2
  v_add_f32_dpp v57, v70, v57 row_ror:12 row_mask:0xf bank_mask:0x2
  v_add_f32_dpp v57, v71, v57 row_ror:8 row_mask:0xf bank_mask:0x2
  s_waitcnt vmcnt(26)
  v_mfma_f32_16x16x32_bf16 v[64:67], a[60:63], v[4:7], 0
  v_add_f32_dpp v57, v72, v74 row_ror:8 row_mask:0xf bank_mask:0x4
  v_add_f32_dpp v57, v73, v57 row_ror:4 row_mask:0xf bank_mask:0x4
  v_add_f32_dpp v57, v75, v57 row_ror:12 row_mask:0xf bank_mask:0x4
  s_waitcnt vmcnt(25)
  v_mfma_f32_16x16x32_bf16 v[68:71], a[64:67], v[4:7], 0
  v_add_f32_dpp v57, v76, v79 row_ror:12 row_mask:0xf bank_mask:0x8
  v_add_f32_dpp v57, v77, v57 row_ror:8 row_mask:0xf bank_mask:0x8
  v_add_f32_dpp v57, v78, v57 row_ror:4 row_mask:0xf bank_mask:0x8
  s_waitcnt vmcnt(24)
  v_mfma_f32_16x16x32_bf16 v[72:75], a[68:71], v[4:7], 0
  v_add_f32_dpp v58, v65, v64 row_ror:12 row_mask:0xf bank_mask:0x1
  v_add_f32_dpp v58, v66, v58 row_ror:8 row_mask:0xf bank_mask:0x1
  v_add_f32_dpp v58, v67, v58 row_ror:4 row_mask:0xf bank_mask:0x1
  s_waitcnt vmcnt(23)
  v_mfma_f32_16x16x32_bf16 v[76:79], a[72:75], v[4:7], 0
  v_add_f32_dpp v58, v68, v69 row_ror:4 row_mask:0xf bank_mask:0x2
  v_add_f32_dpp v58, v70, v58 row_ror:12 row_mask:0xf bank_mask:0x2
  v_add_f32_dpp v58, v71, v58 row_ror:8 row_mask:0xf bank_mask:0x2
  s_waitcnt vmcnt(22)
  v_mfma_f32_16x16x32_bf16 v[64:67], a[76:79], v[4:7], 0
  v_add_f32_dpp v58, v72, v74 row_ror:8 row_mask:0xf bank_mask:0x4
  v_add_f32_dpp v58, v73, v58 row_ror:4 row_mask:0xf bank_mask:0x4
  v_add_f32_dpp v58, v75, v58 row_ror:12 row_mask:0xf bank_mask:0x4
  s_waitcnt vmcnt(21)
  v_mfma_f32_16x16x32_bf16 v[68:71], a[80:83], v[4:7], 0
  v_add_f32_dpp v58, v76, v79 row_ror:12 row_mask:0xf bank_mask:0x8
  v_add_f32_dpp v58, v77, v58 row_ror:8 row_mask:0xf bank_mask:0x8
  v_add_f32_dpp v58, v78, v58 row_ror:4 row_mask:0xf bank_mask:0x8
  s_waitcnt vmcnt(20)
  v_mfma_f32_16x16x32_bf16 v[72:75], a[84:87], v[4:7], 0
  v_add_f32_dpp v59, v65, v64 row_ror:12 row_mask:0xf bank_mask:0x1
  v_add_f32_dpp v59, v66, v59 row_ror:8 row_mask:0xf bank_mask:0x1
  v_add_f32_dpp v59, v67, v59 row_ror:4 row_mask:0xf bank_mask:0x1
  s_waitcnt vmcnt(19)
  v_mfma_f32_16x16x32_bf16 v[76:79], a[88:91], v[4:7], 0
  v_add_f32_dpp v59, v68, v69 row_ror:4 row_mask:0xf bank_mask:0x2
  v_add_f32_dpp v59, v70, v59 row_ror:12 row_mask:0xf bank_mask:0x2
  v_add_f32_dpp v59, v71, v59 row_ror:8 row_mask:0xf bank_mask:0x2
  s_waitcnt vmcnt(18)
  v_mfma_f32_16x16x32_bf16 v[64:67], a[92:95], v[4:7], 0
  v_add_f32_dpp v59, v72, v74 row_ror:8 row_mask:0xf bank_mask:0x4
  v_add_f32_dpp v59, v73, v59 row_ror:4 row_mask:0xf bank_mask:0x4
  v_add_f32_dpp v59, v75, v59 row_ror:12 row_mask:0xf bank_mask:0x4
  s_waitcnt vmcnt(17)
  v_mfma_f32_16x16x32_bf16 v[68:71], a[96:99], v[4:7], 0
  v_add_f32_dpp v59, v76, v79 row_ror:12 row_mask:0xf bank_mask:0x8
  v_add_f32_dpp v59, v77, v59 row_ror:8 row_mask:0xf bank_mask:0x8
  v_add_f32_dpp v59, v78, v59 row_ror:4 row_mask:0xf bank_mask:0x8
  s_waitcnt vmcnt(16)
  v_mfma_f32_16x16x32_bf16 v[72:75], a[100:103], v[4:7], 0
  v_add_f32_dpp v60, v65, v64 row_ror:12 row_mask:0xf bank_mask:0x1
  v_add_f32_dpp v60, v66, v60 row_ror:8 row_mask:0xf bank_mask:0x1
  v_add_f32_dpp v60, v67, v60 row_ror:4 row_mask:0xf bank_mask:0x1
  s_waitcnt vmcnt(15)
  v_mfma_f32_16x16x32_bf16 v[76:79], a[104:107], v[4:7], 0
  v_add_f32_dpp v60, v68, v69 row_ror:4 row_mask:0xf bank_mask:0x2
  v_add_f32_dpp v60, v70, v60 row_ror:12 row_mask:0xf bank_mask:0x2
  v_add_f32_dpp v60, v71, v60 row_ror:8 row_mask:0xf bank_mask:0x2
  s_waitcnt vmcnt(14)
  v_mfma_f32_16x16x32_bf16 v[64:67], a[108:111], v[4:7], 0
  s_bitcmp1_b32 s99, 4
  s_cbranch_scc1 L_td_280
  s_bitcmp1_b32 s99, 0
  s_cbranch_scc1 L_th_279
  s_waitcnt vmcnt(5)
L_th_279:
  s_waitcnt vmcnt(6)
L_td_280:
  buffer_load_dwordx4 v[80:83], v3, s[12:15], s59 offen offset:3072
  s_mov_b32 s59, 0x1000
  s_bitcmp1_b32 s99, 4
  s_cbranch_scc1 L_td_282
  s_bitcmp1_b32 s99, 0
  s_cbranch_scc1 L_th_281
  s_waitcnt vmcnt(5)
L_th_281:
  s_waitcnt vmcnt(5)
L_td_282:
  buffer_load_dwordx4 v[84:87], v3, s[12:15], s59 offen offset:0
  s_waitcnt vmcnt(8)
  s_bitset0_b32 s99, 4
  v_cmp_lt_i32 vcc, 0x75, v31
  s_bcnt1_i32_b32 s55, vcc_lo
  s_cmp_lt_u32 s55, 22
  s_cbranch_scc1 L_ck_283
  s_bitset1_b32 s99, 4
L_ck_283:
  v_and_b32 v31, 31, v1
  v_lshl_add_u32 v31, v31, 2, s92
  v_mov_b32 v30, 0x85
  s_cmp_lg_u32 s52, 0
  s_cbranch_scc1 L_w0_284
  s_mov_b64 exec, 0x1
  buffer_store_dword v30, v1, s[48:51], s93 offen
  s_mov_b64 exec, -1
L_w0_284:
  buffer_load_dword v31, v31, s[48:51], 0 offen sc1
  v_add_f32_dpp v60, v72, v74 row_ror:8 row_mask:0xf bank_mask:0x4
  v_add_f32_dpp v60, v73, v60 row_ror:4 row_mask:0xf bank_mask:0x4
  v_add_f32_dpp v60, v75, v60 row_ror:12 row_mask:0xf bank_mask:0x4
  s_waitcnt vmcnt(15)
  v_mfma_f32_16x16x32_bf16 v[68:71], a[112:115], v[4:7], 0
  v_add_f32_dpp v60, v76, v79 row_ror:12 row_mask:0xf bank_mask:0x8
  v_add_f32_dpp v60, v77, v60 row_ror:8 row_mask:0xf bank_mask:0x8
  v_add_f32_dpp v60, v78, v60 row_ror:4 row_mask:0xf bank_mask:0x8
  s_waitcnt vmcnt(14)
  v_mfma_f32_16x16x32_bf16 v[72:75], a[116:119], v[4:7], 0
  v_add_f32_dpp v61, v65, v64 row_ror:12 row_mask:0xf bank_mask:0x1
  v_add_f32_dpp v61, v66, v61 row_ror:8 row_mask:0xf bank_mask:0x1
  v_add_f32_dpp v61, v67, v61 row_ror:4 row_mask:0xf bank_mask:0x1
  s_waitcnt vmcnt(13)
  v_mfma_f32_16x16x32_bf16 v[76:79], a[120:123], v[4:7], 0
  v_add_f32_dpp v61, v68, v69 row_ror:4 row_mask:0xf bank_mask:0x2
  v_add_f32_dpp v61, v70, v61 row_ror:12 row_mask:0xf bank_mask:0x2
  v_add_f32_dpp v61, v71, v61 row_ror:8 row_mask:0xf bank_mask:0x2
  s_waitcnt vmcnt(12)
  v_mfma_f32_16x16x32_bf16 v[64:67], a[124:127], v[4:7], 0
  v_add_f32_dpp v61, v72, v74 row_ror:8 row_mask:0xf bank_mask:0x4
  v_add_f32_dpp v61, v73, v61 row_ror:4 row_mask:0xf bank_mask:0x4
  v_add_f32_dpp v61, v75, v61 row_ror:12 row_mask:0xf bank_mask:0x4
  s_waitcnt vmcnt(11)
  v_mfma_f32_16x16x32_bf16 v[68:71], a[128:131], v[4:7], 0
  v_add_f32_dpp v61, v76, v79 row_ror:12 row_mask:0xf bank_mask:0x8
  v_add_f32_dpp v61, v77, v61 row_ror:8 row_mask:0xf bank_mask:0x8
  v_add_f32_dpp v61, v78, v61 row_ror:4 row_mask:0xf bank_mask:0x8
  s_waitcnt vmcnt(10)
  v_mfma_f32_16x16x32_bf16 v[72:75], a[132:135], v[4:7], 0
  v_add_f32_dpp v62, v65, v64 row_ror:12 row_mask:0xf bank_mask:0x1
  v_add_f32_dpp v62, v66, v62 row_ror:8 row_mask:0xf bank_mask:0x1
  v_add_f32_dpp v62, v67, v62 row_ror:4 row_mask:0xf bank_mask:0x1
  s_waitcnt vmcnt(9)
  v_mfma_f32_16x16x32_bf16 v[76:79], a[136:139], v[4:7], 0
  v_add_f32_dpp v62, v68, v69 row_ror:4 row_mask:0xf bank_mask:0x2
  v_add_f32_dpp v62, v70, v62 row_ror:12 row_mask:0xf bank_mask:0x2
  v_add_f32_dpp v62, v71, v62 row_ror:8 row_mask:0xf bank_mask:0x2
  s_waitcnt vmcnt(8)
  v_mfma_f32_16x16x32_bf16 v[64:67], a[140:143], v[4:7], 0
  v_add_f32_dpp v62, v72, v74 row_ror:8 row_mask:0xf bank_mask:0x4
  v_add_f32_dpp v62, v73, v62 row_ror:4 row_mask:0xf bank_mask:0x4
  v_add_f32_dpp v62, v75, v62 row_ror:12 row_mask:0xf bank_mask:0x4
  s_waitcnt vmcnt(7)
  v_mfma_f32_16x16x32_bf16 v[68:71], a[144:147], v[4:7], 0
  v_add_f32_dpp v62, v76, v79 row_ror:12 row_mask:0xf bank_mask:0x8
  v_add_f32_dpp v62, v77, v62 row_ror:8 row_mask:0xf bank_mask:0x8
  v_add_f32_dpp v62, v78, v62 row_ror:4 row_mask:0xf bank_mask:0x8
  s_waitcnt vmcnt(6)
  v_mfma_f32_16x16x32_bf16 v[72:75], a[148:151], v[4:7], 0
  v_add_f32_dpp v63, v65, v64 row_ror:12 row_mask:0xf bank_mask:0x1
  v_add_f32_dpp v63, v66, v63 row_ror:8 row_mask:0xf bank_mask:0x1
  v_add_f32_dpp v63, v67, v63 row_ror:4 row_mask:0xf bank_mask:0x1
  s_waitcnt vmcnt(5)
  v_mfma_f32_16x16x32_bf16 v[76:79], a[152:155], v[4:7], 0
  v_add_f32_dpp v63, v68, v69 row_ror:4 row_mask:0xf bank_mask:0x2
  v_add_f32_dpp v63, v70, v63 row_ror:12 row_mask:0xf bank_mask:0x2
  v_add_f32_dpp v63, v71, v63 row_ror:8 row_mask:0xf bank_mask:0x2
  s_nop 3
  v_add_f32_dpp v63, v72, v74 row_ror:8 row_mask:0xf bank_mask:0x4
  v_add_f32_dpp v63, v73, v63 row_ror:4 row_mask:0xf bank_mask:0x4
  v_add_f32_dpp v63, v75, v63 row_ror:12 row_mask:0xf bank_mask:0x4
  s_nop 3
  v_add_f32_dpp v63, v76, v79 row_ror:12 row_mask:0xf bank_mask:0x8
  v_add_f32_dpp v63, v77, v63 row_ror:8 row_mask:0xf bank_mask:0x8
  v_add_f32_dpp v63, v78, v63 row_ror:4 row_mask:0xf bank_mask:0x8
  s_bitcmp1_b32 s99, 4
  s_cbranch_scc1 L_td_286
  s_bitcmp1_b32 s99, 0
  s_cbranch_scc1 L_th_285
  s_waitcnt vmcnt(5)
L_th_285:
  s_waitcnt vmcnt(6)
L_td_286:
  buffer_load_dwordx4 v[64:67], v3, s[12:15], s59 offen offset:1024
  s_bitcmp1_b32 s99, 4
  s_cbranch_scc1 L_td_288
  s_bitcmp1_b32 s99, 0
  s_cbranch_scc1 L_th_287
  s_waitcnt vmcnt(5)
L_th_287:
  s_waitcnt vmcnt(5)
L_td_288:
  buffer_load_dwordx4 v[68:71], v3, s[12:15], s59 offen offset:2048
  s_bitcmp1_b32 s99, 4
  s_cbranch_scc1 L_td_290
  s_bitcmp1_b32 s99, 0
  s_cbranch_scc1 L_th_289
  s_waitcnt vmcnt(5)
L_th_289:
  s_waitcnt vmcnt(6)
L_td_290:
  buffer_load_dwordx4 v[72:75], v3, s[12:15], s59 offen offset:3072
  s_mov_b32 s59, 0x2000
  s_bitcmp1_b32 s99, 4
  s_cbranch_scc1 L_td_292
  s_bitcmp1_b32 s99, 0
  s_cbranch_scc1 L_th_291
  s_waitcnt vmcnt(5)
L_th_291:
  s_waitcnt vmcnt(5)
L_td_292:
  buffer_load_dwordx4 v[76:79], v3, s[12:15], s59 offen offset:0
  v_max3_f32 v26, v32, v33, v34
  v_max3_f32 v26, v26, v35, v36
  v_max3_f32 v26, v26, v37, v38
  v_max3_f32 v26, v26, v39, v40
  v_max3_f32 v26, v26, v41, v42
  v_max3_f32 v26, v26, v43, v44
  v_max3_f32 v26, v26, v45, v46
  v_max3_f32 v26, v26, v47, v48
  v_max3_f32 v26, v26, v49, v50
  v_max3_f32 v26, v26, v51, v52
  v_max3_f32 v26, v26, v53, v54
  v_max3_f32 v26, v26, v55, v56
  v_max3_f32 v26, v26, v57, v58
  v_max3_f32 v26, v26, v59, v60
  v_max3_f32 v26, v26, v61, v62
  v_max_f32 v26, v26, v63
  s_nop 1
  v_max_f32_dpp v26, v26, v26 row_ror:8 row_mask:0xf bank_mask:0xf
  s_nop 1
  v_max_f32_dpp v26, v26, v26 row_ror:4 row_mask:0xf bank_mask:0xf
  v_mov_b32 v28, v26
  s_nop 1
  v_permlane32_swap_b32 v26, v28
  s_nop 0
  v_max_f32 v26, v26, v28
  v_mov_b32 v28, v26
  s_nop 1
  v_permlane16_swap_b32 v26, v28
  s_nop 0
  v_max_f32 v26, v26, v28
  v_mul_f32 v28, s96, v26
  v_mov_b32 v27, 0
  v_fma_f32 v32, v32, s96, -v28
  v_fma_f32 v33, v33, s96, -v28
  v_fma_f32 v34, v34, s96, -v28
  v_fma_f32 v35, v35, s96, -v28
  v_fma_f32 v36, v36, s96, -v28
  v_fma_f32 v37, v37, s96, -v28
  v_fma_f32 v38, v38, s96, -v28
  v_fma_f32 v39, v39, s96, -v28
  v_fma_f32 v40, v40, s96, -v28
  v_fma_f32 v41, v41, s96, -v28
  v_fma_f32 v42, v42, s96, -v28
  v_fma_f32 v43, v43, s96, -v28
  v_fma_f32 v44, v44, s96, -v28
  v_fma_f32 v45, v45, s96, -v28
  v_fma_f32 v46, v46, s96, -v28
  v_fma_f32 v47, v47, s96, -v28
  v_fma_f32 v48, v48, s96, -v28
  v_fma_f32 v49, v49, s96, -v28
  v_fma_f32 v50, v50, s96, -v28
  v_fma_f32 v51, v51, s96, -v28
  v_fma_f32 v52, v52, s96, -v28
  v_fma_f32 v53, v53, s96, -v28
  v_fma_f32 v54, v54, s96, -v28
  v_fma_f32 v55, v55, s96, -v28
  v_fma_f32 v56, v56, s96, -v28
  v_fma_f32 v57, v57, s96, -v28
  v_fma_f32 v58, v58, s96, -v28
  v_fma_f32 v59, v59, s96, -v28
  v_fma_f32 v60, v60, s96, -v28
  v_fma_f32 v61, v61, s96, -v28
  v_fma_f32 v62, v62, s96, -v28
  v_fma_f32 v63, v63, s96, -v28
  v_exp_f32 v32, v32
  v_exp_f32 v33, v33
  v_exp_f32 v34, v34
  v_exp_f32 v35, v35
  v_exp_f32 v36, v36
  v_exp_f32 v37, v37
  v_exp_f32 v38, v38
  v_exp_f32 v39, v39
  v_exp_f32 v40, v40
  v_exp_f32 v41, v41
  v_exp_f32 v42, v42
  v_exp_f32 v43, v43
  v_exp_f32 v44, v44
  v_exp_f32 v45, v45
  v_exp_f32 v46, v46
  v_exp_f32 v47, v47
  v_exp_f32 v48, v48
  v_exp_f32 v49, v49
  v_exp_f32 v50, v50
  v_exp_f32 v51, v51
  v_exp_f32 v52, v52
  v_exp_f32 v53, v53
  v_exp_f32 v54, v54
  v_exp_f32 v55, v55
  v_exp_f32 v56, v56
  v_exp_f32 v57, v57
  v_exp_f32 v58, v58
  v_exp_f32 v59, v59
  v_exp_f32 v60, v60
  v_exp_f32 v61, v61
  v_exp_f32 v62, v62
  v_exp_f32 v63, v63
  v_add_f32 v27, v27, v32
  v_cvt_pk_bf16_f32 v32, v32, v32
  v_add_f32 v27, v27, v33
  v_cvt_pk_bf16_f32 v33, v33, v33
  v_add_f32 v27, v27, v34
  v_cvt_pk_bf16_f32 v34, v34, v34
  v_add_f32 v27, v27, v35
  v_cvt_pk_bf16_f32 v35, v35, v35
  v_add_f32 v27, v27, v36
  v_cvt_pk_bf16_f32 v36, v36, v36
  v_add_f32 v27, v27, v37
  v_cvt_pk_bf16_f32 v37, v37, v37
  v_add_f32 v27, v27, v38
  v_cvt_pk_bf16_f32 v38, v38, v38
  v_add_f32 v27, v27, v39
  v_cvt_pk_bf16_f32 v39, v39, v39
  v_add_f32 v27, v27, v40
  v_cvt_pk_bf16_f32 v40, v40, v40
  v_add_f32 v27, v27, v41
  v_cvt_pk_bf16_f32 v41, v41, v41
  v_add_f32 v27, v27, v42
  v_cvt_pk_bf16_f32 v42, v42, v42
  v_add_f32 v27, v27, v43
  v_cvt_pk_bf16_f32 v43, v43, v43
  v_add_f32 v27, v27, v44
  v_cvt_pk_bf16_f32 v44, v44, v44
  v_add_f32 v27, v27, v45
  v_cvt_pk_bf16_f32 v45, v45, v45
  v_add_f32 v27, v27, v46
  v_cvt_pk_bf16_f32 v46, v46, v46
  v_add_f32 v27, v27, v47
  v_cvt_pk_bf16_f32 v47, v47, v47
  v_add_f32 v27, v27, v48
  v_cvt_pk_bf16_f32 v48, v48, v48
  v_add_f32 v27, v27, v49
  v_cvt_pk_bf16_f32 v49, v49, v49
  v_add_f32 v27, v27, v50
  v_cvt_pk_bf16_f32 v50, v50, v50
  v_add_f32 v27, v27, v51
  v_cvt_pk_bf16_f32 v51, v51, v51
  v_add_f32 v27, v27, v52
  v_cvt_pk_bf16_f32 v52, v52, v52
  v_add_f32 v27, v27, v53
  v_cvt_pk_bf16_f32 v53, v53, v53
  v_add_f32 v27, v27, v54
  v_cvt_pk_bf16_f32 v54, v54, v54
  v_add_f32 v27, v27, v55
  v_cvt_pk_bf16_f32 v55, v55, v55
  v_add_f32 v27, v27, v56
  v_cvt_pk_bf16_f32 v56, v56, v56
  v_add_f32 v27, v27, v57
  v_cvt_pk_bf16_f32 v57, v57, v57
  v_add_f32 v27, v27, v58
  v_cvt_pk_bf16_f32 v58, v58, v58
  v_add_f32 v27, v27, v59
  v_cvt_pk_bf16_f32 v59, v59, v59
  v_add_f32 v27, v27, v60
  v_cvt_pk_bf16_f32 v60, v60, v60
  v_add_f32 v27, v27, v61
  v_cvt_pk_bf16_f32 v61, v61, v61
  v_add_f32 v27, v27, v62
  v_cvt_pk_bf16_f32 v62, v62, v62
  v_add_f32 v27, v27, v63
  v_cvt_pk_bf16_f32 v63, v63, v63
  ds_bpermute_b32 v32, v24, v32
  ds_bpermute_b32 v33, v24, v33
  ds_bpermute_b32 v34, v24, v34
  ds_bpermute_b32 v35, v24, v35
  ds_bpermute_b32 v36, v24, v36
  ds_bpermute_b32 v37, v24, v37
  ds_bpermute_b32 v38, v24, v38
  ds_bpermute_b32 v39, v24, v39
  s_waitcnt lgkmcnt(0)
  ds_bpermute_b32 v40, v24, v40
  ds_bpermute_b32 v41, v24, v41
  ds_bpermute_b32 v42, v24, v42
  ds_bpermute_b32 v43, v24, v43
  ds_bpermute_b32 v44, v24, v44
  ds_bpermute_b32 v45, v24, v45
  ds_bpermute_b32 v46, v24, v46
  ds_bpermute_b32 v47, v24, v47
  s_waitcnt lgkmcnt(0)
  ds_bpermute_b32 v48, v24, v48
  ds_bpermute_b32 v49, v24, v49
  ds_bpermute_b32 v50, v24, v50
  ds_bpermute_b32 v51, v24, v51
  ds_bpermute_b32 v52, v24, v52
  ds_bpermute_b32 v53, v24, v53
  ds_bpermute_b32 v54, v24, v54
  ds_bpermute_b32 v55, v24, v55
  s_waitcnt lgkmcnt(0)
  ds_bpermute_b32 v56, v24, v56
  ds_bpermute_b32 v57, v24, v57
  ds_bpermute_b32 v58, v24, v58
  ds_bpermute_b32 v59, v24, v59
  ds_bpermute_b32 v60, v24, v60
  ds_bpermute_b32 v61, v24, v61
  ds_bpermute_b32 v62, v24, v62
  ds_bpermute_b32 v63, v24, v63
  s_waitcnt lgkmcnt(0)
  s_nop 1
  v_add_f32_dpp v27, v27, v27 row_ror:8 row_mask:0xf bank_mask:0xf
  s_nop 1
  v_add_f32_dpp v27, v27, v27 row_ror:4 row_mask:0xf bank_mask:0xf
  v_mov_b32 v28, v27
  s_nop 1
  v_permlane32_swap_b32 v27, v28
  s_nop 0
  v_add_f32 v27, v27, v28
  v_mov_b32 v28, v27
  s_nop 1
  v_permlane16_swap_b32 v27, v28
  s_nop 0
  v_add_f32 v27, v27, v28
  v_min_u32 v26, -2, v26
  v_min_u32 v27, -2, v27
  v_lshlrev_b32 v28, 10, v1
  s_lshl_b32 s55, s53, 12
  s_lshl_b32 s56, s54, 5
  s_add_u32 s55, s55, s56
  s_lshl_b32 s56, s52, 3
  s_add_u32 s55, s55, s56
  s_add_u32 s55, s55, 0x1c000
  s_mov_b64 exec, 0xf
  buffer_store_dwordx2 v[26:27], v28, s[48:51], s55 offen sc1
  s_mov_b64 exec, -1
  v_mov_b32 v8, 0
  v_mov_b32 v9, 0
  v_mov_b32 v10, 0
  v_mov_b32 v11, 0
  v_mov_b32 v12, 0
  v_mov_b32 v13, 0
  v_mov_b32 v14, 0
  v_mov_b32 v15, 0
  s_waitcnt lgkmcnt(0)
  v_and_b32_dpp v16, v32, v20 quad_perm:[0,0,0,0] row_mask:0xf bank_mask:0xf
  v_and_b32_dpp v17, v32, v21 quad_perm:[0,0,0,0] row_mask:0xf bank_mask:0xf
  v_and_b32_dpp v18, v32, v20 quad_perm:[1,1,1,1] row_mask:0xf bank_mask:0xf
  v_and_b32_dpp v19, v32, v21 quad_perm:[1,1,1,1] row_mask:0xf bank_mask:0xf
  s_waitcnt vmcnt(8)
  v_mfma_f32_16x16x16_bf16 v[8:11], v[244:245], v[16:17], v[8:11]
  v_mfma_f32_16x16x16_bf16 v[12:15], v[246:247], v[16:17], v[12:15]
  s_bitcmp1_b32 s99, 4
  s_cbranch_scc1 L_td_294
  s_bitcmp1_b32 s99, 0
  s_cbranch_scc1 L_th_293
  s_waitcnt vmcnt(5)
L_th_293:
  s_waitcnt vmcnt(6)
L_td_294:
  buffer_load_dwordx4 v[244:247], v3, s[12:15], s59 offen offset:1024
  v_and_b32_dpp v16, v32, v20 quad_perm:[2,2,2,2] row_mask:0xf bank_mask:0xf
  v_and_b32_dpp v17, v32, v21 quad_perm:[2,2,2,2] row_mask:0xf bank_mask:0xf
  s_waitcnt vmcnt(8)
  v_mfma_f32_16x16x16_bf16 v[8:11], v[248:249], v[18:19], v[8:11]
  v_mfma_f32_16x16x16_bf16 v[12:15], v[250:251], v[18:19], v[12:15]
  s_bitcmp1_b32 s99, 4
  s_cbranch_scc1 L_td_296
  s_bitcmp1_b32 s99, 0
  s_cbranch_scc1 L_th_295
  s_waitcnt vmcnt(5)
L_th_295:
  s_waitcnt vmcnt(5)
L_td_296:
  buffer_load_dwordx4 v[248:251], v3, s[12:15], s59 offen offset:2048
  v_and_b32_dpp v18, v32, v20 quad_perm:[3,3,3,3] row_mask:0xf bank_mask:0xf
  v_and_b32_dpp v19, v32, v21 quad_perm:[3,3,3,3] row_mask:0xf bank_mask:0xf
  s_waitcnt vmcnt(8)
  v_mfma_f32_16x16x16_bf16 v[8:11], v[252:253], v[16:17], v[8:11]
  v_mfma_f32_16x16x16_bf16 v[12:15], v[254:255], v[16:17], v[12:15]
  s_bitcmp1_b32 s99, 4
  s_cbranch_scc1 L_td_298
  s_bitcmp1_b32 s99, 0
  s_cbranch_scc1 L_th_297
  s_waitcnt vmcnt(5)
L_th_297:
  s_waitcnt vmcnt(6)
L_td_298:
  buffer_load_dwordx4 v[252:255], v3, s[12:15], s59 offen offset:3072
  v_and_b32_dpp v16, v33, v20 quad_perm:[0,0,0,0] row_mask:0xf bank_mask:0xf
  v_and_b32_dpp v17, v33, v21 quad_perm:[0,0,0,0] row_mask:0xf bank_mask:0xf
  s_waitcnt vmcnt(8)
  v_mfma_f32_16x16x16_bf16 v[8:11], v[80:81], v[18:19], v[8:11]
  v_mfma_f32_16x16x16_bf16 v[12:15], v[82:83], v[18:19], v[12:15]
  s_mov_b32 s59, 0x3000
  s_bitcmp1_b32 s99, 4
  s_cbranch_scc1 L_td_300
  s_bitcmp1_b32 s99, 0
  s_cbranch_scc1 L_th_299
  s_waitcnt vmcnt(5)
L_th_299:
  s_waitcnt vmcnt(5)
L_td_300:
  buffer_load_dwordx4 v[80:83], v3, s[12:15], s59 offen offset:0
  s_waitcnt vmcnt(8)
  s_bitset0_b32 s99, 4
  v_cmp_lt_i32 vcc, 0x7d, v31
  s_bcnt1_i32_b32 s55, vcc_lo
  s_cmp_lt_u32 s55, 22
  s_cbranch_scc1 L_ck_301
  s_bitset1_b32 s99, 4
L_ck_301:
  v_and_b32 v31, 31, v1
  v_lshl_add_u32 v31, v31, 2, s92
  v_mov_b32 v30, 0x8d
  s_cmp_lg_u32 s52, 0
  s_cbranch_scc1 L_w0_302
  s_mov_b64 exec, 0x1
  buffer_store_dword v30, v1, s[48:51], s93 offen
  s_mov_b64 exec, -1
L_w0_302:
  buffer_load_dword v31, v31, s[48:51], 0 offen sc1
  v_and_b32_dpp v18, v33, v20 quad_perm:[1,1,1,1] row_mask:0xf bank_mask:0xf
  v_and_b32_dpp v19, v33, v21 quad_perm:[1,1,1,1] row_mask:0xf bank_mask:0xf
  s_waitcnt vmcnt(8)
  v_mfma_f32_16x16x16_bf16 v[8:11], v[84:85], v[16:17], v[8:11]
  v_mfma_f32_16x16x16_bf16 v[12:15], v[86:87], v[16:17], v[12:15]
  s_bitcmp1_b32 s99, 4
  s_cbranch_scc1 L_td_304
  s_bitcmp1_b32 s99, 0
  s_cbranch_scc1 L_th_303
  s_waitcnt vmcnt(5)
L_th_303:
  s_waitcnt vmcnt(6)
L_td_304:
  buffer_load_dwordx4 v[84:87], v3, s[12:15], s59 offen offset:1024
  v_and_b32_dpp v16, v33, v20 quad_perm:[2,2,2,2] row_mask:0xf bank_mask:0xf
  v_and_b32_dpp v17, v33, v21 quad_perm:[2,2,2,2] row_mask:0xf bank_mask:0xf
  s_waitcnt vmcnt(8)
  v_mfma_f32_16x16x16_bf16 v[8:11], v[64:65], v[18:19], v[8:11]
  v_mfma_f32_16x16x16_bf16 v[12:15], v[66:67], v[18:19], v[12:15]
  s_bitcmp1_b32 s99, 4
  s_cbranch_scc1 L_td_306
  s_bitcmp1_b32 s99, 0
  s_cbranch_scc1 L_th_305
  s_waitcnt vmcnt(5)
L_th_305:
  s_waitcnt vmcnt(5)
L_td_306:
  buffer_load_dwordx4 v[64:67], v3, s[12:15], s59 offen offset:2048
  v_and_b32_dpp v18, v33, v20 quad_perm:[3,3,3,3] row_mask:0xf bank_mask:0xf
  v_and_b32_dpp v19, v33, v21 quad_perm:[3,3,3,3] row_mask:0xf bank_mask:0xf
  s_waitcnt vmcnt(8)
  v_mfma_f32_16x16x16_bf16 v[8:11], v[68:69], v[16:17], v[8:11]
  v_mfma_f32_16x16x16_bf16 v[12:15], v[70:71], v[16:17], v[12:15]
  s_bitcmp1_b32 s99, 4
  s_cbranch_scc1 L_td_308
  s_bitcmp1_b32 s99, 0
  s_cbranch_scc1 L_th_307
  s_waitcnt vmcnt(5)
L_th_307:
  s_waitcnt vmcnt(6)
L_td_308:
  buffer_load_dwordx4 v[68:71], v3, s[12:15], s59 offen offset:3072
  v_and_b32_dpp v16, v34, v20 quad_perm:[0,0,0,0] row_mask:0xf bank_mask:0xf
  v_and_b32_dpp v17, v34, v21 quad_perm:[0,0,0,0] row_mask:0xf bank_mask:0xf
  s_waitcnt vmcnt(8)
  v_mfma_f32_16x16x16_bf16 v[8:11], v[72:73], v[18:19], v[8:11]
  v_mfma_f32_16x16x16_bf16 v[12:15], v[74:75], v[18:19], v[12:15]
  s_mov_b32 s59, 0x4000
  s_bitcmp1_b32 s99, 4
  s_cbranch_scc1 L_td_310
  s_bitcmp1_b32 s99, 0
  s_cbranch_scc1 L_th_309
  s_waitcnt vmcnt(5)
L_th_309:
  s_waitcnt vmcnt(5)
L_td_310:
  buffer_load_dwordx4 v[72:75], v3, s[12:15], s59 offen offset:0
  v_and_b32_dpp v18, v34, v20 quad_perm:[1,1,1,1] row_mask:0xf bank_mask:0xf
  v_and_b32_dpp v19, v34, v21 quad_perm:[1,1,1,1] row_mask:0xf bank_mask:0xf
  s_waitcnt vmcnt(8)
  v_mfma_f32_16x16x16_bf16 v[8:11], v[76:77], v[16:17], v[8:11]
  v_mfma_f32_16x16x16_bf16 v[12:15], v[78:79], v[16:17], v[12:15]
  s_bitcmp1_b32 s99, 4
  s_cbranch_scc1 L_td_312
  s_bitcmp1_b32 s99, 0
  s_cbranch_scc1 L_th_311
  s_waitcnt vmcnt(5)
L_th_311:
  s_waitcnt vmcnt(6)
L_td_312:
  buffer_load_dwordx4 v[76:79], v3, s[12:15], s59 offen offset:1024
  v_and_b32_dpp v16, v34, v20 quad_perm:[2,2,2,2] row_mask:0xf bank_mask:0xf
  v_and_b32_dpp v17, v34, v21 quad_perm:[2,2,2,2] row_mask:0xf bank_mask:0xf
  s_waitcnt vmcnt(8)
  v_mfma_f32_16x16x16_bf16 v[8:11], v[244:245], v[18:19], v[8:11]
  v_mfma_f32_16x16x16_bf16 v[12:15], v[246:247], v[18:19], v[12:15]
  s_bitcmp1_b32 s99, 4
  s_cbranch_scc1 L_td_314
  s_bitcmp1_b32 s99, 0
  s_cbranch_scc1 L_th_313
  s_waitcnt vmcnt(5)
L_th_313:
  s_waitcnt vmcnt(5)
L_td_314:
  buffer_load_dwordx4 v[244:247], v3, s[12:15], s59 offen offset:2048
  v_and_b32_dpp v18, v34, v20 quad_perm:[3,3,3,3] row_mask:0xf bank_mask:0xf
  v_and_b32_dpp v19, v34, v21 quad_perm:[3,3,3,3] row_mask:0xf bank_mask:0xf
  s_waitcnt vmcnt(8)
  v_mfma_f32_16x16x16_bf16 v[8:11], v[248:249], v[16:17], v[8:11]
  v_mfma_f32_16x16x16_bf16 v[12:15], v[250:251], v[16:17], v[12:15]
  s_bitcmp1_b32 s99, 4
  s_cbranch_scc1 L_td_316
  s_bitcmp1_b32 s99, 0
  s_cbranch_scc1 L_th_315
  s_waitcnt vmcnt(5)
L_th_315:
  s_waitcnt vmcnt(6)
L_td_316:
  buffer_load_dwordx4 v[248:251], v3, s[12:15], s59 offen offset:3072
  v_and_b32_dpp v16, v35, v20 quad_perm:[0,0,0,0] row_mask:0xf bank_mask:0xf
  v_and_b32_dpp v17, v35, v21 quad_perm:[0,0,0,0] row_mask:0xf bank_mask:0xf
  s_waitcnt vmcnt(8)
  v_mfma_f32_16x16x16_bf16 v[8:11], v[252:253], v[18:19], v[8:11]
  v_mfma_f32_16x16x16_bf16 v[12:15], v[254:255], v[18:19], v[12:15]
  s_mov_b32 s59, 0x5000
  s_bitcmp1_b32 s99, 4
  s_cbranch_scc1 L_td_318
  s_bitcmp1_b32 s99, 0
  s_cbranch_scc1 L_th_317
  s_waitcnt vmcnt(5)
L_th_317:
  s_waitcnt vmcnt(5)
L_td_318:
  buffer_load_dwordx4 v[252:255], v3, s[12:15], s59 offen offset:0
  s_waitcnt vmcnt(8)
  s_bitset0_b32 s99, 4
  v_cmp_lt_i32 vcc, 0x85, v31
  s_bcnt1_i32_b32 s55, vcc_lo
  s_cmp_lt_u32 s55, 22
  s_cbranch_scc1 L_ck_319
  s_bitset1_b32 s99, 4
L_ck_319:
  v_and_b32 v31, 31, v1
  v_lshl_add_u32 v31, v31, 2, s92
  v_mov_b32 v30, 0x95
  s_cmp_lg_u32 s52, 0
  s_cbranch_scc1 L_w0_320
  s_mov_b64 exec, 0x1
  buffer_store_dword v30, v1, s[48:51], s93 offen
  s_mov_b64 exec, -1
L_w0_320:
  buffer_load_dword v31, v31, s[48:51], 0 offen sc1
  v_and_b32_dpp v18, v35, v20 quad_perm:[1,1,1,1] row_mask:0xf bank_mask:0xf
  v_and_b32_dpp v19, v35, v21 quad_perm:[1,1,1,1] row_mask:0xf bank_mask:0xf
  s_waitcnt vmcnt(8)
  v_mfma_f32_16x16x16_bf16 v[8:11], v[80:81], v[16:17], v[8:11]
  v_mfma_f32_16x16x16_bf16 v[12:15], v[82:83], v[16:17], v[12:15]
  s_bitcmp1_b32 s99, 4
  s_cbranch_scc1 L_td_322
  s_bitcmp1_b32 s99, 0
  s_cbranch_scc1 L_th_321
  s_waitcnt vmcnt(5)
L_th_321:
  s_waitcnt vmcnt(6)
L_td_322:
  buffer_load_dwordx4 v[80:83], v3, s[12:15], s59 offen offset:1024
  v_and_b32_dpp v16, v35, v20 quad_perm:[2,2,2,2] row_mask:0xf bank_mask:0xf
  v_and_b32_dpp v17, v35, v21 quad_perm:[2,2,2,2] row_mask:0xf bank_mask:0xf
  s_waitcnt vmcnt(8)
  v_mfma_f32_16x16x16_bf16 v[8:11], v[84:85], v[18:19], v[8:11]
  v_mfma_f32_16x16x16_bf16 v[12:15], v[86:87], v[18:19], v[12:15]
  s_bitcmp1_b32 s99, 4
  s_cbranch_scc1 L_td_324
  s_bitcmp1_b32 s99, 0
  s_cbranch_scc1 L_th_323
  s_waitcnt vmcnt(5)
L_th_323:
  s_waitcnt vmcnt(5)
L_td_324:
  buffer_load_dwordx4 v[84:87], v3, s[12:15], s59 offen offset:2048
  v_and_b32_dpp v18, v35, v20 quad_perm:[3,3,3,3] row_mask:0xf bank_mask:0xf
  v_and_b32_dpp v19, v35, v21 quad_perm:[3,3,3,3] row_mask:0xf bank_mask:0xf
  s_waitcnt vmcnt(8)
  v_mfma_f32_16x16x16_bf16 v[8:11], v[64:65], v[16:17], v[8:11]
  v_mfma_f32_16x16x16_bf16 v[12:15], v[66:67], v[16:17], v[12:15]
  s_bitcmp1_b32 s99, 4
  s_cbranch_scc1 L_td_326
  s_bitcmp1_b32 s99, 0
  s_cbranch_scc1 L_th_325
  s_waitcnt vmcnt(5)
L_th_325:
  s_waitcnt vmcnt(6)
L_td_326:
  buffer_load_dwordx4 v[64:67], v3, s[12:15], s59 offen offset:3072
  v_and_b32_dpp v16, v36, v20 quad_perm:[0,0,0,0] row_mask:0xf bank_mask:0xf
  v_and_b32_dpp v17, v36, v21 quad_perm:[0,0,0,0] row_mask:0xf bank_mask:0xf
  s_waitcnt vmcnt(8)
  v_mfma_f32_16x16x16_bf16 v[8:11], v[68:69], v[18:19], v[8:11]
  v_mfma_f32_16x16x16_bf16 v[12:15], v[70:71], v[18:19], v[12:15]
  s_mov_b32 s59, 0x6000
  s_bitcmp1_b32 s99, 4
  s_cbranch_scc1 L_td_328
  s_bitcmp1_b32 s99, 0
  s_cbranch_scc1 L_th_327
  s_waitcnt vmcnt(5)
L_th_327:
  s_waitcnt vmcnt(5)
L_td_328:
  buffer_load_dwordx4 v[32:35], v3, s[12:15], s59 offen offset:0
  s_bitcmp1_b32 s99, 4
  s_cbranch_scc1 L_td_330
  s_bitcmp1_b32 s99, 0
  s_cbranch_scc1 L_th_329
  s_waitcnt vmcnt(5)
L_th_329:
  s_waitcnt vmcnt(6)
L_td_330:
  buffer_load_dwordx4 v[68:71], v3, s[12:15], s59 offen offset:1024
  v_and_b32_dpp v18, v36, v20 quad_perm:[1,1,1,1] row_mask:0xf bank_mask:0xf
  v_and_b32_dpp v19, v36, v21 quad_perm:[1,1,1,1] row_mask:0xf bank_mask:0xf
  s_waitcnt vmcnt(9)
  v_mfma_f32_16x16x16_bf16 v[8:11], v[72:73], v[16:17], v[8:11]
  v_mfma_f32_16x16x16_bf16 v[12:15], v[74:75], v[16:17], v[12:15]
  s_bitcmp1_b32 s99, 4
  s_cbranch_scc1 L_td_332
  s_bitcmp1_b32 s99, 0
  s_cbranch_scc1 L_th_331
  s_waitcnt vmcnt(5)
L_th_331:
  s_waitcnt vmcnt(5)
L_td_332:
  buffer_load_dwordx4 v[72:75], v3, s[12:15], s59 offen offset:2048
  v_and_b32_dpp v16, v36, v20 quad_perm:[2,2,2,2] row_mask:0xf bank_mask:0xf
  v_and_b32_dpp v17, v36, v21 quad_perm:[2,2,2,2] row_mask:0xf bank_mask:0xf
  s_waitcnt vmcnt(9)
  v_mfma_f32_16x16x16_bf16 v[8:11], v[76:77], v[18:19], v[8:11]
  v_mfma_f32_16x16x16_bf16 v[12:15], v[78:79], v[18:19], v[12:15]
  s_bitcmp1_b32 s99, 4
  s_cbranch_scc1 L_td_334
  s_bitcmp1_b32 s99, 0
  s_cbranch_scc1 L_th_333
  s_waitcnt vmcnt(5)
L_th_333:
  s_waitcnt vmcnt(6)
L_td_334:
  buffer_load_dwordx4 v[76:79], v3, s[12:15], s59 offen offset:3072
  v_and_b32_dpp v18, v36, v20 quad_perm:[3,3,3,3] row_mask:0xf bank_mask:0xf
  v_and_b32_dpp v19, v36, v21 quad_perm:[3,3,3,3] row_mask:0xf bank_mask:0xf
  s_waitcnt vmcnt(9)
  v_mfma_f32_16x16x16_bf16 v[8:11], v[244:245], v[16:17], v[8:11]
  v_mfma_f32_16x16x16_bf16 v[12:15], v[246:247], v[16:17], v[12:15]
  s_mov_b32 s59, 0x7000
  s_bitcmp1_b32 s99, 4
  s_cbranch_scc1 L_td_336
  s_bitcmp1_b32 s99, 0
  s_cbranch_scc1 L_th_335
  s_waitcnt vmcnt(5)
L_th_335:
  s_waitcnt vmcnt(5)
L_td_336:
  buffer_load_dwordx4 v[244:247], v3, s[12:15], s59 offen offset:0
  s_waitcnt vmcnt(8)
  s_bitset0_b32 s99, 4
  v_cmp_lt_i32 vcc, 0x8d, v31
  s_bcnt1_i32_b32 s55, vcc_lo
  s_cmp_lt_u32 s55, 22
  s_cbranch_scc1 L_ck_337
  s_bitset1_b32 s99, 4
L_ck_337:
  v_and_b32 v31, 31, v1
  v_lshl_add_u32 v31, v31, 2, s92
  v_mov_b32 v30, 0x9d
  s_cmp_lg_u32 s52, 0
  s_cbranch_scc1 L_w0_338
  s_mov_b64 exec, 0x1
  buffer_store_dword v30, v1, s[48:51], s93 offen
  s_mov_b64 exec, -1
L_w0_338:
  buffer_load_dword v31, v31, s[48:51], 0 offen sc1
  v_and_b32_dpp v16, v37, v20 quad_perm:[0,0,0,0] row_mask:0xf bank_mask:0xf
  v_and_b32_dpp v17, v37, v21 quad_perm:[0,0,0,0] row_mask:0xf bank_mask:0xf
  s_waitcnt vmcnt(9)
  v_mfma_f32_16x16x16_bf16 v[8:11], v[248:249], v[18:19], v[8:11]
  v_mfma_f32_16x16x16_bf16 v[12:15], v[250:251], v[18:19], v[12:15]
  s_bitcmp1_b32 s99, 4
  s_cbranch_scc1 L_td_340
  s_bitcmp1_b32 s99, 0
  s_cbranch_scc1 L_th_339
  s_waitcnt vmcnt(5)
L_th_339:
  s_waitcnt vmcnt(6)
L_td_340:
  buffer_load_dwordx4 v[248:251], v3, s[12:15], s59 offen offset:1024
  v_and_b32_dpp v18, v37, v20 quad_perm:[1,1,1,1] row_mask:0xf bank_mask:0xf
  v_and_b32_dpp v19, v37, v21 quad_perm:[1,1,1,1] row_mask:0xf bank_mask:0xf
  s_waitcnt vmcnt(9)
  v_mfma_f32_16x16x16_bf16 v[8:11], v[252:253], v[16:17], v[8:11]
  v_mfma_f32_16x16x16_bf16 v[12:15], v[254:255], v[16:17], v[12:15]
  s_bitcmp1_b32 s99, 4
  s_cbranch_scc1 L_td_342
  s_bitcmp1_b32 s99, 0
  s_cbranch_scc1 L_th_341
  s_waitcnt vmcnt(5)
L_th_341:
  s_waitcnt vmcnt(5)
L_td_342:
  buffer_load_dwordx4 v[252:255], v3, s[12:15], s59 offen offset:2048
  v_and_b32_dpp v16, v37, v20 quad_perm:[2,2,2,2] row_mask:0xf bank_mask:0xf
  v_and_b32_dpp v17, v37, v21 quad_perm:[2,2,2,2] row_mask:0xf bank_mask:0xf
  s_waitcnt vmcnt(9)
  v_mfma_f32_16x16x16_bf16 v[8:11], v[80:81], v[18:19], v[8:11]
  v_mfma_f32_16x16x16_bf16 v[12:15], v[82:83], v[18:19], v[12:15]
  s_bitcmp1_b32 s99, 4
  s_cbranch_scc1 L_td_344
  s_bitcmp1_b32 s99, 0
  s_cbranch_scc1 L_th_343
  s_waitcnt vmcnt(5)
L_th_343:
  s_waitcnt vmcnt(6)
L_td_344:
  buffer_load_dwordx4 v[80:83], v3, s[12:15], s59 offen offset:3072
  v_and_b32_dpp v18, v37, v20 quad_perm:[3,3,3,3] row_mask:0xf bank_mask:0xf
  v_and_b32_dpp v19, v37, v21 quad_perm:[3,3,3,3] row_mask:0xf bank_mask:0xf
  s_waitcnt vmcnt(9)
  v_mfma_f32_16x16x16_bf16 v[8:11], v[84:85], v[16:17], v[8:11]
  v_mfma_f32_16x16x16_bf16 v[12:15], v[86:87], v[16:17], v[12:15]
  s_mov_b32 s59, 0x8000
  s_bitcmp1_b32 s99, 4
  s_cbranch_scc1 L_td_346
  s_bitcmp1_b32 s99, 0
  s_cbranch_scc1 L_th_345
  s_waitcnt vmcnt(5)
L_th_345:
  s_waitcnt vmcnt(5)
L_td_346:
  buffer_load_dwordx4 v[84:87], v3, s[12:15], s59 offen offset:0
  v_and_b32_dpp v16, v38, v20 quad_perm:[0,0,0,0] row_mask:0xf bank_mask:0xf
  v_and_b32_dpp v17, v38, v21 quad_perm:[0,0,0,0] row_mask:0xf bank_mask:0xf
  s_waitcnt vmcnt(9)
  v_mfma_f32_16x16x16_bf16 v[8:11], v[64:65], v[18:19], v[8:11]
  v_mfma_f32_16x16x16_bf16 v[12:15], v[66:67], v[18:19], v[12:15]
  s_bitcmp1_b32 s99, 4
  s_cbranch_scc1 L_td_348
  s_bitcmp1_b32 s99, 0
  s_cbranch_scc1 L_th_347
  s_waitcnt vmcnt(5)
L_th_347:
  s_waitcnt vmcnt(6)
L_td_348:
  buffer_load_dwordx4 v[64:67], v3, s[12:15], s59 offen offset:1024
  v_and_b32_dpp v18, v38, v20 quad_perm:[1,1,1,1] row_mask:0xf bank_mask:0xf
  v_and_b32_dpp v19, v38, v21 quad_perm:[1,1,1,1] row_mask:0xf bank_mask:0xf
  s_waitcnt vmcnt(9)
  v_mfma_f32_16x16x16_bf16 v[8:11], v[32:33], v[16:17], v[8:11]
  v_mfma_f32_16x16x16_bf16 v[12:15], v[34:35], v[16:17], v[12:15]
  s_bitcmp1_b32 s99, 4
  s_cbranch_scc1 L_td_350
  s_bitcmp1_b32 s99, 0
  s_cbranch_scc1 L_th_349
  s_waitcnt vmcnt(5)
L_th_349:
  s_waitcnt vmcnt(5)
L_td_350:
  buffer_load_dwordx4 v[32:35], v3, s[12:15], s59 offen offset:2048
  v_and_b32_dpp v16, v38, v20 quad_perm:[2,2,2,2] row_mask:0xf bank_mask:0xf
  v_and_b32_dpp v17, v38, v21 quad_perm:[2,2,2,2] row_mask:0xf bank_mask:0xf
  s_waitcnt vmcnt(9)
  v_mfma_f32_16x16x16_bf16 v[8:11], v[68:69], v[18:19], v[8:11]
  v_mfma_f32_16x16x16_bf16 v[12:15], v[70:71], v[18:19], v[12:15]
  s_bitcmp1_b32 s99, 4
  s_cbranch_scc1 L_td_352
  s_bitcmp1_b32 s99, 0
  s_cbranch_scc1 L_th_351
  s_waitcnt vmcnt(5)
L_th_351:
  s_waitcnt vmcnt(6)
L_td_352:
  buffer_load_dwordx4 v[68:71], v3, s[12:15], s59 offen offset:3072
  v_and_b32_dpp v18, v38, v20 quad_perm:[3,3,3,3] row_mask:0xf bank_mask:0xf
  v_and_b32_dpp v19, v38, v21 quad_perm:[3,3,3,3] row_mask:0xf bank_mask:0xf
  s_waitcnt vmcnt(9)
  v_mfma_f32_16x16x16_bf16 v[8:11], v[72:73], v[16:17], v[8:11]
  v_mfma_f32_16x16x16_bf16 v[12:15], v[74:75], v[16:17], v[12:15]
  s_mov_b32 s59, 0x9000
  s_bitcmp1_b32 s99, 4
  s_cbranch_scc1 L_td_354
  s_bitcmp1_b32 s99, 0
  s_cbranch_scc1 L_th_353
  s_waitcnt vmcnt(5)
L_th_353:
  s_waitcnt vmcnt(5)
L_td_354:
  buffer_load_dwordx4 v[72:75], v3, s[12:15], s59 offen offset:0
  s_waitcnt vmcnt(8)
  s_bitset0_b32 s99, 4
  v_cmp_lt_i32 vcc, 0x95, v31
  s_bcnt1_i32_b32 s55, vcc_lo
  s_cmp_lt_u32 s55, 22
  s_cbranch_scc1 L_ck_355
  s_bitset1_b32 s99, 4
L_ck_355:
  v_and_b32 v31, 31, v1
  v_lshl_add_u32 v31, v31, 2, s92
  v_mov_b32 v30, 0xa5
  s_cmp_lg_u32 s52, 0
  s_cbranch_scc1 L_w0_356
  s_mov_b64 exec, 0x1
  buffer_store_dword v30, v1, s[48:51], s93 offen
  s_mov_b64 exec, -1
L_w0_356:
  buffer_load_dword v31, v31, s[48:51], 0 offen sc1
  v_and_b32_dpp v16, v39, v20 quad_perm:[0,0,0,0] row_mask:0xf bank_mask:0xf
  v_and_b32_dpp v17, v39, v21 quad_perm:[0,0,0,0] row_mask:0xf bank_mask:0xf
  s_waitcnt vmcnt(9)
  v_mfma_f32_16x16x16_bf16 v[8:11], v[76:77], v[18:19], v[8:11]
  v_mfma_f32_16x16x16_bf16 v[12:15], v[78:79], v[18:19], v[12:15]
  s_bitcmp1_b32 s99, 4
  s_cbranch_scc1 L_td_358
  s_bitcmp1_b32 s99, 0
  s_cbranch_scc1 L_th_357
  s_waitcnt vmcnt(5)
L_th_357:
  s_waitcnt vmcnt(6)
L_td_358:
  buffer_load_dwordx4 v[76:79], v3, s[12:15], s59 offen offset:1024
  v_and_b32_dpp v18, v39, v20 quad_perm:[1,1,1,1] row_mask:0xf bank_mask:0xf
  v_and_b32_dpp v19, v39, v21 quad_perm:[1,1,1,1] row_mask:0xf bank_mask:0xf
  s_waitcnt vmcnt(9)
  v_mfma_f32_16x16x16_bf16 v[8:11], v[244:245], v[16:17], v[8:11]
  v_mfma_f32_16x16x16_bf16 v[12:15], v[246:247], v[16:17], v[12:15]
  s_bitcmp1_b32 s99, 4
  s_cbranch_scc1 L_td_360
  s_bitcmp1_b32 s99, 0
  s_cbranch_scc1 L_th_359
  s_waitcnt vmcnt(5)
L_th_359:
  s_waitcnt vmcnt(5)
L_td_360:
  buffer_load_dwordx4 v[244:247], v3, s[12:15], s59 offen offset:2048
  v_and_b32_dpp v16, v39, v20 quad_perm:[2,2,2,2] row_mask:0xf bank_mask:0xf
  v_and_b32_dpp v17, v39, v21 quad_perm:[2,2,2,2] row_mask:0xf bank_mask:0xf
  s_waitcnt vmcnt(9)
  v_mfma_f32_16x16x16_bf16 v[8:11], v[248:249], v[18:19], v[8:11]
  v_mfma_f32_16x16x16_bf16 v[12:15], v[250:251], v[18:19], v[12:15]
  s_bitcmp1_b32 s99, 4
  s_cbranch_scc1 L_td_362
  s_bitcmp1_b32 s99, 0
  s_cbranch_scc1 L_th_361
  s_waitcnt vmcnt(5)
L_th_361:
  s_waitcnt vmcnt(6)
L_td_362:
  buffer_load_dwordx4 v[248:251], v3, s[12:15], s59 offen offset:3072
  v_and_b32_dpp v18, v39, v20 quad_perm:[3,3,3,3] row_mask:0xf bank_mask:0xf
  v_and_b32_dpp v19, v39, v21 quad_perm:[3,3,3,3] row_mask:0xf bank_mask:0xf
  s_waitcnt vmcnt(9)
  v_mfma_f32_16x16x16_bf16 v[8:11], v[252:253], v[16:17], v[8:11]
  v_mfma_f32_16x16x16_bf16 v[12:15], v[254:255], v[16:17], v[12:15]
  s_mov_b32 s59, 0xa000
  s_bitcmp1_b32 s99, 4
  s_cbranch_scc1 L_td_364
  s_bitcmp1_b32 s99, 0
  s_cbranch_scc1 L_th_363
  s_waitcnt vmcnt(5)
L_th_363:
  s_waitcnt vmcnt(5)
L_td_364:
  buffer_load_dwordx4 v[252:255], v3, s[12:15], s59 offen offset:0
  v_and_b32_dpp v16, v40, v20 quad_perm:[0,0,0,0] row_mask:0xf bank_mask:0xf
  v_and_b32_dpp v17, v40, v21 quad_perm:[0,0,0,0] row_mask:0xf bank_mask:0xf
  s_waitcnt vmcnt(9)
  v_mfma_f32_16x16x16_bf16 v[8:11], v[80:81], v[18:19], v[8:11]
  v_mfma_f32_16x16x16_bf16 v[12:15], v[82:83], v[18:19], v[12:15]
  s_bitcmp1_b32 s99, 4
  s_cbranch_scc1 L_td_366
  s_bitcmp1_b32 s99, 0
  s_cbranch_scc1 L_th_365
  s_waitcnt vmcnt(5)
L_th_365:
  s_waitcnt vmcnt(6)
L_td_366:
  buffer_load_dwordx4 v[80:83], v3, s[12:15], s59 offen offset:1024
  s_bitcmp1_b32 s99, 4
  s_cbranch_scc1 L_td_368
  s_bitcmp1_b32 s99, 0
  s_cbranch_scc1 L_th_367
  s_waitcnt vmcnt(5)
L_th_367:
  s_waitcnt vmcnt(5)
L_td_368:
  buffer_load_dwordx4 v[36:39], v3, s[12:15], s59 offen offset:2048
  v_and_b32_dpp v18, v40, v20 quad_perm:[1,1,1,1] row_mask:0xf bank_mask:0xf
  v_and_b32_dpp v19, v40, v21 quad_perm:[1,1,1,1] row_mask:0xf bank_mask:0xf
  s_waitcnt vmcnt(10)
  v_mfma_f32_16x16x16_bf16 v[8:11], v[84:85], v[16:17], v[8:11]
  v_mfma_f32_16x16x16_bf16 v[12:15], v[86:87], v[16:17], v[12:15]
  s_bitcmp1_b32 s99, 4
  s_cbranch_scc1 L_td_370
  s_bitcmp1_b32 s99, 0
  s_cbranch_scc1 L_th_369
  s_waitcnt vmcnt(5)
L_th_369:
  s_waitcnt vmcnt(6)
L_td_370:
  buffer_load_dwordx4 v[84:87], v3, s[12:15], s59 offen offset:3072
  v_and_b32_dpp v16, v40, v20 quad_perm:[2,2,2,2] row_mask:0xf bank_mask:0xf
  v_and_b32_dpp v17, v40, v21 quad_perm:[2,2,2,2] row_mask:0xf bank_mask:0xf
  s_waitcnt vmcnt(10)
  v_mfma_f32_16x16x16_bf16 v[8:11], v[64:65], v[18:19], v[8:11]
  v_mfma_f32_16x16x16_bf16 v[12:15], v[66:67], v[18:19], v[12:15]
  s_mov_b32 s59, 0xb000
  s_bitcmp1_b32 s99, 4
  s_cbranch_scc1 L_td_372
  s_bitcmp1_b32 s99, 0
  s_cbranch_scc1 L_th_371
  s_waitcnt vmcnt(5)
L_th_371:
  s_waitcnt vmcnt(5)
L_td_372:
  buffer_load_dwordx4 v[64:67], v3, s[12:15], s59 offen offset:0
  s_waitcnt vmcnt(8)
  s_bitset0_b32 s99, 4
  v_cmp_lt_i32 vcc, 0x9d, v31
  s_bcnt1_i32_b32 s55, vcc_lo
  s_cmp_lt_u32 s55, 22
  s_cbranch_scc1 L_ck_373
  s_bitset1_b32 s99, 4
L_ck_373:
  v_and_b32 v31, 31, v1
  v_lshl_add_u32 v31, v31, 2, s92
  v_mov_b32 v30, 0xad
  s_cmp_lg_u32 s52, 0
  s_cbranch_scc1 L_w0_374
  s_mov_b64 exec, 0x1
  buffer_store_dword v30, v1, s[48:51], s93 offen
  s_mov_b64 exec, -1
L_w0_374:
  buffer_load_dword v31, v31, s[48:51], 0 offen sc1
  v_and_b32_dpp v18, v40, v20 quad_perm:[3,3,3,3] row_mask:0xf bank_mask:0xf
  v_and_b32_dpp v19, v40, v21 quad_perm:[3,3,3,3] row_mask:0xf bank_mask:0xf
  s_waitcnt vmcnt(10)
  v_mfma_f32_16x16x16_bf16 v[8:11], v[32:33], v[16:17], v[8:11]
  v_mfma_f32_16x16x16_bf16 v[12:15], v[34:35], v[16:17], v[12:15]
  s_bitcmp1_b32 s99, 4
  s_cbranch_scc1 L_td_376
  s_bitcmp1_b32 s99, 0
  s_cbranch_scc1 L_th_375
  s_waitcnt vmcnt(5)
L_th_375:
  s_waitcnt vmcnt(6)
L_td_376:
  buffer_load_dwordx4 v[32:35], v3, s[12:15], s59 offen offset:1024
  v_and_b32_dpp v16, v41, v20 quad_perm:[0,0,0,0] row_mask:0xf bank_mask:0xf
  v_and_b32_dpp v17, v41, v21 quad_perm:[0,0,0,0] row_mask:0xf bank_mask:0xf
  s_waitcnt vmcnt(10)
  v_mfma_f32_16x16x16_bf16 v[8:11], v[68:69], v[18:19], v[8:11]
  v_mfma_f32_16x16x16_bf16 v[12:15], v[70:71], v[18:19], v[12:15]
  s_bitcmp1_b32 s99, 4
  s_cbranch_scc1 L_td_378
  s_bitcmp1_b32 s99, 0
  s_cbranch_scc1 L_th_377
  s_waitcnt vmcnt(5)
L_th_377:
  s_waitcnt vmcnt(5)
L_td_378:
  buffer_load_dwordx4 v[68:71], v3, s[12:15], s59 offen offset:2048
  v_and_b32_dpp v18, v41, v20 quad_perm:[1,1,1,1] row_mask:0xf bank_mask:0xf
  v_and_b32_dpp v19, v41, v21 quad_perm:[1,1,1,1] row_mask:0xf bank_mask:0xf
  s_waitcnt vmcnt(10)
  v_mfma_f32_16x16x16_bf16 v[8:11], v[72:73], v[16:17], v[8:11]
  v_mfma_f32_16x16x16_bf16 v[12:15], v[74:75], v[16:17], v[12:15]
  s_bitcmp1_b32 s99, 4
  s_cbranch_scc1 L_td_380
  s_bitcmp1_b32 s99, 0
  s_cbranch_scc1 L_th_379
  s_waitcnt vmcnt(5)
L_th_379:
  s_waitcnt vmcnt(6)
L_td_380:
  buffer_load_dwordx4 v[72:75], v3, s[12:15], s59 offen offset:3072
  v_and_b32_dpp v16, v41, v20 quad_perm:[2,2,2,2] row_mask:0xf bank_mask:0xf
  v_and_b32_dpp v17, v41, v21 quad_perm:[2,2,2,2] row_mask:0xf bank_mask:0xf
  s_waitcnt vmcnt(10)
  v_mfma_f32_16x16x16_bf16 v[8:11], v[76:77], v[18:19], v[8:11]
  v_mfma_f32_16x16x16_bf16 v[12:15], v[78:79], v[18:19], v[12:15]
  s_mov_b32 s59, 0xc000
  s_bitcmp1_b32 s99, 4
  s_cbranch_scc1 L_td_382
  s_bitcmp1_b32 s99, 0
  s_cbranch_scc1 L_th_381
  s_waitcnt vmcnt(5)
L_th_381:
  s_waitcnt vmcnt(5)
L_td_382:
  buffer_load_dwordx4 v[76:79], v3, s[12:15], s59 offen offset:0
  v_and_b32_dpp v18, v41, v20 quad_perm:[3,3,3,3] row_mask:0xf bank_mask:0xf
  v_and_b32_dpp v19, v41, v21 quad_perm:[3,3,3,3] row_mask:0xf bank_mask:0xf
  s_waitcnt vmcnt(10)
  v_mfma_f32_16x16x16_bf16 v[8:11], v[244:245], v[16:17], v[8:11]
  v_mfma_f32_16x16x16_bf16 v[12:15], v[246:247], v[16:17], v[12:15]
  s_bitcmp1_b32 s99, 4
  s_cbranch_scc1 L_td_384
  s_bitcmp1_b32 s99, 0
  s_cbranch_scc1 L_th_383
  s_waitcnt vmcnt(5)
L_th_383:
  s_waitcnt vmcnt(6)
L_td_384:
  buffer_load_dwordx4 v[244:247], v3, s[12:15], s59 offen offset:1024
  v_and_b32_dpp v16, v42, v20 quad_perm:[0,0,0,0] row_mask:0xf bank_mask:0xf
  v_and_b32_dpp v17, v42, v21 quad_perm:[0,0,0,0] row_mask:0xf bank_mask:0xf
  s_waitcnt vmcnt(10)
  v_mfma_f32_16x16x16_bf16 v[8:11], v[248:249], v[18:19], v[8:11]
  v_mfma_f32_16x16x16_bf16 v[12:15], v[250:251], v[18:19], v[12:15]
  s_bitcmp1_b32 s99, 4
  s_cbranch_scc1 L_td_386
  s_bitcmp1_b32 s99, 0
  s_cbranch_scc1 L_th_385
  s_waitcnt vmcnt(5)
L_th_385:
  s_waitcnt vmcnt(5)
L_td_386:
  buffer_load_dwordx4 v[248:251], v3, s[12:15], s59 offen offset:2048
  v_and_b32_dpp v18, v42, v20 quad_perm:[1,1,1,1] row_mask:0xf bank_mask:0xf
  v_and_b32_dpp v19, v42, v21 quad_perm:[1,1,1,1] row_mask:0xf bank_mask:0xf
  s_waitcnt vmcnt(10)
  v_mfma_f32_16x16x16_bf16 v[8:11], v[252:253], v[16:17], v[8:11]
  v_mfma_f32_16x16x16_bf16 v[12:15], v[254:255], v[16:17], v[12:15]
  s_bitcmp1_b32 s99, 4
  s_cbranch_scc1 L_td_388
  s_bitcmp1_b32 s99, 0
  s_cbranch_scc1 L_th_387
  s_waitcnt vmcnt(5)
L_th_387:
  s_waitcnt vmcnt(6)
L_td_388:
  buffer_load_dwordx4 v[252:255], v3, s[12:15], s59 offen offset:3072
  v_and_b32_dpp v16, v42, v20 quad_perm:[2,2,2,2] row_mask:0xf bank_mask:0xf
  v_and_b32_dpp v17, v42, v21 quad_perm:[2,2,2,2] row_mask:0xf bank_mask:0xf
  s_waitcnt vmcnt(10)
  v_mfma_f32_16x16x16_bf16 v[8:11], v[80:81], v[18:19], v[8:11]
  v_mfma_f32_16x16x16_bf16 v[12:15], v[82:83], v[18:19], v[12:15]
  v_and_b32_dpp v18, v42, v20 quad_perm:[3,3,3,3] row_mask:0xf bank_mask:0xf
  v_and_b32_dpp v19, v42, v21 quad_perm:[3,3,3,3] row_mask:0xf bank_mask:0xf
  s_waitcnt vmcnt(9)
  v_mfma_f32_16x16x16_bf16 v[8:11], v[36:37], v[16:17], v[8:11]
  v_mfma_f32_16x16x16_bf16 v[12:15], v[38:39], v[16:17], v[12:15]
  s_mov_b32 s59, 0xd000
  s_bitcmp1_b32 s99, 4
  s_cbranch_scc1 L_td_390
  s_bitcmp1_b32 s99, 0
  s_cbranch_scc1 L_th_389
  s_waitcnt vmcnt(5)
L_th_389:
  s_waitcnt vmcnt(5)
L_td_390:
  buffer_load_dwordx4 v[36:39], v3, s[12:15], s59 offen offset:0
  s_waitcnt vmcnt(8)
  s_bitset0_b32 s99, 4
  v_cmp_lt_i32 vcc, 0xa5, v31
  s_bcnt1_i32_b32 s55, vcc_lo
  s_cmp_lt_u32 s55, 22
  s_cbranch_scc1 L_ck_391
  s_bitset1_b32 s99, 4
L_ck_391:
  v_and_b32 v31, 31, v1
  v_lshl_add_u32 v31, v31, 2, s92
  v_mov_b32 v30, 0xb5
  s_cmp_lg_u32 s52, 0
  s_cbranch_scc1 L_w0_392
  s_mov_b64 exec, 0x1
  buffer_store_dword v30, v1, s[48:51], s93 offen
  s_mov_b64 exec, -1
L_w0_392:
  buffer_load_dword v31, v31, s[48:51], 0 offen sc1
  v_and_b32_dpp v16, v43, v20 quad_perm:[0,0,0,0] row_mask:0xf bank_mask:0xf
  v_and_b32_dpp v17, v43, v21 quad_perm:[0,0,0,0] row_mask:0xf bank_mask:0xf
  s_waitcnt vmcnt(9)
  v_mfma_f32_16x16x16_bf16 v[8:11], v[84:85], v[18:19], v[8:11]
  v_mfma_f32_16x16x16_bf16 v[12:15], v[86:87], v[18:19], v[12:15]
  v_and_b32_dpp v18, v43, v20 quad_perm:[1,1,1,1] row_mask:0xf bank_mask:0xf
  v_and_b32_dpp v19, v43, v21 quad_perm:[1,1,1,1] row_mask:0xf bank_mask:0xf
  s_waitcnt vmcnt(8)
  v_mfma_f32_16x16x16_bf16 v[8:11], v[64:65], v[16:17], v[8:11]
  v_mfma_f32_16x16x16_bf16 v[12:15], v[66:67], v[16:17], v[12:15]
  s_bitcmp1_b32 s99, 4
  s_cbranch_scc1 L_td_394
  s_bitcmp1_b32 s99, 0
  s_cbranch_scc1 L_th_393
  s_waitcnt vmcnt(5)
L_th_393:
  s_waitcnt vmcnt(6)
L_td_394:
  buffer_load_dwordx4 v[64:67], v3, s[12:15], s59 offen offset:1024
  v_and_b32_dpp v16, v43, v20 quad_perm:[2,2,2,2] row_mask:0xf bank_mask:0xf
  v_and_b32_dpp v17, v43, v21 quad_perm:[2,2,2,2] row_mask:0xf bank_mask:0xf
  s_waitcnt vmcnt(8)
  v_mfma_f32_16x16x16_bf16 v[8:11], v[32:33], v[18:19], v[8:11]
  v_mfma_f32_16x16x16_bf16 v[12:15], v[34:35], v[18:19], v[12:15]
  s_bitcmp1_b32 s99, 4
  s_cbranch_scc1 L_td_396
  s_bitcmp1_b32 s99, 0
  s_cbranch_scc1 L_th_395
  s_waitcnt vmcnt(5)
L_th_395:
  s_waitcnt vmcnt(5)
L_td_396:
  buffer_load_dwordx4 v[32:35], v3, s[12:15], s59 offen offset:2048
  v_and_b32_dpp v18, v43, v20 quad_perm:[3,3,3,3] row_mask:0xf bank_mask:0xf
  v_and_b32_dpp v19, v43, v21 quad_perm:[3,3,3,3] row_mask:0xf bank_mask:0xf
  s_waitcnt vmcnt(8)
  v_mfma_f32_16x16x16_bf16 v[8:11], v[68:69], v[16:17], v[8:11]
  v_mfma_f32_16x16x16_bf16 v[12:15], v[70:71], v[16:17], v[12:15]
  s_bitcmp1_b32 s99, 4
  s_cbranch_scc1 L_td_398
  s_bitcmp1_b32 s99, 0
  s_cbranch_scc1 L_th_397
  s_waitcnt vmcnt(5)
L_th_397:
  s_waitcnt vmcnt(6)
L_td_398:
  buffer_load_dwordx4 v[68:71], v3, s[12:15], s59 offen offset:3072
  v_and_b32_dpp v16, v44, v20 quad_perm:[0,0,0,0] row_mask:0xf bank_mask:0xf
  v_and_b32_dpp v17, v44, v21 quad_perm:[0,0,0,0] row_mask:0xf bank_mask:0xf
  s_waitcnt vmcnt(8)
  v_mfma_f32_16x16x16_bf16 v[8:11], v[72:73], v[18:19], v[8:11]
  v_mfma_f32_16x16x16_bf16 v[12:15], v[74:75], v[18:19], v[12:15]
  s_mov_b32 s59, 0xe000
  s_bitcmp1_b32 s99, 4
  s_cbranch_scc1 L_td_400
  s_bitcmp1_b32 s99, 0
  s_cbranch_scc1 L_th_399
  s_waitcnt vmcnt(5)
L_th_399:
  s_waitcnt vmcnt(5)
L_td_400:
  buffer_load_dwordx4 v[40:43], v3, s[12:15], s59 offen offset:0
  s_bitcmp1_b32 s99, 4
  s_cbranch_scc1 L_td_402
  s_bitcmp1_b32 s99, 0
  s_cbranch_scc1 L_th_401
  s_waitcnt vmcnt(5)
L_th_401:
  s_waitcnt vmcnt(6)
L_td_402:
  buffer_load_dwordx4 v[72:75], v3, s[12:15], s59 offen offset:1024
  v_and_b32_dpp v18, v44, v20 quad_perm:[1,1,1,1] row_mask:0xf bank_mask:0xf
  v_and_b32_dpp v19, v44, v21 quad_perm:[1,1,1,1] row_mask:0xf bank_mask:0xf
  s_waitcnt vmcnt(9)
  v_mfma_f32_16x16x16_bf16 v[8:11], v[76:77], v[16:17], v[8:11]
  v_mfma_f32_16x16x16_bf16 v[12:15], v[78:79], v[16:17], v[12:15]
  s_bitcmp1_b32 s99, 4
  s_cbranch_scc1 L_td_404
  s_bitcmp1_b32 s99, 0
  s_cbranch_scc1 L_th_403
  s_waitcnt vmcnt(5)
L_th_403:
  s_waitcnt vmcnt(5)
L_td_404:
  buffer_load_dwordx4 v[76:79], v3, s[12:15], s59 offen offset:2048
  v_and_b32_dpp v16, v44, v20 quad_perm:[2,2,2,2] row_mask:0xf bank_mask:0xf
  v_and_b32_dpp v17, v44, v21 quad_perm:[2,2,2,2] row_mask:0xf bank_mask:0xf
  s_waitcnt vmcnt(9)
  v_mfma_f32_16x16x16_bf16 v[8:11], v[244:245], v[18:19], v[8:11]
  v_mfma_f32_16x16x16_bf16 v[12:15], v[246:247], v[18:19], v[12:15]
  s_bitcmp1_b32 s99, 4
  s_cbranch_scc1 L_td_406
  s_bitcmp1_b32 s99, 0
  s_cbranch_scc1 L_th_405
  s_waitcnt vmcnt(5)
L_th_405:
  s_waitcnt vmcnt(6)
L_td_406:
  buffer_load_dwordx4 v[244:247], v3, s[12:15], s59 offen offset:3072
  v_and_b32_dpp v18, v44, v20 quad_perm:[3,3,3,3] row_mask:0xf bank_mask:0xf
  v_and_b32_dpp v19, v44, v21 quad_perm:[3,3,3,3] row_mask:0xf bank_mask:0xf
  s_waitcnt vmcnt(9)
  v_mfma_f32_16x16x16_bf16 v[8:11], v[248:249], v[16:17], v[8:11]
  v_mfma_f32_16x16x16_bf16 v[12:15], v[250:251], v[16:17], v[12:15]
  s_mov_b32 s59, 0xf000
  s_bitcmp1_b32 s99, 4
  s_cbranch_scc1 L_td_408
  s_bitcmp1_b32 s99, 0
  s_cbranch_scc1 L_th_407
  s_waitcnt vmcnt(5)
L_th_407:
  s_waitcnt vmcnt(5)
L_td_408:
  buffer_load_dwordx4 v[248:251], v3, s[12:15], s59 offen offset:0
  s_waitcnt vmcnt(8)
  s_bitset0_b32 s99, 4
  v_cmp_lt_i32 vcc, 0xad, v31
  s_bcnt1_i32_b32 s55, vcc_lo
  s_cmp_lt_u32 s55, 22
  s_cbranch_scc1 L_ck_409
  s_bitset1_b32 s99, 4
L_ck_409:
  v_and_b32 v31, 31, v1
  v_lshl_add_u32 v31, v31, 2, s92
  v_mov_b32 v30, 0xbd
  s_cmp_lg_u32 s52, 0
  s_cbranch_scc1 L_w0_410
  s_mov_b64 exec, 0x1
  buffer_store_dword v30, v1, s[48:51], s93 offen
  s_mov_b64 exec, -1
L_w0_410:
  buffer_load_dword v31, v31, s[48:51], 0 offen sc1
  v_and_b32_dpp v16, v45, v20 quad_perm:[0,0,0,0] row_mask:0xf bank_mask:0xf
  v_and_b32_dpp v17, v45, v21 quad_perm:[0,0,0,0] row_mask:0xf bank_mask:0xf
  s_waitcnt vmcnt(9)
  v_mfma_f32_16x16x16_bf16 v[8:11], v[252:253], v[18:19], v[8:11]
  v_mfma_f32_16x16x16_bf16 v[12:15], v[254:255], v[18:19], v[12:15]
  s_bitcmp1_b32 s99, 4
  s_cbranch_scc1 L_td_412
  s_bitcmp1_b32 s99, 0
  s_cbranch_scc1 L_th_411
  s_waitcnt vmcnt(5)
L_th_411:
  s_waitcnt vmcnt(6)
L_td_412:
  buffer_load_dwordx4 v[252:255], v3, s[12:15], s59 offen offset:1024
  v_and_b32_dpp v18, v45, v20 quad_perm:[1,1,1,1] row_mask:0xf bank_mask:0xf
  v_and_b32_dpp v19, v45, v21 quad_perm:[1,1,1,1] row_mask:0xf bank_mask:0xf
  s_waitcnt vmcnt(9)
  v_mfma_f32_16x16x16_bf16 v[8:11], v[36:37], v[16:17], v[8:11]
  v_mfma_f32_16x16x16_bf16 v[12:15], v[38:39], v[16:17], v[12:15]
  s_bitcmp1_b32 s99, 4
  s_cbranch_scc1 L_td_414
  s_bitcmp1_b32 s99, 0
  s_cbranch_scc1 L_th_413
  s_waitcnt vmcnt(5)
L_th_413:
  s_waitcnt vmcnt(5)
L_td_414:
  buffer_load_dwordx4 v[36:39], v3, s[12:15], s59 offen offset:2048
  v_and_b32_dpp v16, v45, v20 quad_perm:[2,2,2,2] row_mask:0xf bank_mask:0xf
  v_and_b32_dpp v17, v45, v21 quad_perm:[2,2,2,2] row_mask:0xf bank_mask:0xf
  s_waitcnt vmcnt(9)
  v_mfma_f32_16x16x16_bf16 v[8:11], v[64:65], v[18:19], v[8:11]
  v_mfma_f32_16x16x16_bf16 v[12:15], v[66:67], v[18:19], v[12:15]
  s_bitcmp1_b32 s99, 4
  s_cbranch_scc1 L_td_416
  s_bitcmp1_b32 s99, 0
  s_cbranch_scc1 L_th_415
  s_waitcnt vmcnt(5)
L_th_415:
  s_waitcnt vmcnt(6)
L_td_416:
  buffer_load_dwordx4 v[64:67], v3, s[12:15], s59 offen offset:3072
  v_and_b32_dpp v18, v45, v20 quad_perm:[3,3,3,3] row_mask:0xf bank_mask:0xf
  v_and_b32_dpp v19, v45, v21 quad_perm:[3,3,3,3] row_mask:0xf bank_mask:0xf
  s_waitcnt vmcnt(9)
  v_mfma_f32_16x16x16_bf16 v[8:11], v[32:33], v[16:17], v[8:11]
  v_mfma_f32_16x16x16_bf16 v[12:15], v[34:35], v[16:17], v[12:15]
  s_mov_b32 s59, 0x10000
  s_bitcmp1_b32 s99, 4
  s_cbranch_scc1 L_td_418
  s_bitcmp1_b32 s99, 0
  s_cbranch_scc1 L_th_417
  s_waitcnt vmcnt(5)
L_th_417:
  s_waitcnt vmcnt(5)
L_td_418:
  buffer_load_dwordx4 v[32:35], v3, s[12:15], s59 offen offset:0
  v_and_b32_dpp v16, v46, v20 quad_perm:[0,0,0,0] row_mask:0xf bank_mask:0xf
  v_and_b32_dpp v17, v46, v21 quad_perm:[0,0,0,0] row_mask:0xf bank_mask:0xf
  s_waitcnt vmcnt(9)
  v_mfma_f32_16x16x16_bf16 v[8:11], v[68:69], v[18:19], v[8:11]
  v_mfma_f32_16x16x16_bf16 v[12:15], v[70:71], v[18:19], v[12:15]
  s_bitcmp1_b32 s99, 4
  s_cbranch_scc1 L_td_420
  s_bitcmp1_b32 s99, 0
  s_cbranch_scc1 L_th_419
  s_waitcnt vmcnt(5)
L_th_419:
  s_waitcnt vmcnt(6)
L_td_420:
  buffer_load_dwordx4 v[68:71], v3, s[12:15], s59 offen offset:1024
  v_and_b32_dpp v18, v46, v20 quad_perm:[1,1,1,1] row_mask:0xf bank_mask:0xf
  v_and_b32_dpp v19, v46, v21 quad_perm:[1,1,1,1] row_mask:0xf bank_mask:0xf
  s_waitcnt vmcnt(9)
  v_mfma_f32_16x16x16_bf16 v[8:11], v[40:41], v[16:17], v[8:11]
  v_mfma_f32_16x16x16_bf16 v[12:15], v[42:43], v[16:17], v[12:15]
  s_bitcmp1_b32 s99, 4
  s_cbranch_scc1 L_td_422
  s_bitcmp1_b32 s99, 0
  s_cbranch_scc1 L_th_421
  s_waitcnt vmcnt(5)
L_th_421:
  s_waitcnt vmcnt(5)
L_td_422:
  buffer_load_dwordx4 v[40:43], v3, s[12:15], s59 offen offset:2048
  v_and_b32_dpp v16, v46, v20 quad_perm:[2,2,2,2] row_mask:0xf bank_mask:0xf
  v_and_b32_dpp v17, v46, v21 quad_perm:[2,2,2,2] row_mask:0xf bank_mask:0xf
  s_waitcnt vmcnt(9)
  v_mfma_f32_16x16x16_bf16 v[8:11], v[72:73], v[18:19], v[8:11]
  v_mfma_f32_16x16x16_bf16 v[12:15], v[74:75], v[18:19], v[12:15]
  s_bitcmp1_b32 s99, 4
  s_cbranch_scc1 L_td_424
  s_bitcmp1_b32 s99, 0
  s_cbranch_scc1 L_th_423
  s_waitcnt vmcnt(5)
L_th_423:
  s_waitcnt vmcnt(6)
L_td_424:
  buffer_load_dwordx4 v[72:75], v3, s[12:15], s59 offen offset:3072
  v_and_b32_dpp v18, v46, v20 quad_perm:[3,3,3,3] row_mask:0xf bank_mask:0xf
  v_and_b32_dpp v19, v46, v21 quad_perm:[3,3,3,3] row_mask:0xf bank_mask:0xf
  s_waitcnt vmcnt(9)
  v_mfma_f32_16x16x16_bf16 v[8:11], v[76:77], v[16:17], v[8:11]
  v_mfma_f32_16x16x16_bf16 v[12:15], v[78:79], v[16:17], v[12:15]
  s_mov_b32 s59, 0x11000
  s_bitcmp1_b32 s99, 4
  s_cbranch_scc1 L_td_426
  s_bitcmp1_b32 s99, 0
  s_cbranch_scc1 L_th_425
  s_waitcnt vmcnt(5)
L_th_425:
  s_waitcnt vmcnt(5)
L_td_426:
  buffer_load_dwordx4 v[76:79], v3, s[12:15], s59 offen offset:0
  s_waitcnt vmcnt(8)
  s_bitset0_b32 s99, 4
  v_cmp_lt_i32 vcc, 0xb5, v31
  s_bcnt1_i32_b32 s55, vcc_lo
  s_cmp_lt_u32 s55, 22
  s_cbranch_scc1 L_ck_427
  s_bitset1_b32 s99, 4
L_ck_427:
  v_and_b32 v31, 31, v1
  v_lshl_add_u32 v31, v31, 2, s92
  v_mov_b32 v30, 0xc5
  s_cmp_lg_u32 s52, 0
  s_cbranch_scc1 L_w0_428
  s_mov_b64 exec, 0x1
  buffer_store_dword v30, v1, s[48:51], s93 offen
  s_mov_b64 exec, -1
L_w0_428:
  buffer_load_dword v31, v31, s[48:51], 0 offen sc1
  v_and_b32_dpp v16, v47, v20 quad_perm:[0,0,0,0] row_mask:0xf bank_mask:0xf
  v_and_b32_dpp v17, v47, v21 quad_perm:[0,0,0,0] row_mask:0xf bank_mask:0xf
  s_waitcnt vmcnt(9)
  v_mfma_f32_16x16x16_bf16 v[8:11], v[244:245], v[18:19], v[8:11]
  v_mfma_f32_16x16x16_bf16 v[12:15], v[246:247], v[18:19], v[12:15]
  s_bitcmp1_b32 s99, 4
  s_cbranch_scc1 L_td_430
  s_bitcmp1_b32 s99, 0
  s_cbranch_scc1 L_th_429
  s_waitcnt vmcnt(5)
L_th_429:
  s_waitcnt vmcnt(6)
L_td_430:
  buffer_load_dwordx4 v[244:247], v3, s[12:15], s59 offen offset:1024
  v_and_b32_dpp v18, v47, v20 quad_perm:[1,1,1,1] row_mask:0xf bank_mask:0xf
  v_and_b32_dpp v19, v47, v21 quad_perm:[1,1,1,1] row_mask:0xf bank_mask:0xf
  s_waitcnt vmcnt(9)
  v_mfma_f32_16x16x16_bf16 v[8:11], v[248:249], v[16:17], v[8:11]
  v_mfma_f32_16x16x16_bf16 v[12:15], v[250:251], v[16:17], v[12:15]
  s_bitcmp1_b32 s99, 4
  s_cbranch_scc1 L_td_432
  s_bitcmp1_b32 s99, 0
  s_cbranch_scc1 L_th_431
  s_waitcnt vmcnt(5)
L_th_431:
  s_waitcnt vmcnt(5)
L_td_432:
  buffer_load_dwordx4 v[248:251], v3, s[12:15], s59 offen offset:2048
  v_and_b32_dpp v16, v47, v20 quad_perm:[2,2,2,2] row_mask:0xf bank_mask:0xf
  v_and_b32_dpp v17, v47, v21 quad_perm:[2,2,2,2] row_mask:0xf bank_mask:0xf
  s_waitcnt vmcnt(9)
  v_mfma_f32_16x16x16_bf16 v[8:11], v[252:253], v[18:19], v[8:11]
  v_mfma_f32_16x16x16_bf16 v[12:15], v[254:255], v[18:19], v[12:15]
  s_bitcmp1_b32 s99, 4
  s_cbranch_scc1 L_td_434
  s_bitcmp1_b32 s99, 0
  s_cbranch_scc1 L_th_433
  s_waitcnt vmcnt(5)
L_th_433:
  s_waitcnt vmcnt(6)
L_td_434:
  buffer_load_dwordx4 v[252:255], v3, s[12:15], s59 offen offset:3072
  v_and_b32_dpp v18, v47, v20 quad_perm:[3,3,3,3] row_mask:0xf bank_mask:0xf
  v_and_b32_dpp v19, v47, v21 quad_perm:[3,3,3,3] row_mask:0xf bank_mask:0xf
  s_waitcnt vmcnt(9)
  v_mfma_f32_16x16x16_bf16 v[8:11], v[36:37], v[16:17], v[8:11]
  v_mfma_f32_16x16x16_bf16 v[12:15], v[38:39], v[16:17], v[12:15]
  s_mov_b32 s59, 0x12000
  s_bitcmp1_b32 s99, 4
  s_cbranch_scc1 L_td_436
  s_bitcmp1_b32 s99, 0
  s_cbranch_scc1 L_th_435
  s_waitcnt vmcnt(5)
L_th_435:
  s_waitcnt vmcnt(5)
L_td_436:
  buffer_load_dwordx4 v[36:39], v3, s[12:15], s59 offen offset:0
  v_and_b32_dpp v16, v48, v20 quad_perm:[0,0,0,0] row_mask:0xf bank_mask:0xf
  v_and_b32_dpp v17, v48, v21 quad_perm:[0,0,0,0] row_mask:0xf bank_mask:0xf
  s_waitcnt vmcnt(9)
  v_mfma_f32_16x16x16_bf16 v[8:11], v[64:65], v[18:19], v[8:11]
  v_mfma_f32_16x16x16_bf16 v[12:15], v[66:67], v[18:19], v[12:15]
  s_bitcmp1_b32 s99, 4
  s_cbranch_scc1 L_td_438
  s_bitcmp1_b32 s99, 0
  s_cbranch_scc1 L_th_437
  s_waitcnt vmcnt(5)
L_th_437:
  s_waitcnt vmcnt(6)
L_td_438:
  buffer_load_dwordx4 v[44:47], v3, s[12:15], s59 offen offset:1024
  s_bitcmp1_b32 s99, 4
  s_cbranch_scc1 L_td_440
  s_bitcmp1_b32 s99, 0
  s_cbranch_scc1 L_th_439
  s_waitcnt vmcnt(5)
L_th_439:
  s_waitcnt vmcnt(5)
L_td_440:
  buffer_load_dwordx4 v[64:67], v3, s[12:15], s59 offen offset:2048
  v_and_b32_dpp v18, v48, v20 quad_perm:[1,1,1,1] row_mask:0xf bank_mask:0xf
  v_and_b32_dpp v19, v48, v21 quad_perm:[1,1,1,1] row_mask:0xf bank_mask:0xf
  s_waitcnt vmcnt(10)
  v_mfma_f32_16x16x16_bf16 v[8:11], v[32:33], v[16:17], v[8:11]
  v_mfma_f32_16x16x16_bf16 v[12:15], v[34:35], v[16:17], v[12:15]
  s_bitcmp1_b32 s99, 4
  s_cbranch_scc1 L_td_442
  s_bitcmp1_b32 s99, 0
  s_cbranch_scc1 L_th_441
  s_waitcnt vmcnt(5)
L_th_441:
  s_waitcnt vmcnt(6)
L_td_442:
  buffer_load_dwordx4 v[32:35], v3, s[12:15], s59 offen offset:3072
  v_and_b32_dpp v16, v48, v20 quad_perm:[2,2,2,2] row_mask:0xf bank_mask:0xf
  v_and_b32_dpp v17, v48, v21 quad_perm:[2,2,2,2] row_mask:0xf bank_mask:0xf
  s_waitcnt vmcnt(10)
  v_mfma_f32_16x16x16_bf16 v[8:11], v[68:69], v[18:19], v[8:11]
  v_mfma_f32_16x16x16_bf16 v[12:15], v[70:71], v[18:19], v[12:15]
  s_mov_b32 s59, 0x13000
  s_bitcmp1_b32 s99, 4
  s_cbranch_scc1 L_td_444
  s_bitcmp1_b32 s99, 0
  s_cbranch_scc1 L_th_443
  s_waitcnt vmcnt(5)
L_th_443:
  s_waitcnt vmcnt(5)
L_td_444:
  buffer_load_dwordx4 v[68:71], v3, s[12:15], s59 offen offset:0
  s_waitcnt vmcnt(8)
  s_bitset0_b32 s99, 4
  v_cmp_lt_i32 vcc, 0xbd, v31
  s_bcnt1_i32_b32 s55, vcc_lo
  s_cmp_lt_u32 s55, 22
  s_cbranch_scc1 L_ck_445
  s_bitset1_b32 s99, 4
L_ck_445:
  v_and_b32 v31, 31, v1
  v_lshl_add_u32 v31, v31, 2, s92
  v_mov_b32 v30, 0xcd
  s_cmp_lg_u32 s52, 0
  s_cbranch_scc1 L_w0_446
  s_mov_b64 exec, 0x1
  buffer_store_dword v30, v1, s[48:51], s93 offen
  s_mov_b64 exec, -1
L_w0_446:
  buffer_load_dword v31, v31, s[48:51], 0 offen sc1
  v_and_b32_dpp v18, v48, v20 quad_perm:[3,3,3,3] row_mask:0xf bank_mask:0xf
  v_and_b32_dpp v19, v48, v21 quad_perm:[3,3,3,3] row_mask:0xf bank_mask:0xf
  s_waitcnt vmcnt(10)
  v_mfma_f32_16x16x16_bf16 v[8:11], v[40:41], v[16:17], v[8:11]
  v_mfma_f32_16x16x16_bf16 v[12:15], v[42:43], v[16:17], v[12:15]
  s_bitcmp1_b32 s99, 4
  s_cbranch_scc1 L_td_448
  s_bitcmp1_b32 s99, 0
  s_cbranch_scc1 L_th_447
  s_waitcnt vmcnt(5)
L_th_447:
  s_waitcnt vmcnt(6)
L_td_448:
  buffer_load_dwordx4 v[40:43], v3, s[12:15], s59 offen offset:1024
  v_and_b32_dpp v16, v49, v20 quad_perm:[0,0,0,0] row_mask:0xf bank_mask:0xf
  v_and_b32_dpp v17, v49, v21 quad_perm:[0,0,0,0] row_mask:0xf bank_mask:0xf
  s_waitcnt vmcnt(10)
  v_mfma_f32_16x16x16_bf16 v[8:11], v[72:73], v[18:19], v[8:11]
  v_mfma_f32_16x16x16_bf16 v[12:15], v[74:75], v[18:19], v[12:15]
  s_bitcmp1_b32 s99, 4
  s_cbranch_scc1 L_td_450
  s_bitcmp1_b32 s99, 0
  s_cbranch_scc1 L_th_449
  s_waitcnt vmcnt(5)
L_th_449:
  s_waitcnt vmcnt(5)
L_td_450:
  buffer_load_dwordx4 v[72:75], v3, s[12:15], s59 offen offset:2048
  v_and_b32_dpp v18, v49, v20 quad_perm:[1,1,1,1] row_mask:0xf bank_mask:0xf
  v_and_b32_dpp v19, v49, v21 quad_perm:[1,1,1,1] row_mask:0xf bank_mask:0xf
  s_waitcnt vmcnt(10)
  v_mfma_f32_16x16x16_bf16 v[8:11], v[76:77], v[16:17], v[8:11]
  v_mfma_f32_16x16x16_bf16 v[12:15], v[78:79], v[16:17], v[12:15]
  s_bitcmp1_b32 s99, 4
  s_cbranch_scc1 L_td_452
  s_bitcmp1_b32 s99, 0
  s_cbranch_scc1 L_th_451
  s_waitcnt vmcnt(5)
L_th_451:
  s_waitcnt vmcnt(6)
L_td_452:
  buffer_load_dwordx4 v[76:79], v3, s[12:15], s59 offen offset:3072
  v_and_b32_dpp v16, v49, v20 quad_perm:[2,2,2,2] row_mask:0xf bank_mask:0xf
  v_and_b32_dpp v17, v49, v21 quad_perm:[2,2,2,2] row_mask:0xf bank_mask:0xf
  s_waitcnt vmcnt(10)
  v_mfma_f32_16x16x16_bf16 v[8:11], v[244:245], v[18:19], v[8:11]
  v_mfma_f32_16x16x16_bf16 v[12:15], v[246:247], v[18:19], v[12:15]
  s_mov_b32 s59, 0x14000
  s_bitcmp1_b32 s99, 4
  s_cbranch_scc1 L_td_454
  s_bitcmp1_b32 s99, 0
  s_cbranch_scc1 L_th_453
  s_waitcnt vmcnt(5)
L_th_453:
  s_waitcnt vmcnt(5)
L_td_454:
  buffer_load_dwordx4 v[244:247], v3, s[12:15], s59 offen offset:0
  v_and_b32_dpp v18, v49, v20 quad_perm:[3,3,3,3] row_mask:0xf bank_mask:0xf
  v_and_b32_dpp v19, v49, v21 quad_perm:[3,3,3,3] row_mask:0xf bank_mask:0xf
  s_waitcnt vmcnt(10)
  v_mfma_f32_16x16x16_bf16 v[8:11], v[248:249], v[16:17], v[8:11]
  v_mfma_f32_16x16x16_bf16 v[12:15], v[250:251], v[16:17], v[12:15]
  s_bitcmp1_b32 s99, 4
  s_cbranch_scc1 L_td_456
  s_bitcmp1_b32 s99, 0
  s_cbranch_scc1 L_th_455
  s_waitcnt vmcnt(5)
L_th_455:
  s_waitcnt vmcnt(6)
L_td_456:
  buffer_load_dwordx4 v[248:251], v3, s[12:15], s59 offen offset:1024
  v_and_b32_dpp v16, v50, v20 quad_perm:[0,0,0,0] row_mask:0xf bank_mask:0xf
  v_and_b32_dpp v17, v50, v21 quad_perm:[0,0,0,0] row_mask:0xf bank_mask:0xf
  s_waitcnt vmcnt(10)
  v_mfma_f32_16x16x16_bf16 v[8:11], v[252:253], v[18:19], v[8:11]
  v_mfma_f32_16x16x16_bf16 v[12:15], v[254:255], v[18:19], v[12:15]
  s_bitcmp1_b32 s99, 4
  s_cbranch_scc1 L_td_458
  s_bitcmp1_b32 s99, 0
  s_cbranch_scc1 L_th_457
  s_waitcnt vmcnt(5)
L_th_457:
  s_waitcnt vmcnt(5)
L_td_458:
  buffer_load_dwordx4 v[252:255], v3, s[12:15], s59 offen offset:2048
  v_and_b32_dpp v18, v50, v20 quad_perm:[1,1,1,1] row_mask:0xf bank_mask:0xf
  v_and_b32_dpp v19, v50, v21 quad_perm:[1,1,1,1] row_mask:0xf bank_mask:0xf
  s_waitcnt vmcnt(10)
  v_mfma_f32_16x16x16_bf16 v[8:11], v[36:37], v[16:17], v[8:11]
  v_mfma_f32_16x16x16_bf16 v[12:15], v[38:39], v[16:17], v[12:15]
  s_bitcmp1_b32 s99, 4
  s_cbranch_scc1 L_td_460
  s_bitcmp1_b32 s99, 0
  s_cbranch_scc1 L_th_459
  s_waitcnt vmcnt(5)
L_th_459:
  s_waitcnt vmcnt(6)
L_td_460:
  buffer_load_dwordx4 v[36:39], v3, s[12:15], s59 offen offset:3072
  v_and_b32_dpp v16, v50, v20 quad_perm:[2,2,2,2] row_mask:0xf bank_mask:0xf
  v_and_b32_dpp v17, v50, v21 quad_perm:[2,2,2,2] row_mask:0xf bank_mask:0xf
  s_waitcnt vmcnt(10)
  v_mfma_f32_16x16x16_bf16 v[8:11], v[44:45], v[18:19], v[8:11]
  v_mfma_f32_16x16x16_bf16 v[12:15], v[46:47], v[18:19], v[12:15]
  s_mov_b32 s59, 0x15000
  s_bitcmp1_b32 s99, 4
  s_cbranch_scc1 L_td_462
  s_bitcmp1_b32 s99, 0
  s_cbranch_scc1 L_th_461
  s_waitcnt vmcnt(5)
L_th_461:
  s_waitcnt vmcnt(5)
L_td_462:
  buffer_load_dwordx4 v[44:47], v3, s[12:15], s59 offen offset:0
  s_waitcnt vmcnt(8)
  s_bitset0_b32 s99, 4
  v_cmp_lt_i32 vcc, 0xc5, v31
  s_bcnt1_i32_b32 s55, vcc_lo
  s_cmp_lt_u32 s55, 22
  s_cbranch_scc1 L_ck_463
  s_bitset1_b32 s99, 4
L_ck_463:
  v_and_b32 v31, 31, v1
  v_lshl_add_u32 v31, v31, 2, s92
  v_mov_b32 v30, 0xd5
  s_cmp_lg_u32 s52, 0
  s_cbranch_scc1 L_w0_464
  s_mov_b64 exec, 0x1
  buffer_store_dword v30, v1, s[48:51], s93 offen
  s_mov_b64 exec, -1
L_w0_464:
  buffer_load_dword v31, v31, s[48:51], 0 offen sc1
  v_and_b32_dpp v18, v50, v20 quad_perm:[3,3,3,3] row_mask:0xf bank_mask:0xf
  v_and_b32_dpp v19, v50, v21 quad_perm:[3,3,3,3] row_mask:0xf bank_mask:0xf
  s_waitcnt vmcnt(10)
  v_mfma_f32_16x16x16_bf16 v[8:11], v[64:65], v[16:17], v[8:11]
  v_mfma_f32_16x16x16_bf16 v[12:15], v[66:67], v[16:17], v[12:15]
  s_bitcmp1_b32 s99, 4
  s_cbranch_scc1 L_td_466
  s_bitcmp1_b32 s99, 0
  s_cbranch_scc1 L_th_465
  s_waitcnt vmcnt(5)
L_th_465:
  s_waitcnt vmcnt(6)
L_td_466:
  buffer_load_dwordx4 v[64:67], v3, s[12:15], s59 offen offset:1024
  v_and_b32_dpp v16, v51, v20 quad_perm:[0,0,0,0] row_mask:0xf bank_mask:0xf
  v_and_b32_dpp v17, v51, v21 quad_perm:[0,0,0,0] row_mask:0xf bank_mask:0xf
  s_waitcnt vmcnt(10)
  v_mfma_f32_16x16x16_bf16 v[8:11], v[32:33], v[18:19], v[8:11]
  v_mfma_f32_16x16x16_bf16 v[12:15], v[34:35], v[18:19], v[12:15]
  s_bitcmp1_b32 s99, 4
  s_cbranch_scc1 L_td_468
  s_bitcmp1_b32 s99, 0
  s_cbranch_scc1 L_th_467
  s_waitcnt vmcnt(5)
L_th_467:
  s_waitcnt vmcnt(5)
L_td_468:
  buffer_load_dwordx4 v[32:35], v3, s[12:15], s59 offen offset:2048
  v_and_b32_dpp v18, v51, v20 quad_perm:[1,1,1,1] row_mask:0xf bank_mask:0xf
  v_and_b32_dpp v19, v51, v21 quad_perm:[1,1,1,1] row_mask:0xf bank_mask:0xf
  s_waitcnt vmcnt(10)
  v_mfma_f32_16x16x16_bf16 v[8:11], v[68:69], v[16:17], v[8:11]
  v_mfma_f32_16x16x16_bf16 v[12:15], v[70:71], v[16:17], v[12:15]
  s_bitcmp1_b32 s99, 4
  s_cbranch_scc1 L_td_470
  s_bitcmp1_b32 s99, 0
  s_cbranch_scc1 L_th_469
  s_waitcnt vmcnt(5)
L_th_469:
  s_waitcnt vmcnt(6)
L_td_470:
  buffer_load_dwordx4 v[68:71], v3, s[12:15], s59 offen offset:3072
  v_and_b32_dpp v16, v51, v20 quad_perm:[2,2,2,2] row_mask:0xf bank_mask:0xf
  v_and_b32_dpp v17, v51, v21 quad_perm:[2,2,2,2] row_mask:0xf bank_mask:0xf
  s_waitcnt vmcnt(10)
  v_mfma_f32_16x16x16_bf16 v[8:11], v[40:41], v[18:19], v[8:11]
  v_mfma_f32_16x16x16_bf16 v[12:15], v[42:43], v[18:19], v[12:15]
  s_mov_b32 s59, 0x16000
  s_bitcmp1_b32 s99, 4
  s_cbranch_scc1 L_td_472
  s_bitcmp1_b32 s99, 0
  s_cbranch_scc1 L_th_471
  s_waitcnt vmcnt(5)
L_th_471:
  s_waitcnt vmcnt(5)
L_td_472:
  buffer_load_dwordx4 v[40:43], v3, s[12:15], s59 offen offset:0
  v_and_b32_dpp v18, v51, v20 quad_perm:[3,3,3,3] row_mask:0xf bank_mask:0xf
  v_and_b32_dpp v19, v51, v21 quad_perm:[3,3,3,3] row_mask:0xf bank_mask:0xf
  s_waitcnt vmcnt(10)
  v_mfma_f32_16x16x16_bf16 v[8:11], v[72:73], v[16:17], v[8:11]
  v_mfma_f32_16x16x16_bf16 v[12:15], v[74:75], v[16:17], v[12:15]
  s_bitcmp1_b32 s99, 4
  s_cbranch_scc1 L_td_474
  s_bitcmp1_b32 s99, 0
  s_cbranch_scc1 L_th_473
  s_waitcnt vmcnt(5)
L_th_473:
  s_waitcnt vmcnt(6)
L_td_474:
  buffer_load_dwordx4 v[72:75], v3, s[12:15], s59 offen offset:1024
  v_and_b32_dpp v16, v52, v20 quad_perm:[0,0,0,0] row_mask:0xf bank_mask:0xf
  v_and_b32_dpp v17, v52, v21 quad_perm:[0,0,0,0] row_mask:0xf bank_mask:0xf
  s_waitcnt vmcnt(10)
  v_mfma_f32_16x16x16_bf16 v[8:11], v[76:77], v[18:19], v[8:11]
  v_mfma_f32_16x16x16_bf16 v[12:15], v[78:79], v[18:19], v[12:15]
  s_bitcmp1_b32 s99, 4
  s_cbranch_scc1 L_td_476
  s_bitcmp1_b32 s99, 0
  s_cbranch_scc1 L_th_475
  s_waitcnt vmcnt(5)
L_th_475:
  s_waitcnt vmcnt(5)
L_td_476:
  buffer_load_dwordx4 v[48:51], v3, s[12:15], s59 offen offset:2048
  s_bitcmp1_b32 s99, 4
  s_cbranch_scc1 L_td_478
  s_bitcmp1_b32 s99, 0
  s_cbranch_scc1 L_th_477
  s_waitcnt vmcnt(5)
L_th_477:
  s_waitcnt vmcnt(6)
L_td_478:
  buffer_load_dwordx4 v[76:79], v3, s[12:15], s59 offen offset:3072
  v_and_b32_dpp v18, v52, v20 quad_perm:[1,1,1,1] row_mask:0xf bank_mask:0xf
  v_and_b32_dpp v19, v52, v21 quad_perm:[1,1,1,1] row_mask:0xf bank_mask:0xf
  s_waitcnt vmcnt(11)
  v_mfma_f32_16x16x16_bf16 v[8:11], v[244:245], v[16:17], v[8:11]
  v_mfma_f32_16x16x16_bf16 v[12:15], v[246:247], v[16:17], v[12:15]
  s_mov_b32 s59, 0x17000
  s_bitcmp1_b32 s99, 4
  s_cbranch_scc1 L_td_480
  s_bitcmp1_b32 s99, 0
  s_cbranch_scc1 L_th_479
  s_waitcnt vmcnt(5)
L_th_479:
  s_waitcnt vmcnt(5)
L_td_480:
  buffer_load_dwordx4 v[244:247], v3, s[12:15], s59 offen offset:0
  s_waitcnt vmcnt(8)
  s_bitset0_b32 s99, 4
  v_cmp_lt_i32 vcc, 0xcd, v31
  s_bcnt1_i32_b32 s55, vcc_lo
  s_cmp_lt_u32 s55, 22
  s_cbranch_scc1 L_ck_481
  s_bitset1_b32 s99, 4
L_ck_481:
  v_and_b32 v31, 31, v1
  v_lshl_add_u32 v31, v31, 2, s92
  v_mov_b32 v30, 0xdd
  s_cmp_lg_u32 s52, 0
  s_cbranch_scc1 L_w0_482
  s_mov_b64 exec, 0x1
  buffer_store_dword v30, v1, s[48:51], s93 offen
  s_mov_b64 exec, -1
L_w0_482:
  buffer_load_dword v31, v31, s[48:51], 0 offen sc1
  v_and_b32_dpp v16, v52, v20 quad_perm:[2,2,2,2] row_mask:0xf bank_mask:0xf
  v_and_b32_dpp v17, v52, v21 quad_perm:[2,2,2,2] row_mask:0xf bank_mask:0xf
  s_waitcnt vmcnt(11)
  v_mfma_f32_16x16x16_bf16 v[8:11], v[248:249], v[18:19], v[8:11]
  v_mfma_f32_16x16x16_bf16 v[12:15], v[250:251], v[18:19], v[12:15]
  s_bitcmp1_b32 s99, 4
  s_cbranch_scc1 L_td_484
  s_bitcmp1_b32 s99, 0
  s_cbranch_scc1 L_th_483
  s_waitcnt vmcnt(5)
L_th_483:
  s_waitcnt vmcnt(6)
L_td_484:
  buffer_load_dwordx4 v[248:251], v3, s[12:15], s59 offen offset:1024
  v_and_b32_dpp v18, v52, v20 quad_perm:[3,3,3,3] row_mask:0xf bank_mask:0xf
  v_and_b32_dpp v19, v52, v21 quad_perm:[3,3,3,3] row_mask:0xf bank_mask:0xf
  s_waitcnt vmcnt(11)
  v_mfma_f32_16x16x16_bf16 v[8:11], v[252:253], v[16:17], v[8:11]
  v_mfma_f32_16x16x16_bf16 v[12:15], v[254:255], v[16:17], v[12:15]
  s_bitcmp1_b32 s99, 4
  s_cbranch_scc1 L_td_486
  s_bitcmp1_b32 s99, 0
  s_cbranch_scc1 L_th_485
  s_waitcnt vmcnt(5)
L_th_485:
  s_waitcnt vmcnt(5)
L_td_486:
  buffer_load_dwordx4 v[252:255], v3, s[12:15], s59 offen offset:2048
  v_and_b32_dpp v16, v53, v20 quad_perm:[0,0,0,0] row_mask:0xf bank_mask:0xf
  v_and_b32_dpp v17, v53, v21 quad_perm:[0,0,0,0] row_mask:0xf bank_mask:0xf
  s_waitcnt vmcnt(11)
  v_mfma_f32_16x16x16_bf16 v[8:11], v[36:37], v[18:19], v[8:11]
  v_mfma_f32_16x16x16_bf16 v[12:15], v[38:39], v[18:19], v[12:15]
  s_bitcmp1_b32 s99, 4
  s_cbranch_scc1 L_td_488
  s_bitcmp1_b32 s99, 0
  s_cbranch_scc1 L_th_487
  s_waitcnt vmcnt(5)
L_th_487:
  s_waitcnt vmcnt(6)
L_td_488:
  buffer_load_dwordx4 v[36:39], v3, s[12:15], s59 offen offset:3072
  v_and_b32_dpp v18, v53, v20 quad_perm:[1,1,1,1] row_mask:0xf bank_mask:0xf
  v_and_b32_dpp v19, v53, v21 quad_perm:[1,1,1,1] row_mask:0xf bank_mask:0xf
  s_waitcnt vmcnt(11)
  v_mfma_f32_16x16x16_bf16 v[8:11], v[44:45], v[16:17], v[8:11]
  v_mfma_f32_16x16x16_bf16 v[12:15], v[46:47], v[16:17], v[12:15]
  s_mov_b32 s59, 0x18000
  s_bitcmp1_b32 s99, 4
  s_cbranch_scc1 L_td_490
  s_bitcmp1_b32 s99, 0
  s_cbranch_scc1 L_th_489
  s_waitcnt vmcnt(5)
L_th_489:
  s_waitcnt vmcnt(5)
L_td_490:
  buffer_load_dwordx4 v[44:47], v3, s[12:15], s59 offen offset:0
  v_and_b32_dpp v16, v53, v20 quad_perm:[2,2,2,2] row_mask:0xf bank_mask:0xf
  v_and_b32_dpp v17, v53, v21 quad_perm:[2,2,2,2] row_mask:0xf bank_mask:0xf
  s_waitcnt vmcnt(11)
  v_mfma_f32_16x16x16_bf16 v[8:11], v[64:65], v[18:19], v[8:11]
  v_mfma_f32_16x16x16_bf16 v[12:15], v[66:67], v[18:19], v[12:15]
  s_bitcmp1_b32 s99, 4
  s_cbranch_scc1 L_td_492
  s_bitcmp1_b32 s99, 0
  s_cbranch_scc1 L_th_491
  s_waitcnt vmcnt(5)
L_th_491:
  s_waitcnt vmcnt(6)
L_td_492:
  buffer_load_dwordx4 v[64:67], v3, s[12:15], s59 offen offset:1024
  v_and_b32_dpp v18, v53, v20 quad_perm:[3,3,3,3] row_mask:0xf bank_mask:0xf
  v_and_b32_dpp v19, v53, v21 quad_perm:[3,3,3,3] row_mask:0xf bank_mask:0xf
  s_waitcnt vmcnt(11)
  v_mfma_f32_16x16x16_bf16 v[8:11], v[32:33], v[16:17], v[8:11]
  v_mfma_f32_16x16x16_bf16 v[12:15], v[34:35], v[16:17], v[12:15]
  s_bitcmp1_b32 s99, 4
  s_cbranch_scc1 L_td_494
  s_bitcmp1_b32 s99, 0
  s_cbranch_scc1 L_th_493
  s_waitcnt vmcnt(5)
L_th_493:
  s_waitcnt vmcnt(5)
L_td_494:
  buffer_load_dwordx4 v[32:35], v3, s[12:15], s59 offen offset:2048
  v_and_b32_dpp v16, v54, v20 quad_perm:[0,0,0,0] row_mask:0xf bank_mask:0xf
  v_and_b32_dpp v17, v54, v21 quad_perm:[0,0,0,0] row_mask:0xf bank_mask:0xf
  s_waitcnt vmcnt(11)
  v_mfma_f32_16x16x16_bf16 v[8:11], v[68:69], v[18:19], v[8:11]
  v_mfma_f32_16x16x16_bf16 v[12:15], v[70:71], v[18:19], v[12:15]
  s_bitcmp1_b32 s99, 4
  s_cbranch_scc1 L_td_496
  s_bitcmp1_b32 s99, 0
  s_cbranch_scc1 L_th_495
  s_waitcnt vmcnt(5)
L_th_495:
  s_waitcnt vmcnt(6)
L_td_496:
  buffer_load_dwordx4 v[68:71], v3, s[12:15], s59 offen offset:3072
  v_and_b32_dpp v18, v54, v20 quad_perm:[1,1,1,1] row_mask:0xf bank_mask:0xf
  v_and_b32_dpp v19, v54, v21 quad_perm:[1,1,1,1] row_mask:0xf bank_mask:0xf
  s_waitcnt vmcnt(11)
  v_mfma_f32_16x16x16_bf16 v[8:11], v[40:41], v[16:17], v[8:11]
  v_mfma_f32_16x16x16_bf16 v[12:15], v[42:43], v[16:17], v[12:15]
  s_mov_b32 s59, 0x19000
  s_bitcmp1_b32 s99, 4
  s_cbranch_scc1 L_td_498
  s_bitcmp1_b32 s99, 0
  s_cbranch_scc1 L_th_497
  s_waitcnt vmcnt(5)
L_th_497:
  s_waitcnt vmcnt(5)
L_td_498:
  buffer_load_dwordx4 v[40:43], v3, s[12:15], s59 offen offset:0
  s_waitcnt vmcnt(8)
  s_bitset0_b32 s99, 4
  v_cmp_lt_i32 vcc, 0xd5, v31
  s_bcnt1_i32_b32 s55, vcc_lo
  s_cmp_lt_u32 s55, 22
  s_cbranch_scc1 L_ck_499
  s_bitset1_b32 s99, 4
L_ck_499:
  v_and_b32 v31, 31, v1
  v_lshl_add_u32 v31, v31, 2, s92
  v_mov_b32 v30, 0xe5
  s_cmp_lg_u32 s52, 0
  s_cbranch_scc1 L_w0_500
  s_mov_b64 exec, 0x1
  buffer_store_dword v30, v1, s[48:51], s93 offen
  s_mov_b64 exec, -1
L_w0_500:
  buffer_load_dword v31, v31, s[48:51], 0 offen sc1
  v_and_b32_dpp v16, v54, v20 quad_perm:[2,2,2,2] row_mask:0xf bank_mask:0xf
  v_and_b32_dpp v17, v54, v21 quad_perm:[2,2,2,2] row_mask:0xf bank_mask:0xf
  s_waitcnt vmcnt(11)
  v_mfma_f32_16x16x16_bf16 v[8:11], v[72:73], v[18:19], v[8:11]
  v_mfma_f32_16x16x16_bf16 v[12:15], v[74:75], v[18:19], v[12:15]
  s_bitcmp1_b32 s99, 4
  s_cbranch_scc1 L_td_502
  s_bitcmp1_b32 s99, 0
  s_cbranch_scc1 L_th_501
  s_waitcnt vmcnt(5)
L_th_501:
  s_waitcnt vmcnt(6)
L_td_502:
  buffer_load_dwordx4 v[72:75], v3, s[12:15], s59 offen offset:1024
  v_and_b32_dpp v18, v54, v20 quad_perm:[3,3,3,3] row_mask:0xf bank_mask:0xf
  v_and_b32_dpp v19, v54, v21 quad_perm:[3,3,3,3] row_mask:0xf bank_mask:0xf
  s_waitcnt vmcnt(11)
  v_mfma_f32_16x16x16_bf16 v[8:11], v[48:49], v[16:17], v[8:11]
  v_mfma_f32_16x16x16_bf16 v[12:15], v[50:51], v[16:17], v[12:15]
  s_bitcmp1_b32 s99, 4
  s_cbranch_scc1 L_td_504
  s_bitcmp1_b32 s99, 0
  s_cbranch_scc1 L_th_503
  s_waitcnt vmcnt(5)
L_th_503:
  s_waitcnt vmcnt(5)
L_td_504:
  buffer_load_dwordx4 v[48:51], v3, s[12:15], s59 offen offset:2048
  v_and_b32_dpp v16, v55, v20 quad_perm:[0,0,0,0] row_mask:0xf bank_mask:0xf
  v_and_b32_dpp v17, v55, v21 quad_perm:[0,0,0,0] row_mask:0xf bank_mask:0xf
  s_waitcnt vmcnt(11)
  v_mfma_f32_16x16x16_bf16 v[8:11], v[76:77], v[18:19], v[8:11]
  v_mfma_f32_16x16x16_bf16 v[12:15], v[78:79], v[18:19], v[12:15]
  s_bitcmp1_b32 s99, 4
  s_cbranch_scc1 L_td_506
  s_bitcmp1_b32 s99, 0
  s_cbranch_scc1 L_th_505
  s_waitcnt vmcnt(5)
L_th_505:
  s_waitcnt vmcnt(6)
L_td_506:
  buffer_load_dwordx4 v[76:79], v3, s[12:15], s59 offen offset:3072
  s_waitcnt vmcnt(3)
  s_bitset0_b32 s99, 4
  v_and_b32_dpp v18, v55, v20 quad_perm:[1,1,1,1] row_mask:0xf bank_mask:0xf
  v_and_b32_dpp v19, v55, v21 quad_perm:[1,1,1,1] row_mask:0xf bank_mask:0xf
  s_waitcnt vmcnt(11)
  v_mfma_f32_16x16x16_bf16 v[8:11], v[244:245], v[16:17], v[8:11]
  v_mfma_f32_16x16x16_bf16 v[12:15], v[246:247], v[16:17], v[12:15]
  s_mov_b32 s59, 0x1a000
  s_bitcmp1_b32 s99, 0
  s_cbranch_scc1 L_th_507
  s_waitcnt vmcnt(5)
L_th_507:
  s_waitcnt vmcnt(5)
  buffer_load_dwordx4 v[244:247], v3, s[12:15], s59 offen offset:0
  v_and_b32_dpp v16, v55, v20 quad_perm:[2,2,2,2] row_mask:0xf bank_mask:0xf
  v_and_b32_dpp v17, v55, v21 quad_perm:[2,2,2,2] row_mask:0xf bank_mask:0xf
  s_waitcnt vmcnt(11)
  v_mfma_f32_16x16x16_bf16 v[8:11], v[248:249], v[18:19], v[8:11]
  v_mfma_f32_16x16x16_bf16 v[12:15], v[250:251], v[18:19], v[12:15]
  s_bitcmp1_b32 s99, 0
  s_cbranch_scc1 L_th_509
  s_waitcnt vmcnt(5)
L_th_509:
  s_waitcnt vmcnt(6)
  buffer_load_dwordx4 v[248:251], v3, s[12:15], s59 offen offset:1024
  v_and_b32_dpp v18, v55, v20 quad_perm:[3,3,3,3] row_mask:0xf bank_mask:0xf
  v_and_b32_dpp v19, v55, v21 quad_perm:[3,3,3,3] row_mask:0xf bank_mask:0xf
  s_waitcnt vmcnt(11)
  v_mfma_f32_16x16x16_bf16 v[8:11], v[252:253], v[16:17], v[8:11]
  v_mfma_f32_16x16x16_bf16 v[12:15], v[254:255], v[16:17], v[12:15]
  s_bitcmp1_b32 s99, 0
  s_cbranch_scc1 L_th_511
  s_waitcnt vmcnt(5)
L_th_511:
  s_waitcnt vmcnt(5)
  buffer_load_dwordx4 v[252:255], v3, s[12:15], s59 offen offset:2048
  v_and_b32_dpp v16, v56, v20 quad_perm:[0,0,0,0] row_mask:0xf bank_mask:0xf
  v_and_b32_dpp v17, v56, v21 quad_perm:[0,0,0,0] row_mask:0xf bank_mask:0xf
  s_waitcnt vmcnt(11)
  v_mfma_f32_16x16x16_bf16 v[8:11], v[36:37], v[18:19], v[8:11]
  v_mfma_f32_16x16x16_bf16 v[12:15], v[38:39], v[18:19], v[12:15]
  s_bitcmp1_b32 s99, 0
  s_cbranch_scc1 L_th_513
  s_waitcnt vmcnt(5)
L_th_513:
  s_waitcnt vmcnt(6)
  buffer_load_dwordx4 v[36:39], v3, s[12:15], s59 offen offset:3072
  s_mov_b32 s59, 0x1b000
  s_bitcmp1_b32 s99, 0
  s_cbranch_scc1 L_th_515
  s_waitcnt vmcnt(5)
L_th_515:
  s_waitcnt vmcnt(5)
  buffer_load_dwordx4 v[52:55], v3, s[12:15], s59 offen offset:0
  v_and_b32_dpp v18, v56, v20 quad_perm:[1,1,1,1] row_mask:0xf bank_mask:0xf
  v_and_b32_dpp v19, v56, v21 quad_perm:[1,1,1,1] row_mask:0xf bank_mask:0xf
  s_waitcnt vmcnt(12)
  v_mfma_f32_16x16x16_bf16 v[8:11], v[44:45], v[16:17], v[8:11]
  v_mfma_f32_16x16x16_bf16 v[12:15], v[46:47], v[16:17], v[12:15]
  s_bitcmp1_b32 s99, 0
  s_cbranch_scc1 L_th_517
  s_waitcnt vmcnt(5)
L_th_517:
  s_waitcnt vmcnt(6)
  buffer_load_dwordx4 v[44:47], v3, s[12:15], s59 offen offset:1024
  v_and_b32_dpp v16, v56, v20 quad_perm:[2,2,2,2] row_mask:0xf bank_mask:0xf
  v_and_b32_dpp v17, v56, v21 quad_perm:[2,2,2,2] row_mask:0xf bank_mask:0xf
  s_waitcnt vmcnt(12)
  v_mfma_f32_16x16x16_bf16 v[8:11], v[64:65], v[18:19], v[8:11]
  v_mfma_f32_16x16x16_bf16 v[12:15], v[66:67], v[18:19], v[12:15]
  s_bitcmp1_b32 s99, 0
  s_cbranch_scc1 L_th_519
  s_waitcnt vmcnt(5)
L_th_519:
  s_waitcnt vmcnt(5)
  buffer_load_dwordx4 v[64:67], v3, s[12:15], s59 offen offset:2048
  v_and_b32_dpp v18, v56, v20 quad_perm:[3,3,3,3] row_mask:0xf bank_mask:0xf
  v_and_b32_dpp v19, v56, v21 quad_perm:[3,3,3,3] row_mask:0xf bank_mask:0xf
  s_waitcnt vmcnt(12)
  v_mfma_f32_16x16x16_bf16 v[8:11], v[32:33], v[16:17], v[8:11]
  v_mfma_f32_16x16x16_bf16 v[12:15], v[34:35], v[16:17], v[12:15]
  s_bitcmp1_b32 s99, 0
  s_cbranch_scc1 L_th_521
  s_waitcnt vmcnt(5)
L_th_521:
  s_waitcnt vmcnt(6)
  buffer_load_dwordx4 v[32:35], v3, s[12:15], s59 offen offset:3072
  v_and_b32_dpp v16, v57, v20 quad_perm:[0,0,0,0] row_mask:0xf bank_mask:0xf
  v_and_b32_dpp v17, v57, v21 quad_perm:[0,0,0,0] row_mask:0xf bank_mask:0xf
  s_waitcnt vmcnt(12)
  v_mfma_f32_16x16x16_bf16 v[8:11], v[68:69], v[18:19], v[8:11]
  v_mfma_f32_16x16x16_bf16 v[12:15], v[70:71], v[18:19], v[12:15]
  s_mov_b32 s59, 0x1c000
  s_bitcmp1_b32 s99, 0
  s_cbranch_scc1 L_th_523
  s_waitcnt vmcnt(5)
L_th_523:
  s_waitcnt vmcnt(5)
  buffer_load_dwordx4 v[68:71], v3, s[12:15], s59 offen offset:0
  v_and_b32_dpp v18, v57, v20 quad_perm:[1,1,1,1] row_mask:0xf bank_mask:0xf
  v_and_b32_dpp v19, v57, v21 quad_perm:[1,1,1,1] row_mask:0xf bank_mask:0xf
  s_waitcnt vmcnt(12)
  v_mfma_f32_16x16x16_bf16 v[8:11], v[40:41], v[16:17], v[8:11]
  v_mfma_f32_16x16x16_bf16 v[12:15], v[42:43], v[16:17], v[12:15]
  s_bitcmp1_b32 s99, 0
  s_cbranch_scc1 L_th_525
  s_waitcnt vmcnt(5)
L_th_525:
  s_waitcnt vmcnt(6)
  buffer_load_dwordx4 v[40:43], v3, s[12:15], s59 offen offset:1024
  v_and_b32_dpp v16, v57, v20 quad_perm:[2,2,2,2] row_mask:0xf bank_mask:0xf
  v_and_b32_dpp v17, v57, v21 quad_perm:[2,2,2,2] row_mask:0xf bank_mask:0xf
  s_waitcnt vmcnt(12)
  v_mfma_f32_16x16x16_bf16 v[8:11], v[72:73], v[18:19], v[8:11]
  v_mfma_f32_16x16x16_bf16 v[12:15], v[74:75], v[18:19], v[12:15]
  s_bitcmp1_b32 s99, 0
  s_cbranch_scc1 L_th_527
  s_waitcnt vmcnt(5)
L_th_527:
  s_waitcnt vmcnt(5)
  buffer_load_dwordx4 v[72:75], v3, s[12:15], s59 offen offset:2048
  v_and_b32_dpp v18, v57, v20 quad_perm:[3,3,3,3] row_mask:0xf bank_mask:0xf
  v_and_b32_dpp v19, v57, v21 quad_perm:[3,3,3,3] row_mask:0xf bank_mask:0xf
  s_waitcnt vmcnt(12)
  v_mfma_f32_16x16x16_bf16 v[8:11], v[48:49], v[16:17], v[8:11]
  v_mfma_f32_16x16x16_bf16 v[12:15], v[50:51], v[16:17], v[12:15]
  s_bitcmp1_b32 s99, 0
  s_cbranch_scc1 L_th_529
  s_waitcnt vmcnt(5)
L_th_529:
  s_waitcnt vmcnt(6)
  buffer_load_dwordx4 v[48:51], v3, s[12:15], s59 offen offset:3072
  v_and_b32_dpp v16, v58, v20 quad_perm:[0,0,0,0] row_mask:0xf bank_mask:0xf
  v_and_b32_dpp v17, v58, v21 quad_perm:[0,0,0,0] row_mask:0xf bank_mask:0xf
  s_waitcnt vmcnt(12)
  v_mfma_f32_16x16x16_bf16 v[8:11], v[76:77], v[18:19], v[8:11]
  v_mfma_f32_16x16x16_bf16 v[12:15], v[78:79], v[18:19], v[12:15]
  v_and_b32_dpp v18, v58, v20 quad_perm:[1,1,1,1] row_mask:0xf bank_mask:0xf
  v_and_b32_dpp v19, v58, v21 quad_perm:[1,1,1,1] row_mask:0xf bank_mask:0xf
  s_waitcnt vmcnt(11)
  v_mfma_f32_16x16x16_bf16 v[8:11], v[244:245], v[16:17], v[8:11]
  v_mfma_f32_16x16x16_bf16 v[12:15], v[246:247], v[16:17], v[12:15]
  v_lshlrev_b32 v26, 4, v1
  v_lshrrev_b32 v27, 2, v1
  v_lshlrev_b32 v27, 4, v27
  s_lshl_b32 s55, s52, 8
  v_add_u32 v27, s55, v27
  s_lshl_b32 s66, s53, 12
  s_lshr_b32 s55, s54, 3
  s_lshl_b32 s55, s55, 10
  s_add_u32 s66, s66, s55
  s_add_u32 s66, s66, 0x1c000
  v_mov_b32 v80, -1
  v_mov_b32 v81, -1
  v_mov_b32 v82, -1
  v_mov_b32 v83, -1
  v_mov_b32 v84, -1
  v_mov_b32 v85, -1
  v_mov_b32 v86, -1
  v_mov_b32 v87, -1
  buffer_load_dwordx4 v[80:83], v26, s[48:51], s66 offen sc1
  buffer_load_dwordx4 v[84:87], v27, s[48:51], s66 offen sc1
  v_and_b32_dpp v16, v58, v20 quad_perm:[2,2,2,2] row_mask:0xf bank_mask:0xf
  v_and_b32_dpp v17, v58, v21 quad_perm:[2,2,2,2] row_mask:0xf bank_mask:0xf
  s_waitcnt vmcnt(10)
  v_mfma_f32_16x16x16_bf16 v[8:11], v[248:249], v[18:19], v[8:11]
  v_mfma_f32_16x16x16_bf16 v[12:15], v[250:251], v[18:19], v[12:15]
  v_and_b32_dpp v18, v58, v20 quad_perm:[3,3,3,3] row_mask:0xf bank_mask:0xf
  v_and_b32_dpp v19, v58, v21 quad_perm:[3,3,3,3] row_mask:0xf bank_mask:0xf
  s_waitcnt vmcnt(9)
  v_mfma_f32_16x16x16_bf16 v[8:11], v[252:253], v[16:17], v[8:11]
  v_mfma_f32_16x16x16_bf16 v[12:15], v[254:255], v[16:17], v[12:15]
  v_and_b32_dpp v16, v59, v20 quad_perm:[0,0,0,0] row_mask:0xf bank_mask:0xf
  v_and_b32_dpp v17, v59, v21 quad_perm:[0,0,0,0] row_mask:0xf bank_mask:0xf
  s_waitcnt vmcnt(8)
  v_mfma_f32_16x16x16_bf16 v[8:11], v[36:37], v[18:19], v[8:11]
  v_mfma_f32_16x16x16_bf16 v[12:15], v[38:39], v[18:19], v[12:15]
  v_and_b32_dpp v18, v59, v20 quad_perm:[1,1,1,1] row_mask:0xf bank_mask:0xf
  v_and_b32_dpp v19, v59, v21 quad_perm:[1,1,1,1] row_mask:0xf bank_mask:0xf
  s_waitcnt vmcnt(7)
  v_mfma_f32_16x16x16_bf16 v[8:11], v[52:53], v[16:17], v[8:11]
  v_mfma_f32_16x16x16_bf16 v[12:15], v[54:55], v[16:17], v[12:15]
  v_and_b32_dpp v16, v59, v20 quad_perm:[2,2,2,2] row_mask:0xf bank_mask:0xf
  v_and_b32_dpp v17, v59, v21 quad_perm:[2,2,2,2] row_mask:0xf bank_mask:0xf
  s_waitcnt vmcnt(6)
  v_mfma_f32_16x16x16_bf16 v[8:11], v[44:45], v[18:19], v[8:11]
  v_mfma_f32_16x16x16_bf16 v[12:15], v[46:47], v[18:19], v[12:15]
  v_and_b32_dpp v18, v59, v20 quad_perm:[3,3,3,3] row_mask:0xf bank_mask:0xf
  v_and_b32_dpp v19, v59, v21 quad_perm:[3,3,3,3] row_mask:0xf bank_mask:0xf
  s_waitcnt vmcnt(5)
  v_mfma_f32_16x16x16_bf16 v[8:11], v[64:65], v[16:17], v[8:11]
  v_mfma_f32_16x16x16_bf16 v[12:15], v[66:67], v[16:17], v[12:15]
  v_and_b32_dpp v16, v60, v20 quad_perm:[0,0,0,0] row_mask:0xf bank_mask:0xf
  v_and_b32_dpp v17, v60, v21 quad_perm:[0,0,0,0] row_mask:0xf bank_mask:0xf
  s_waitcnt vmcnt(4)
  v_mfma_f32_16x16x16_bf16 v[8:11], v[32:33], v[18:19], v[8:11]
  v_mfma_f32_16x16x16_bf16 v[12:15], v[34:35], v[18:19], v[12:15]
  v_and_b32_dpp v18, v60, v20 quad_perm:[1,1,1,1] row_mask:0xf bank_mask:0xf
  v_and_b32_dpp v19, v60, v21 quad_perm:[1,1,1,1] row_mask:0xf bank_mask:0xf
  s_waitcnt vmcnt(3)
  v_mfma_f32_16x16x16_bf16 v[8:11], v[68:69], v[16:17], v[8:11]
  v_mfma_f32_16x16x16_bf16 v[12:15], v[70:71], v[16:17], v[12:15]
  v_and_b32_dpp v16, v60, v20 quad_perm:[2,2,2,2] row_mask:0xf bank_mask:0xf
  v_and_b32_dpp v17, v60, v21 quad_perm:[2,2,2,2] row_mask:0xf bank_mask:0xf
  s_waitcnt vmcnt(2)
  v_mfma_f32_16x16x16_bf16 v[8:11], v[40:41], v[18:19], v[8:11]
  v_mfma_f32_16x16x16_bf16 v[12:15], v[42:43], v[18:19], v[12:15]
  s_mov_b32 s59, 0x1d000
  s_bitcmp1_b32 s99, 0
  s_cbranch_scc1 L_th_531
  s_waitcnt vmcnt(5)
L_th_531:
  s_waitcnt vmcnt(5)
  buffer_load_dwordx4 v[40:43], v3, s[12:15], s59 offen offset:0 nt
  s_bitcmp1_b32 s99, 0
  s_cbranch_scc1 L_th_533
  s_waitcnt vmcnt(5)
L_th_533:
  s_waitcnt vmcnt(6)
  buffer_load_dwordx4 v[44:47], v3, s[12:15], s59 offen offset:1024 nt
  v_and_b32_dpp v18, v60, v20 quad_perm:[3,3,3,3] row_mask:0xf bank_mask:0xf
  v_and_b32_dpp v19, v60, v21 quad_perm:[3,3,3,3] row_mask:0xf bank_mask:0xf
  s_waitcnt vmcnt(3)
  v_mfma_f32_16x16x16_bf16 v[8:11], v[72:73], v[16:17], v[8:11]
  v_mfma_f32_16x16x16_bf16 v[12:15], v[74:75], v[16:17], v[12:15]
  v_and_b32_dpp v16, v61, v20 quad_perm:[0,0,0,0] row_mask:0xf bank_mask:0xf
  v_and_b32_dpp v17, v61, v21 quad_perm:[0,0,0,0] row_mask:0xf bank_mask:0xf
  s_waitcnt vmcnt(2)
  v_mfma_f32_16x16x16_bf16 v[8:11], v[48:49], v[18:19], v[8:11]
  v_mfma_f32_16x16x16_bf16 v[12:15], v[50:51], v[18:19], v[12:15]
  s_bitcmp1_b32 s99, 0
  s_cbranch_scc1 L_th_535
  s_waitcnt vmcnt(5)
L_th_535:
  s_waitcnt vmcnt(5)
  buffer_load_dwordx4 v[48:51], v3, s[12:15], s59 offen offset:2048 nt
  s_bitcmp1_b32 s99, 0
  s_cbranch_scc1 L_th_537
  s_waitcnt vmcnt(5)
L_th_537:
  s_waitcnt vmcnt(6)
  buffer_load_dwordx4 v[52:55], v3, s[12:15], s59 offen offset:3072 nt
  s_mov_b32 s59, 0x1e000
  s_bitcmp1_b32 s99, 0
  s_cbranch_scc1 L_th_539
  s_waitcnt vmcnt(5)
L_th_539:
  s_waitcnt vmcnt(5)
  buffer_load_dwordx4 v[64:67], v3, s[12:15], s59 offen offset:0 nt
  s_bitcmp1_b32 s99, 0
  s_cbranch_scc1 L_th_541
  s_waitcnt vmcnt(5)
L_th_541:
  s_waitcnt vmcnt(6)
  buffer_load_dwordx4 v[68:71], v3, s[12:15], s59 offen offset:1024 nt
  s_bitcmp1_b32 s99, 0
  s_cbranch_scc1 L_th_543
  s_waitcnt vmcnt(5)
L_th_543:
  s_waitcnt vmcnt(5)
  buffer_load_dwordx4 v[72:75], v3, s[12:15], s59 offen offset:2048 nt
  s_bitcmp1_b32 s99, 0
  s_cbranch_scc1 L_th_545
  s_waitcnt vmcnt(5)
L_th_545:
  s_waitcnt vmcnt(6)
  buffer_load_dwordx4 v[76:79], v3, s[12:15], s59 offen offset:3072 nt
  s_mov_b32 s59, 0x1f000
  s_bitcmp1_b32 s99, 0
  s_cbranch_scc1 L_th_547
  s_waitcnt vmcnt(5)
L_th_547:
  s_waitcnt vmcnt(5)
  buffer_load_dwordx4 v[244:247], v3, s[12:15], s59 offen offset:0 nt
  s_bitcmp1_b32 s99, 0
  s_cbranch_scc1 L_th_549
  s_waitcnt vmcnt(5)
L_th_549:
  s_waitcnt vmcnt(6)
  buffer_load_dwordx4 v[248:251], v3, s[12:15], s59 offen offset:1024 nt
  s_bitcmp1_b32 s99, 0
  s_cbranch_scc1 L_th_551
  s_waitcnt vmcnt(5)
L_th_551:
  s_waitcnt vmcnt(5)
  buffer_load_dwordx4 v[252:255], v3, s[12:15], s59 offen offset:2048 nt
  s_bitcmp1_b32 s99, 0
  s_cbranch_scc1 L_th_553
  s_waitcnt vmcnt(5)
L_th_553:
  s_waitcnt vmcnt(6)
  buffer_load_dwordx4 v[56:59], v3, s[12:15], s59 offen offset:3072 nt
  v_and_b32_dpp v18, v61, v20 quad_perm:[1,1,1,1] row_mask:0xf bank_mask:0xf
  v_and_b32_dpp v19, v61, v21 quad_perm:[1,1,1,1] row_mask:0xf bank_mask:0xf
  s_waitcnt vmcnt(11)
  v_mfma_f32_16x16x16_bf16 v[8:11], v[40:41], v[16:17], v[8:11]
  v_mfma_f32_16x16x16_bf16 v[12:15], v[42:43], v[16:17], v[12:15]
  v_and_b32_dpp v16, v61, v20 quad_perm:[2,2,2,2] row_mask:0xf bank_mask:0xf
  v_and_b32_dpp v17, v61, v21 quad_perm:[2,2,2,2] row_mask:0xf bank_mask:0xf
  s_waitcnt vmcnt(10)
  v_mfma_f32_16x16x16_bf16 v[8:11], v[44:45], v[18:19], v[8:11]
  v_mfma_f32_16x16x16_bf16 v[12:15], v[46:47], v[18:19], v[12:15]
  v_and_b32_dpp v18, v61, v20 quad_perm:[3,3,3,3] row_mask:0xf bank_mask:0xf
  v_and_b32_dpp v19, v61, v21 quad_perm:[3,3,3,3] row_mask:0xf bank_mask:0xf
  s_waitcnt vmcnt(9)
  v_mfma_f32_16x16x16_bf16 v[8:11], v[48:49], v[16:17], v[8:11]
  v_mfma_f32_16x16x16_bf16 v[12:15], v[50:51], v[16:17], v[12:15]
  v_and_b32_dpp v16, v62, v20 quad_perm:[0,0,0,0] row_mask:0xf bank_mask:0xf
  v_and_b32_dpp v17, v62, v21 quad_perm:[0,0,0,0] row_mask:0xf bank_mask:0xf
  s_waitcnt vmcnt(8)
  v_mfma_f32_16x16x16_bf16 v[8:11], v[52:53], v[18:19], v[8:11]
  v_mfma_f32_16x16x16_bf16 v[12:15], v[54:55], v[18:19], v[12:15]
  v_and_b32_dpp v18, v62, v20 quad_perm:[1,1,1,1] row_mask:0xf bank_mask:0xf
  v_and_b32_dpp v19, v62, v21 quad_perm:[1,1,1,1] row_mask:0xf bank_mask:0xf
  s_waitcnt vmcnt(7)
  v_mfma_f32_16x16x16_bf16 v[8:11], v[64:65], v[16:17], v[8:11]
  v_mfma_f32_16x16x16_bf16 v[12:15], v[66:67], v[16:17], v[12:15]
  s_waitcnt vmcnt(12)
  v_max3_u32 v28, v80, v81, v82
  v_max3_u32 v28, v28, v83, v84
  v_max3_u32 v28, v28, v85, v86
  v_max_u32 v28, v28, v87
  v_cmp_eq_u32 vcc, -1, v28
  s_mov_b32 s98, 0
  s_cbranch_vccnz L_mlt_555
  v_max_f32 v28, v80, v82
  s_nop 1
  v_max_f32_dpp v28, v28, v28 row_ror:8 row_mask:0xf bank_mask:0xf
  s_nop 1
  v_max_f32_dpp v28, v28, v28 row_ror:4 row_mask:0xf bank_mask:0xf
  s_nop 1
  v_max_f32_dpp v28, v28, v28 row_ror:2 row_mask:0xf bank_mask:0xf
  s_nop 1
  v_max_f32_dpp v28, v28, v28 row_ror:1 row_mask:0xf bank_mask:0xf
  v_mov_b32 v30, v28
  s_nop 1
  v_permlane32_swap_b32 v28, v30
  s_nop 0
  v_max_f32 v28, v28, v30
  v_mov_b32 v30, v28
  s_nop 1
  v_permlane16_swap_b32 v28, v30
  s_nop 0
  v_max_f32 v28, v28, v30
  v_mul_f32 v28, s96, v28
  v_fma_f32 v80, v80, s96, -v28
  v_fma_f32 v82, v82, s96, -v28
  v_fma_f32 v84, v84, s96, -v28
  v_fma_f32 v86, v86, s96, -v28
  v_exp_f32 v80, v80
  v_exp_f32 v82, v82
  v_exp_f32 v84, v84
  v_exp_f32 v86, v86
  s_nop 0
  v_mul_f32 v29, v80, v81
  v_fmac_f32 v29, v82, v83
  s_nop 1
  v_add_f32_dpp v29, v29, v29 row_ror:8 row_mask:0xf bank_mask:0xf
  s_nop 1
  v_add_f32_dpp v29, v29, v29 row_ror:4 row_mask:0xf bank_mask:0xf
  s_nop 1
  v_add_f32_dpp v29, v29, v29 row_ror:2 row_mask:0xf bank_mask:0xf
  s_nop 1
  v_add_f32_dpp v29, v29, v29 row_ror:1 row_mask:0xf bank_mask:0xf
  v_mov_b32 v30, v29
  s_nop 1
  v_permlane32_swap_b32 v29, v30
  s_nop 0
  v_add_f32 v29, v29, v30
  v_mov_b32 v30, v29
  s_nop 1
  v_permlane16_swap_b32 v29, v30
  s_nop 0
  v_add_f32 v29, v29, v30
  v_rcp_f32 v29, v29
  s_nop 0
  v_mul_f32 v80, v84, v29
  v_mul_f32 v81, v86, v29
  s_mov_b32 s98, 1
L_mlt_555:
  v_bfe_u32 v82, v1, 2, 2
  v_lshlrev_b32 v82, 16, v82
  v_lshrrev_b32 v83, 4, v1
  v_lshl_add_u32 v82, v83, 14, v82
  v_and_b32 v83, 3, v1
  v_lshl_add_u32 v82, v83, 4, v82
  s_lshl_b32 s97, s53, 18
  s_lshl_b32 s56, s54, 8
  s_add_u32 s97, s97, s56
  s_lshl_b32 s56, s52, 6
  s_add_u32 s97, s97, s56
  s_add_u32 s97, s97, 0x48000
  v_and_b32_dpp v16, v62, v20 quad_perm:[2,2,2,2] row_mask:0xf bank_mask:0xf
  v_and_b32_dpp v17, v62, v21 quad_perm:[2,2,2,2] row_mask:0xf bank_mask:0xf
  s_waitcnt vmcnt(6)
  v_mfma_f32_16x16x16_bf16 v[8:11], v[68:69], v[18:19], v[8:11]
  v_mfma_f32_16x16x16_bf16 v[12:15], v[70:71], v[18:19], v[12:15]
  v_and_b32_dpp v18, v62, v20 quad_perm:[3,3,3,3] row_mask:0xf bank_mask:0xf
  v_and_b32_dpp v19, v62, v21 quad_perm:[3,3,3,3] row_mask:0xf bank_mask:0xf
  s_waitcnt vmcnt(5)
  v_mfma_f32_16x16x16_bf16 v[8:11], v[72:73], v[16:17], v[8:11]
  v_mfma_f32_16x16x16_bf16 v[12:15], v[74:75], v[16:17], v[12:15]
  v_and_b32_dpp v16, v63, v20 quad_perm:[0,0,0,0] row_mask:0xf bank_mask:0xf
  v_and_b32_dpp v17, v63, v21 quad_perm:[0,0,0,0] row_mask:0xf bank_mask:0xf
  s_waitcnt vmcnt(4)
  v_mfma_f32_16x16x16_bf16 v[8:11], v[76:77], v[18:19], v[8:11]
  v_mfma_f32_16x16x16_bf16 v[12:15], v[78:79], v[18:19], v[12:15]
  v_and_b32_dpp v18, v63, v20 quad_perm:[1,1,1,1] row_mask:0xf bank_mask:0xf
  v_and_b32_dpp v19, v63, v21 quad_perm:[1,1,1,1] row_mask:0xf bank_mask:0xf
  s_waitcnt vmcnt(3)
  v_mfma_f32_16x16x16_bf16 v[8:11], v[244:245], v[16:17], v[8:11]
  v_mfma_f32_16x16x16_bf16 v[12:15], v[246:247], v[16:17], v[12:15]
  v_and_b32_dpp v16, v63, v20 quad_perm:[2,2,2,2] row_mask:0xf bank_mask:0xf
  v_and_b32_dpp v17, v63, v21 quad_perm:[2,2,2,2] row_mask:0xf bank_mask:0xf
  s_waitcnt vmcnt(2)
  v_mfma_f32_16x16x16_bf16 v[8:11], v[248:249], v[18:19], v[8:11]
  v_mfma_f32_16x16x16_bf16 v[12:15], v[250:251], v[18:19], v[12:15]
  v_and_b32_dpp v18, v63, v20 quad_perm:[3,3,3,3] row_mask:0xf bank_mask:0xf
  v_and_b32_dpp v19, v63, v21 quad_perm:[3,3,3,3] row_mask:0xf bank_mask:0xf
  s_waitcnt vmcnt(1)
  v_mfma_f32_16x16x16_bf16 v[8:11], v[252:253], v[16:17], v[8:11]
  v_mfma_f32_16x16x16_bf16 v[12:15], v[254:255], v[16:17], v[12:15]
  s_nop 1
  s_waitcnt vmcnt(0)
  v_mfma_f32_16x16x16_bf16 v[8:11], v[56:57], v[18:19], v[8:11]
  v_mfma_f32_16x16x16_bf16 v[12:15], v[58:59], v[18:19], v[12:15]
  s_nop 7
  v_min_u32 v8, -2, v8
  v_min_u32 v9, -2, v9
  v_min_u32 v10, -2, v10
  v_min_u32 v11, -2, v11
  v_min_u32 v12, -2, v12
  v_min_u32 v13, -2, v13
  v_min_u32 v14, -2, v14
  v_min_u32 v15, -2, v15
  s_add_u32 s55, s97, 8192
  buffer_store_dwordx4 v[8:11], v82, s[48:51], s97 offen sc1
  buffer_store_dwordx4 v[12:15], v82, s[48:51], s55 offen sc1
  s_barrier
  v_mov_b32 v30, 0x3e8
  s_cmp_lg_u32 s52, 0
  s_cbranch_scc1 L_w0_557
  s_mov_b64 exec, 0x1
  buffer_store_dword v30, v1, s[48:51], s93 offen
  s_mov_b64 exec, -1
L_w0_557:
  v_and_b32 v30, 31, v1
  v_lshl_add_u32 v30, v30, 2, s92
  s_mov_b32 s57, 60
  s_mov_b32 s95, 1
L_hd_556:
  buffer_load_dword v31, v30, s[48:51], 0 offen sc1
  s_waitcnt vmcnt(0)
  v_cmp_gt_i32 vcc, 0x3e8, v31
  s_cbranch_vccz L_hd_556_ok
  s_sub_u32 s57, s57, 1
  s_cmp_gt_i32 s57, 0
  s_cbranch_scc1 L_hd_556
  s_mov_b32 s95, 0
L_hd_556_ok:
  s_cmp_eq_u32 s98, 1
  s_cbranch_scc1 L_mls_558
  v_lshlrev_b32 v26, 4, v1
  v_lshrrev_b32 v27, 2, v1
  v_lshlrev_b32 v27, 4, v27
  s_lshl_b32 s55, s52, 8
  v_add_u32 v27, s55, v27
  s_lshl_b32 s66, s53, 12
  s_lshr_b32 s55, s54, 3
  s_lshl_b32 s55, s55, 10
  s_add_u32 s66, s66, s55
  s_add_u32 s66, s66, 0x1c000
  buffer_load_dwordx4 v[80:83], v26, s[48:51], s66 offen sc1
  buffer_load_dwordx4 v[84:87], v27, s[48:51], s66 offen sc1
  s_waitcnt vmcnt(0)
  v_max3_u32 v28, v80, v81, v82
  v_max3_u32 v28, v28, v83, v84
  v_max3_u32 v28, v28, v85, v86
  v_max_u32 v28, v28, v87
  v_cmp_eq_u32 vcc, -1, v28
  s_cbranch_vccz L_ml_559_ok
  s_mov_b64 s[76:77], -1
  s_mov_b64 s[78:79], -1
L_ml_559:
  s_mov_b64 exec, s[76:77]
  s_cbranch_execz L_ml_559_c0
  v_max3_u32 v28, v80, v81, v82
  v_max_u32 v28, v28, v83
  v_cmp_eq_u32 vcc, -1, v28
  s_mov_b64 s[76:77], vcc
L_ml_559_c0:
  s_mov_b64 exec, s[78:79]
  s_cbranch_execz L_ml_559_c1
  v_max3_u32 v28, v84, v85, v86
  v_max_u32 v28, v28, v87
  v_cmp_eq_u32 vcc, -1, v28
  s_mov_b64 s[78:79], vcc
L_ml_559_c1:
  s_mov_b64 s[60:61], s[76:77]
  s_or_b64 s[60:61], s[60:61], s[78:79]
  s_cmp_eq_u64 s[60:61], 0
  s_cbranch_scc1 L_ml_559_x
  s_mov_b64 exec, s[76:77]
  s_cbranch_execz L_ml_559_l0
  buffer_load_dwordx4 v[80:83], v26, s[48:51], s66 offen sc1
L_ml_559_l0:
  s_mov_b64 exec, s[78:79]
  s_cbranch_execz L_ml_559_l1
  buffer_load_dwordx4 v[84:87], v27, s[48:51], s66 offen sc1
L_ml_559_l1:
  s_waitcnt vmcnt(0)
  s_sub_u32 s58, s58, 1
  s_cmp_gt_i32 s58, 0
  s_cbranch_scc1 L_ml_559
L_ml_559_x:
  s_mov_b64 exec, -1
L_ml_559_ok:
  v_max_f32 v28, v80, v82
  s_nop 1
  v_max_f32_dpp v28, v28, v28 row_ror:8 row_mask:0xf bank_mask:0xf
  s_nop 1
  v_max_f32_dpp v28, v28, v28 row_ror:4 row_mask:0xf bank_mask:0xf
  s_nop 1
  v_max_f32_dpp v28, v28, v28 row_ror:2 row_mask:0xf bank_mask:0xf
  s_nop 1
  v_max_f32_dpp v28, v28, v28 row_ror:1 row_mask:0xf bank_mask:0xf
  v_mov_b32 v30, v28
  s_nop 1
  v_permlane32_swap_b32 v28, v30
  s_nop 0
  v_max_f32 v28, v28, v30
  v_mov_b32 v30, v28
  s_nop 1
  v_permlane16_swap_b32 v28, v30
  s_nop 0
  v_max_f32 v28, v28, v30
  v_mul_f32 v28, s96, v28
  v_fma_f32 v80, v80, s96, -v28
  v_fma_f32 v82, v82, s96, -v28
  v_fma_f32 v84, v84, s96, -v28
  v_fma_f32 v86, v86, s96, -v28
  v_exp_f32 v80, v80
  v_exp_f32 v82, v82
  v_exp_f32 v84, v84
  v_exp_f32 v86, v86
  s_nop 0
  v_mul_f32 v29, v80, v81
  v_fmac_f32 v29, v82, v83
  s_nop 1
  v_add_f32_dpp v29, v29, v29 row_ror:8 row_mask:0xf bank_mask:0xf
  s_nop 1
  v_add_f32_dpp v29, v29, v29 row_ror:4 row_mask:0xf bank_mask:0xf
  s_nop 1
  v_add_f32_dpp v29, v29, v29 row_ror:2 row_mask:0xf bank_mask:0xf
  s_nop 1
  v_add_f32_dpp v29, v29, v29 row_ror:1 row_mask:0xf bank_mask:0xf
  v_mov_b32 v30, v29
  s_nop 1
  v_permlane32_swap_b32 v29, v30
  s_nop 0
  v_add_f32 v29, v29, v30
  v_mov_b32 v30, v29
  s_nop 1
  v_permlane16_swap_b32 v29, v30
  s_nop 0
  v_add_f32 v29, v29, v30
  v_rcp_f32 v29, v29
  s_nop 0
  v_mul_f32 v80, v84, v29
  v_mul_f32 v81, v86, v29
L_mls_558:
  v_lshrrev_b32 v26, 2, v1
  v_lshlrev_b32 v26, 7, v26
  v_and_b32 v27, 3, v1
  v_lshlrev_b32 v27, 4, v27
  v_add_u32 v26, v26, v27
  s_lshl_b32 s65, s53, 5
  s_add_u32 s65, s65, s54
  s_lshl_b32 s65, s65, 13
  s_lshl_b32 s55, s52, 11
  s_add_u32 s65, s65, s55
  s_add_u32 s65, s65, 0x48000
  s_lshl_b32 s97, s53, 13
  s_add_u32 s97, s97, s55
  s_lshl_b32 s56, s54, 6
  s_add_u32 s97, s97, s56
  s_add_u32 s97, s97, 0x2000
  s_sleep 2
  buffer_load_dwordx4 v[32:35], v26, s[48:51], s65 offen sc1
  buffer_load_dwordx4 v[36:39], v26, s[48:51], s65 offen offset:64 sc1
  s_waitcnt vmcnt(0)
  v_max3_u32 v28, v32, v33, v34
  v_max3_u32 v28, v28, v35, v36
  v_max3_u32 v28, v28, v37, v38
  v_max_u32 v28, v28, v39
  v_cmp_eq_u32 vcc, -1, v28
  s_cbranch_vccz L_a1_560_ok
  s_mov_b64 s[76:77], -1
  s_mov_b64 s[78:79], -1
L_a1_560:
  s_mov_b64 exec, s[76:77]
  s_cbranch_execz L_a1_560_c0
  v_max3_u32 v28, v32, v33, v34
  v_max_u32 v28, v28, v35
  v_cmp_eq_u32 vcc, -1, v28
  s_mov_b64 s[76:77], vcc
L_a1_560_c0:
  s_mov_b64 exec, s[78:79]
  s_cbranch_execz L_a1_560_c1
  v_max3_u32 v28, v36, v37, v38
  v_max_u32 v28, v28, v39
  v_cmp_eq_u32 vcc, -1, v28
  s_mov_b64 s[78:79], vcc
L_a1_560_c1:
  s_mov_b64 s[60:61], s[76:77]
  s_or_b64 s[60:61], s[60:61], s[78:79]
  s_cmp_eq_u64 s[60:61], 0
  s_cbranch_scc1 L_a1_560_x
  s_mov_b64 exec, s[76:77]
  s_cbranch_execz L_a1_560_l0
  buffer_load_dwordx4 v[32:35], v26, s[48:51], s65 offen sc1
L_a1_560_l0:
  s_mov_b64 exec, s[78:79]
  s_cbranch_execz L_a1_560_l1
  buffer_load_dwordx4 v[36:39], v26, s[48:51], s65 offen offset:64 sc1
L_a1_560_l1:
  s_waitcnt vmcnt(0)
  s_sub_u32 s58, s58, 1
  s_cmp_gt_i32 s58, 0
  s_cbranch_scc1 L_a1_560
L_a1_560_x:
  s_mov_b64 exec, -1
L_a1_560_ok:
  v_mul_f32 v32, v80, v32
  v_mul_f32 v33, v80, v33
  v_mul_f32 v34, v80, v34
  v_mul_f32 v35, v80, v35
  v_fmac_f32 v32, v81, v36
  v_fmac_f32 v33, v81, v37
  v_fmac_f32 v34, v81, v38
  v_fmac_f32 v35, v81, v39
  v_add_f32_dpp v32, v32, v32 row_ror:8 row_mask:0xf bank_mask:0xf
  v_add_f32_dpp v33, v33, v33 row_ror:8 row_mask:0xf bank_mask:0xf
  v_add_f32_dpp v34, v34, v34 row_ror:8 row_mask:0xf bank_mask:0xf
  v_add_f32_dpp v35, v35, v35 row_ror:8 row_mask:0xf bank_mask:0xf
  v_add_f32_dpp v32, v32, v32 row_ror:4 row_mask:0xf bank_mask:0xf
  v_add_f32_dpp v33, v33, v33 row_ror:4 row_mask:0xf bank_mask:0xf
  v_add_f32_dpp v34, v34, v34 row_ror:4 row_mask:0xf bank_mask:0xf
  v_add_f32_dpp v35, v35, v35 row_ror:4 row_mask:0xf bank_mask:0xf
  v_mov_b32 v36, v32
  v_mov_b32 v37, v33
  v_mov_b32 v38, v34
  v_mov_b32 v39, v35
  v_permlane32_swap_b32 v32, v36
  v_permlane32_swap_b32 v33, v37
  v_permlane32_swap_b32 v34, v38
  v_permlane32_swap_b32 v35, v39
  v_add_f32 v32, v32, v36
  v_add_f32 v33, v33, v37
  v_add_f32 v34, v34, v38
  v_add_f32 v35, v35, v39
  v_mov_b32 v36, v32
  v_mov_b32 v37, v33
  v_mov_b32 v38, v34
  v_mov_b32 v39, v35
  v_permlane16_swap_b32 v32, v36
  v_permlane16_swap_b32 v33, v37
  v_permlane16_swap_b32 v34, v38
  v_permlane16_swap_b32 v35, v39
  v_add_f32 v32, v32, v36
  v_add_f32 v33, v33, v37
  v_add_f32 v34, v34, v38
  v_add_f32 v35, v35, v39
  v_min_u32 v32, -2, v32
  v_min_u32 v33, -2, v33
  v_min_u32 v34, -2, v34
  v_min_u32 v35, -2, v35
  s_mov_b64 exec, 0xf
  s_add_u32 s55, s97, 0x36000
  buffer_store_dwordx4 v[32:35], v27, s[48:51], s55 offen
  s_mov_b32 s74, s97
  s_mov_b64 exec, -1
  v_lshrrev_b32 v30, 1, v1
  v_lshlrev_b32 v30, 4, v30
  s_lshl_b32 s65, s53, 13
  s_lshl_b32 s56, s52, 9
  s_add_u32 s65, s65, s56
  s_add_u32 s65, s65, 0x2000
  s_add_u32 s66, s65, 4096
  v_and_b32 v28, 1, v1
  v_lshlrev_b32 v28, 5, v28
  v_lshrrev_b32 v29, 4, v1
  v_lshl_add_u32 v28, v29, 3, v28
  s_lshl_b32 s55, s52, 6
  v_add_u32 v28, s55, v28
  v_and_b32 v29, 7, v1
  v_lshlrev_b32 v29, 3, v29
  s_lshl_b32 s97, s53, 11
  s_lshl_b32 s56, s54, 6
  s_add_u32 s97, s97, s56
  s_add_u32 s97, s97, 0x12000
  s_add_u32 s72, s65, 0x36000
  s_add_u32 s73, s66, 0x36000
  s_cmp_eq_u32 s95, 0
  s_cbranch_scc1 L_ob_561_g
  s_mov_b32 s57, 40
L_ob_561_l:
  buffer_load_dwordx4 v[8:11], v30, s[48:51], s72 offen offset:0 sc1
  buffer_load_dwordx4 v[12:15], v30, s[48:51], s72 offen offset:2048 sc1
  buffer_load_dwordx4 v[80:83], v30, s[48:51], s73 offen offset:0 sc1
  buffer_load_dwordx4 v[84:87], v30, s[48:51], s73 offen offset:2048 sc1
  s_waitcnt vmcnt(0)
  v_max3_u32 v26, v8, v9, v10
  v_max3_u32 v26, v26, v11, v12
  v_max3_u32 v26, v26, v13, v14
  v_max3_u32 v26, v26, v15, v80
  v_max3_u32 v26, v26, v81, v82
  v_max3_u32 v26, v26, v83, v84
  v_max3_u32 v26, v26, v85, v86
  v_max_u32 v26, v26, v87
  v_cmp_eq_u32 vcc, -1, v26
  s_cbranch_vccz L_ob_561_lok
  s_sub_u32 s57, s57, 1
  s_cmp_gt_i32 s57, 0
  s_cbranch_scc1 L_ob_561_l
L_ob_561_g:
  s_mov_b64 exec, 0xf
  buffer_store_dwordx4 v[32:35], v27, s[48:51], s74 offen sc1
  s_mov_b64 exec, -1
  s_sleep 14
  buffer_load_dwordx4 v[8:11], v30, s[48:51], s65 offen offset:0 sc1
  buffer_load_dwordx4 v[12:15], v30, s[48:51], s65 offen offset:2048 sc1
  buffer_load_dwordx4 v[80:83], v30, s[48:51], s66 offen offset:0 sc1
  buffer_load_dwordx4 v[84:87], v30, s[48:51], s66 offen offset:2048 sc1
  s_waitcnt vmcnt(0)
  v_max3_u32 v26, v8, v9, v10
  v_max3_u32 v26, v26, v11, v12
  v_max3_u32 v26, v26, v13, v14
  v_max3_u32 v26, v26, v15, v80
  v_max3_u32 v26, v26, v81, v82
  v_max3_u32 v26, v26, v83, v84
  v_max3_u32 v26, v26, v85, v86
  v_max_u32 v26, v26, v87
  v_cmp_eq_u32 vcc, -1, v26
  s_cbranch_vccz L_ob_561_ok
  s_mov_b64 s[76:77], -1
  s_mov_b64 s[78:79], -1
  s_mov_b64 s[80:81], -1
  s_mov_b64 s[82:83], -1
L_ob_561:
  s_mov_b64 exec, s[76:77]
  s_cbranch_execz L_ob_561_c0
  v_max3_u32 v26, v8, v9, v10
  v_max_u32 v26, v26, v11
  v_cmp_eq_u32 vcc, -1, v26
  s_mov_b64 s[76:77], vcc
L_ob_561_c0:
  s_mov_b64 exec, s[78:79]
  s_cbranch_execz L_ob_561_c1
  v_max3_u32 v26, v12, v13, v14
  v_max_u32 v26, v26, v15
  v_cmp_eq_u32 vcc, -1, v26
  s_mov_b64 s[78:79], vcc
L_ob_561_c1:
  s_mov_b64 exec, s[80:81]
  s_cbranch_execz L_ob_561_c2
  v_max3_u32 v26, v80, v81, v82
  v_max_u32 v26, v26, v83
  v_cmp_eq_u32 vcc, -1, v26
  s_mov_b64 s[80:81], vcc
L_ob_561_c2:
  s_mov_b64 exec, s[82:83]
  s_cbranch_execz L_ob_561_c3
  v_max3_u32 v26, v84, v85, v86
  v_max_u32 v26, v26, v87
  v_cmp_eq_u32 vcc, -1, v26
  s_mov_b64 s[82:83], vcc
L_ob_561_c3:
  s_mov_b64 s[60:61], s[76:77]
  s_or_b64 s[60:61], s[60:61], s[78:79]
  s_or_b64 s[60:61], s[60:61], s[80:81]
  s_or_b64 s[60:61], s[60:61], s[82:83]
  s_cmp_eq_u64 s[60:61], 0
  s_cbranch_scc1 L_ob_561_x
  s_mov_b64 exec, s[76:77]
  s_cbranch_execz L_ob_561_l0
  buffer_load_dwordx4 v[8:11], v30, s[48:51], s65 offen offset:0 sc1
L_ob_561_l0:
  s_mov_b64 exec, s[78:79]
  s_cbranch_execz L_ob_561_l1
  buffer_load_dwordx4 v[12:15], v30, s[48:51], s65 offen offset:2048 sc1
L_ob_561_l1:
  s_mov_b64 exec, s[80:81]
  s_cbranch_execz L_ob_561_l2
  buffer_load_dwordx4 v[80:83], v30, s[48:51], s66 offen offset:0 sc1
L_ob_561_l2:
  s_mov_b64 exec, s[82:83]
  s_cbranch_execz L_ob_561_l3
  buffer_load_dwordx4 v[84:87], v30, s[48:51], s66 offen offset:2048 sc1
L_ob_561_l3:
  s_waitcnt vmcnt(0)
  s_sub_u32 s58, s58, 1
  s_cmp_gt_i32 s58, 0
  s_cbranch_scc1 L_ob_561
L_ob_561_x:
  s_mov_b64 exec, -1
  s_branch L_ob_561_ok
L_ob_561_lok:
  s_mov_b64 exec, 0xf
  buffer_store_dwordx4 v[32:35], v27, s[48:51], s74 offen sc1
  s_mov_b64 exec, -1
L_ob_561_ok:
  v_pk_add_f32 v[8:9], v[8:9], v[12:13]
  v_pk_add_f32 v[80:81], v[80:81], v[84:85]
  v_pk_add_f32 v[10:11], v[10:11], v[14:15]
  v_pk_add_f32 v[82:83], v[82:83], v[86:87]
  v_pk_add_f32 v[8:9], v[8:9], v[80:81]
  v_pk_add_f32 v[10:11], v[10:11], v[82:83]
  v_cvt_pk_bf16_f32 v26, v8, v9
  v_lshlrev_b32 v16, 16, v26
  v_and_b32 v17, 0xffff0000, v26
  v_cvt_pk_bf16_f32 v26, v10, v11
  v_lshlrev_b32 v18, 16, v26
  v_and_b32 v19, 0xffff0000, v26
  v_lshrrev_b32 v80, 16, v16
  v_lshrrev_b32 v81, 16, v17
  v_lshrrev_b32 v82, 16, v18
  v_lshrrev_b32 v83, 16, v19
  v_dot2_f32_bf16 v8, v104, v80, 0
  v_dot2_f32_bf16 v9, v104, v16, 0
  v_dot2_f32_bf16 v10, v105, v80, 0
  v_dot2_f32_bf16 v11, v105, v16, 0
  v_dot2_f32_bf16 v12, v106, v80, 0
  v_dot2_f32_bf16 v13, v106, v16, 0
  v_dot2_f32_bf16 v14, v107, v80, 0
  v_dot2_f32_bf16 v15, v107, v16, 0
  v_dot2c_f32_bf16 v8, v108, v81
  v_dot2c_f32_bf16 v9, v108, v17
  v_dot2c_f32_bf16 v10, v109, v81
  v_dot2c_f32_bf16 v11, v109, v17
  v_dot2c_f32_bf16 v12, v110, v81
  v_dot2c_f32_bf16 v13, v110, v17
  v_dot2c_f32_bf16 v14, v111, v81
  v_dot2c_f32_bf16 v15, v111, v17
  v_dot2c_f32_bf16 v8, v112, v82
  v_dot2c_f32_bf16 v9, v112, v18
  v_dot2c_f32_bf16 v10, v113, v82
  v_dot2c_f32_bf16 v11, v113, v18
  v_dot2c_f32_bf16 v12, v114, v82
  v_dot2c_f32_bf16 v13, v114, v18
  v_dot2c_f32_bf16 v14, v115, v82
  v_dot2c_f32_bf16 v15, v115, v18
  v_dot2c_f32_bf16 v8, v116, v83
  v_dot2c_f32_bf16 v9, v116, v19
  v_dot2c_f32_bf16 v10, v117, v83
  v_dot2c_f32_bf16 v11, v117, v19
  v_dot2c_f32_bf16 v12, v118, v83
  v_dot2c_f32_bf16 v13, v118, v19
  v_dot2c_f32_bf16 v14, v119, v83
  v_dot2c_f32_bf16 v15, v119, v19
  s_nop 2
  v_permlane32_swap_b32 v8, v12
  v_permlane32_swap_b32 v9, v13
  v_permlane32_swap_b32 v10, v14
  v_permlane32_swap_b32 v11, v15
  s_nop 0
  v_add_f32 v8, v8, v12
  v_add_f32 v9, v9, v13
  v_add_f32 v10, v10, v14
  v_add_f32 v11, v11, v15
  s_nop 0
  v_permlane16_swap_b32 v8, v10
  v_permlane16_swap_b32 v9, v11
  s_nop 0
  v_add_f32 v8, v8, v10
  v_add_f32 v9, v9, v11
  s_nop 0
  v_add_f32_dpp v8, v8, v8 row_ror:8 row_mask:0xf bank_mask:0xf
  v_add_f32_dpp v9, v9, v9 row_ror:8 row_mask:0xf bank_mask:0xf
  s_nop 0
  v_add_f32_dpp v8, v8, v8 row_ror:4 row_mask:0xf bank_mask:0xf
  v_add_f32_dpp v9, v9, v9 row_ror:4 row_mask:0xf bank_mask:0xf
  s_nop 0
  v_add_f32_dpp v8, v8, v8 row_ror:2 row_mask:0xf bank_mask:0xf
  v_add_f32_dpp v9, v9, v9 row_ror:2 row_mask:0xf bank_mask:0xf
  ds_write_b64 v28, v[8:9] offset:2304
  s_waitcnt lgkmcnt(0)
  s_barrier
  ds_read_b64 v[8:9], v29 offset:2304
  ds_read_b64 v[10:11], v29 offset:2368
  ds_read_b64 v[12:13], v29 offset:2432
  ds_read_b64 v[14:15], v29 offset:2496
  s_waitcnt lgkmcnt(0)
  v_pk_add_f32 v[8:9], v[8:9], v[10:11]
  v_pk_add_f32 v[12:13], v[12:13], v[14:15]
  v_pk_add_f32 v[80:81], v[8:9], v[12:13]
  v_min_u32 v80, -2, v80
  v_min_u32 v81, -2, v81
  s_cmp_lg_u32 s52, 0
  s_cbranch_scc1 L_w0_562
  s_mov_b64 exec, 0xff
  buffer_store_dwordx2 v[80:81], v29, s[48:51], s97 offen sc1
  s_mov_b64 exec, -1
L_w0_562:
  s_cmp_ge_u32 s2, 224
  s_cbranch_scc1 L_clr1_563
  v_mov_b32 v32, -1
  v_mov_b32 v33, -1
  v_mov_b32 v34, -1
  v_mov_b32 v35, -1
  v_lshlrev_b32 v36, 4, v0
  s_mul_i32 s55, s2, 12288
  s_add_u32 s55, s55, 0x280000
  buffer_store_dwordx4 v[32:35], v36, s[48:51], s55 offen sc1
  s_add_u32 s55, s55, 4096
  buffer_store_dwordx4 v[32:35], v36, s[48:51], s55 offen sc1
  s_add_u32 s55, s55, 4096
  buffer_store_dwordx4 v[32:35], v36, s[48:51], s55 offen sc1
L_clr1_563:
  v_lshlrev_b32 v30, 3, v0
  s_mov_b32 s72, 0x12000
  s_mov_b32 s73, 0x13000
  s_mov_b32 s74, 0x14000
  s_mov_b32 s75, 0x15000
  s_sleep 16
  buffer_load_dwordx2 v[8:9], v30, s[48:51], s72 offen offset:0 sc1
  buffer_load_dwordx2 v[10:11], v30, s[48:51], s72 offen offset:2048 sc1
  buffer_load_dwordx2 v[12:13], v30, s[48:51], s73 offen offset:0 sc1
  buffer_load_dwordx2 v[14:15], v30, s[48:51], s73 offen offset:2048 sc1
  buffer_load_dwordx2 v[80:81], v30, s[48:51], s74 offen offset:0 sc1
  buffer_load_dwordx2 v[82:83], v30, s[48:51], s74 offen offset:2048 sc1
  buffer_load_dwordx2 v[84:85], v30, s[48:51], s75 offen offset:0 sc1
  buffer_load_dwordx2 v[86:87], v30, s[48:51], s75 offen offset:2048 sc1
  s_waitcnt vmcnt(0)
  v_max3_u32 v26, v8, v9, v10
  v_max3_u32 v26, v26, v11, v12
  v_max3_u32 v26, v26, v13, v14
  v_max3_u32 v26, v26, v15, v80
  v_max3_u32 v26, v26, v81, v82
  v_max3_u32 v26, v26, v83, v84
  v_max3_u32 v26, v26, v85, v86
  v_max_u32 v26, v26, v87
  v_cmp_eq_u32 vcc, -1, v26
  s_cbranch_vccz L_xg_564_ok
  s_mov_b64 s[76:77], -1
  s_mov_b64 s[78:79], -1
  s_mov_b64 s[80:81], -1
  s_mov_b64 s[82:83], -1
  s_mov_b64 s[84:85], -1
  s_mov_b64 s[86:87], -1
  s_mov_b64 s[88:89], -1
  s_mov_b64 s[90:91], -1
L_xg_564:
  s_mov_b64 exec, s[76:77]
  s_cbranch_execz L_xg_564_c0
  v_max_u32 v26, v8, v9
  v_cmp_eq_u32 vcc, -1, v26
  s_mov_b64 s[76:77], vcc
L_xg_564_c0:
  s_mov_b64 exec, s[78:79]
  s_cbranch_execz L_xg_564_c1
  v_max_u32 v26, v10, v11
  v_cmp_eq_u32 vcc, -1, v26
  s_mov_b64 s[78:79], vcc
L_xg_564_c1:
  s_mov_b64 exec, s[80:81]
  s_cbranch_execz L_xg_564_c2
  v_max_u32 v26, v12, v13
  v_cmp_eq_u32 vcc, -1, v26
  s_mov_b64 s[80:81], vcc
L_xg_564_c2:
  s_mov_b64 exec, s[82:83]
  s_cbranch_execz L_xg_564_c3
  v_max_u32 v26, v14, v15
  v_cmp_eq_u32 vcc, -1, v26
  s_mov_b64 s[82:83], vcc
L_xg_564_c3:
  s_mov_b64 exec, s[84:85]
  s_cbranch_execz L_xg_564_c4
  v_max_u32 v26, v80, v81
  v_cmp_eq_u32 vcc, -1, v26
  s_mov_b64 s[84:85], vcc
L_xg_564_c4:
  s_mov_b64 exec, s[86:87]
  s_cbranch_execz L_xg_564_c5
  v_max_u32 v26, v82, v83
  v_cmp_eq_u32 vcc, -1, v26
  s_mov_b64 s[86:87], vcc
L_xg_564_c5:
  s_mov_b64 exec, s[88:89]
  s_cbranch_execz L_xg_564_c6
  v_max_u32 v26, v84, v85
  v_cmp_eq_u32 vcc, -1, v26
  s_mov_b64 s[88:89], vcc
L_xg_564_c6:
  s_mov_b64 exec, s[90:91]
  s_cbranch_execz L_xg_564_c7
  v_max_u32 v26, v86, v87
  v_cmp_eq_u32 vcc, -1, v26
  s_mov_b64 s[90:91], vcc
L_xg_564_c7:
  s_mov_b64 s[60:61], s[76:77]
  s_or_b64 s[60:61], s[60:61], s[78:79]
  s_or_b64 s[60:61], s[60:61], s[80:81]
  s_or_b64 s[60:61], s[60:61], s[82:83]
  s_or_b64 s[60:61], s[60:61], s[84:85]
  s_or_b64 s[60:61], s[60:61], s[86:87]
  s_or_b64 s[60:61], s[60:61], s[88:89]
  s_or_b64 s[60:61], s[60:61], s[90:91]
  s_cmp_eq_u64 s[60:61], 0
  s_cbranch_scc1 L_xg_564_x
  s_mov_b64 exec, s[76:77]
  s_cbranch_execz L_xg_564_l0
  buffer_load_dwordx2 v[8:9], v30, s[48:51], s72 offen offset:0 sc1
L_xg_564_l0:
  s_mov_b64 exec, s[78:79]
  s_cbranch_execz L_xg_564_l1
  buffer_load_dwordx2 v[10:11], v30, s[48:51], s72 offen offset:2048 sc1
L_xg_564_l1:
  s_mov_b64 exec, s[80:81]
  s_cbranch_execz L_xg_564_l2
  buffer_load_dwordx2 v[12:13], v30, s[48:51], s73 offen offset:0 sc1
L_xg_564_l2:
  s_mov_b64 exec, s[82:83]
  s_cbranch_execz L_xg_564_l3
  buffer_load_dwordx2 v[14:15], v30, s[48:51], s73 offen offset:2048 sc1
L_xg_564_l3:
  s_mov_b64 exec, s[84:85]
  s_cbranch_execz L_xg_564_l4
  buffer_load_dwordx2 v[80:81], v30, s[48:51], s74 offen offset:0 sc1
L_xg_564_l4:
  s_mov_b64 exec, s[86:87]
  s_cbranch_execz L_xg_564_l5
  buffer_load_dwordx2 v[82:83], v30, s[48:51], s74 offen offset:2048 sc1
L_xg_564_l5:
  s_mov_b64 exec, s[88:89]
  s_cbranch_execz L_xg_564_l6
  buffer_load_dwordx2 v[84:85], v30, s[48:51], s75 offen offset:0 sc1
L_xg_564_l6:
  s_mov_b64 exec, s[90:91]
  s_cbranch_execz L_xg_564_l7
  buffer_load_dwordx2 v[86:87], v30, s[48:51], s75 offen offset:2048 sc1
L_xg_564_l7:
  s_waitcnt vmcnt(0)
  s_sub_u32 s58, s58, 1
  s_cmp_gt_i32 s58, 0
  s_cbranch_scc1 L_xg_564
L_xg_564_x:
  s_mov_b64 exec, -1
L_xg_564_ok:
  v_pk_add_f32 v[8:9], v[8:9], v[10:11]
  v_pk_add_f32 v[12:13], v[12:13], v[14:15]
  v_pk_add_f32 v[80:81], v[80:81], v[82:83]
  v_pk_add_f32 v[84:85], v[84:85], v[86:87]
  v_pk_add_f32 v[8:9], v[8:9], v[12:13]
  v_pk_add_f32 v[80:81], v[80:81], v[84:85]
  v_pk_add_f32 v[8:9], v[8:9], v[80:81]
  v_cvt_pk_bf16_f32 v26, v8, v9
  v_lshlrev_b32 v8, 16, v26
  v_and_b32 v9, 0xffff0000, v26
  v_pk_add_f32 v[22:23], v[22:23], v[8:9]
  v_cvt_pk_bf16_f32 v26, v22, v23
  v_lshlrev_b32 v22, 16, v26
  v_and_b32 v23, 0xffff0000, v26
  v_lshlrev_b32 v30, 3, v0
  ds_write_b64 v30, v[22:23] offset:0
  v_subrev_f32 v26, s70, v22
  v_subrev_f32 v27, s70, v23
  v_add_f32 v28, v26, v27
  v_mul_f32 v29, v26, v26
  v_fmac_f32 v29, v27, v27
  v_lshrrev_b32 v30, 4, v0
  v_lshlrev_b32 v30, 3, v30
  s_nop 0
  v_add_f32_dpp v28, v28, v28 row_ror:8 row_mask:0xf bank_mask:0xf
  v_add_f32_dpp v29, v29, v29 row_ror:8 row_mask:0xf bank_mask:0xf
  s_nop 0
  v_add_f32_dpp v28, v28, v28 row_ror:4 row_mask:0xf bank_mask:0xf
  v_add_f32_dpp v29, v29, v29 row_ror:4 row_mask:0xf bank_mask:0xf
  s_nop 0
  v_add_f32_dpp v28, v28, v28 row_ror:2 row_mask:0xf bank_mask:0xf
  v_add_f32_dpp v29, v29, v29 row_ror:2 row_mask:0xf bank_mask:0xf
  s_nop 0
  v_add_f32_dpp v28, v28, v28 row_ror:1 row_mask:0xf bank_mask:0xf
  v_add_f32_dpp v29, v29, v29 row_ror:1 row_mask:0xf bank_mask:0xf
  ds_write_b64 v30, v[28:29] offset:2944
  s_waitcnt lgkmcnt(0)
  s_barrier
  v_and_b32 v26, 15, v1
  v_lshlrev_b32 v26, 3, v26
  ds_read_b64 v[80:81], v26 offset:2944
  v_lshrrev_b32 v27, 2, v1
  v_lshlrev_b32 v27, 3, v27
  s_lshl_b32 s55, s100, 2
  s_add_u32 s55, s55, s52
  s_lshl_b32 s55, s55, 7
  v_add_u32 v27, s55, v27
  ds_read_b64 v[16:17], v27 offset:0
  v_lshrrev_b32 v28, 5, v1
  v_lshlrev_b32 v28, 7, v28
  v_and_b32 v29, 3, v1
  v_lshl_add_u32 v28, v29, 5, v28
  v_bfe_u32 v29, v1, 4, 1
  v_lshl_add_u32 v28, v29, 4, v28
  s_lshl_b32 s55, s52, 8
  v_add_u32 v28, s55, v28
  v_and_b32 v29, 1, v1
  v_lshlrev_b32 v29, 7, v29
  v_lshrrev_b32 v30, 1, v1
  v_lshl_add_u32 v29, v30, 2, v29
  v_lshlrev_b32 v31, 2, v1
  s_mul_i32 s97, s100, 14336
  s_lshl_b32 s55, s62, 8
  s_add_u32 s97, s97, s55
  s_add_u32 s97, s97, 0x24000
  s_waitcnt lgkmcnt(0)
  s_nop 0
  v_add_f32_dpp v80, v80, v80 row_ror:8 row_mask:0xf bank_mask:0xf
  v_add_f32_dpp v81, v81, v81 row_ror:8 row_mask:0xf bank_mask:0xf
  s_nop 0
  v_add_f32_dpp v80, v80, v80 row_ror:4 row_mask:0xf bank_mask:0xf
  v_add_f32_dpp v81, v81, v81 row_ror:4 row_mask:0xf bank_mask:0xf
  s_nop 0
  v_add_f32_dpp v80, v80, v80 row_ror:2 row_mask:0xf bank_mask:0xf
  v_add_f32_dpp v81, v81, v81 row_ror:2 row_mask:0xf bank_mask:0xf
  s_nop 0
  v_add_f32_dpp v80, v80, v80 row_ror:1 row_mask:0xf bank_mask:0xf
  v_add_f32_dpp v81, v81, v81 row_ror:1 row_mask:0xf bank_mask:0xf
  v_mul_f32 v80, 0x3b000000, v80
  v_mul_f32 v81, 0x3b000000, v81
  v_fma_f32 v81, -v80, v80, v81
  v_max_f32 v81, 0, v81
  v_add_f32 v80, s70, v80
  v_cvt_pk_bf16_f32 v82, v80, v81
  v_lshlrev_b32 v80, 16, v82
  v_and_b32 v81, 0xffff0000, v82
  v_add_f32 v81, 0x3727c5ac, v81
  v_cvt_pk_bf16_f32 v82, v81, v81
  v_lshlrev_b32 v81, 16, v82
  v_sqrt_f32 v81, v81
  v_sub_f32 v16, v16, v80
  v_sub_f32 v17, v17, v80
  v_cvt_pk_bf16_f32 v82, v81, v81
  v_lshlrev_b32 v81, 16, v82
  v_rcp_f32 v81, v81
  v_cvt_pk_bf16_f32 v82, v16, v17
  v_lshlrev_b32 v16, 16, v82
  v_and_b32 v17, 0xffff0000, v82
  v_mul_f32 v16, v16, v81
  v_mul_f32 v17, v17, v81
  v_cvt_pk_bf16_f32 v82, v16, v17
  v_lshlrev_b32 v16, 16, v82
  v_and_b32 v17, 0xffff0000, v82
  v_lshrrev_b32 v18, 16, v16
  v_lshrrev_b32 v19, 16, v17
  v_dot2_f32_bf16 v32, v120, v18, 0
  v_dot2_f32_bf16 v33, v120, v16, 0
  v_dot2_f32_bf16 v34, v121, v18, 0
  v_dot2_f32_bf16 v35, v121, v16, 0
  v_dot2_f32_bf16 v36, v122, v18, 0
  v_dot2_f32_bf16 v37, v122, v16, 0
  v_dot2_f32_bf16 v38, v123, v18, 0
  v_dot2_f32_bf16 v39, v123, v16, 0
  v_dot2c_f32_bf16 v32, v124, v19
  v_dot2c_f32_bf16 v33, v124, v17
  v_dot2c_f32_bf16 v34, v125, v19
  v_dot2c_f32_bf16 v35, v125, v17
  v_dot2c_f32_bf16 v36, v126, v19
  v_dot2c_f32_bf16 v37, v126, v17
  v_dot2c_f32_bf16 v38, v127, v19
  v_dot2c_f32_bf16 v39, v127, v17
  v_lshrrev_b32 v18, 16, v16
  v_lshrrev_b32 v19, 16, v17
  v_dot2_f32_bf16 v8, v128, v18, 0
  v_dot2_f32_bf16 v9, v128, v16, 0
  v_dot2_f32_bf16 v10, v129, v18, 0
  v_dot2_f32_bf16 v11, v129, v16, 0
  v_dot2_f32_bf16 v12, v130, v18, 0
  v_dot2_f32_bf16 v13, v130, v16, 0
  v_dot2_f32_bf16 v14, v131, v18, 0
  v_dot2_f32_bf16 v15, v131, v16, 0
  v_dot2c_f32_bf16 v8, v132, v19
  v_dot2c_f32_bf16 v9, v132, v17
  v_dot2c_f32_bf16 v10, v133, v19
  v_dot2c_f32_bf16 v11, v133, v17
  v_dot2c_f32_bf16 v12, v134, v19
  v_dot2c_f32_bf16 v13, v134, v17
  v_dot2c_f32_bf16 v14, v135, v19
  v_dot2c_f32_bf16 v15, v135, v17
  s_nop 2
  v_permlane32_swap_b32 v32, v8
  v_permlane32_swap_b32 v33, v9
  v_permlane32_swap_b32 v34, v10
  v_permlane32_swap_b32 v35, v11
  v_permlane32_swap_b32 v36, v12
  v_permlane32_swap_b32 v37, v13
  v_permlane32_swap_b32 v38, v14
  v_permlane32_swap_b32 v39, v15
  v_pk_add_f32 v[32:33], v[32:33], v[8:9]
  v_pk_add_f32 v[34:35], v[34:35], v[10:11]
  v_pk_add_f32 v[36:37], v[36:37], v[12:13]
  v_pk_add_f32 v[38:39], v[38:39], v[14:15]
  s_nop 0
  v_permlane16_swap_b32 v32, v36
  v_permlane16_swap_b32 v33, v37
  v_permlane16_swap_b32 v34, v38
  v_permlane16_swap_b32 v35, v39
  s_nop 0
  v_pk_add_f32 v[32:33], v[32:33], v[36:37]
  v_pk_add_f32 v[34:35], v[34:35], v[38:39]
  s_nop 0
  v_add_f32_dpp v32, v32, v32 row_ror:8 row_mask:0xf bank_mask:0xf
  v_add_f32_dpp v33, v33, v33 row_ror:8 row_mask:0xf bank_mask:0xf
  v_add_f32_dpp v34, v34, v34 row_ror:8 row_mask:0xf bank_mask:0xf
  v_add_f32_dpp v35, v35, v35 row_ror:8 row_mask:0xf bank_mask:0xf
  v_add_f32_dpp v32, v32, v32 row_ror:4 row_mask:0xf bank_mask:0xf
  v_add_f32_dpp v33, v33, v33 row_ror:4 row_mask:0xf bank_mask:0xf
  v_add_f32_dpp v34, v34, v34 row_ror:4 row_mask:0xf bank_mask:0xf
  v_add_f32_dpp v35, v35, v35 row_ror:4 row_mask:0xf bank_mask:0xf
  ds_write_b128 v28, v[32:35] offset:3072
  s_waitcnt lgkmcnt(0)
  s_barrier
  ds_read_b32 v8, v29 offset:3072
  ds_read_b32 v9, v29 offset:3328
  ds_read_b32 v10, v29 offset:3584
  ds_read_b32 v11, v29 offset:3840
  s_waitcnt lgkmcnt(0)
  v_pk_add_f32 v[8:9], v[8:9], v[10:11]
  v_add_f32 v8, v8, v9
  v_min_u32 v8, -2, v8
  s_mov_b32 s66, s97
  s_add_u32 s57, s97, 0x22c000
  s_cmp_lg_u32 s52, 0
  s_cbranch_scc1 L_w0_565
  s_cmp_ge_u32 s54, 28
  s_cbranch_scc1 L_w0_565
  buffer_store_dword v8, v31, s[48:51], s57 offen
  s_mov_b64 exec, -1
L_w0_565:
  v_lshrrev_b32 v30, 1, v1
  v_min_u32 v30, 27, v30
  v_lshlrev_b32 v30, 4, v30
  v_add_u32 v27, 0x22c000, v30
  s_mul_i32 s65, s63, 1792
  s_mul_i32 s56, s52, 448
  s_add_u32 s65, s65, s56
  s_add_u32 s72, s65, 0x24000
  s_add_u32 s73, s72, 14336
  s_add_u32 s74, s73, 14336
  s_add_u32 s75, s74, 14336
  v_and_b32 v28, 1, v1
  v_lshlrev_b32 v28, 5, v28
  v_lshrrev_b32 v29, 4, v1
  v_lshl_add_u32 v28, v29, 3, v28
  s_lshl_b32 s55, s52, 6
  v_add_u32 v28, s55, v28
  v_and_b32 v29, 7, v1
  v_lshlrev_b32 v29, 3, v29
  s_lshl_b32 s97, s63, 11
  s_lshl_b32 s56, s64, 6
  s_add_u32 s97, s97, s56
  s_add_u32 s97, s97, 0x18000
  s_cmp_eq_u32 s95, 0
  s_cbranch_scc1 L_hb_566_g
  s_mov_b32 s57, 40
L_hb_566_l:
  buffer_load_dwordx4 v[32:35], v27, s[48:51], s72 offen sc1
  buffer_load_dwordx4 v[36:39], v27, s[48:51], s73 offen sc1
  buffer_load_dwordx4 v[80:83], v27, s[48:51], s74 offen sc1
  buffer_load_dwordx4 v[84:87], v27, s[48:51], s75 offen sc1
  s_waitcnt vmcnt(0)
  v_max3_u32 v26, v32, v33, v34
  v_max3_u32 v26, v26, v35, v36
  v_max3_u32 v26, v26, v37, v38
  v_max3_u32 v26, v26, v39, v80
  v_max3_u32 v26, v26, v81, v82
  v_max3_u32 v26, v26, v83, v84
  v_max3_u32 v26, v26, v85, v86
  v_max_u32 v26, v26, v87
  v_cmp_eq_u32 vcc, -1, v26
  s_cbranch_vccz L_hb_566_lok
  s_sub_u32 s57, s57, 1
  s_cmp_gt_i32 s57, 0
  s_cbranch_scc1 L_hb_566_l
L_hb_566_g:
  s_cmp_lg_u32 s52, 0
  s_cbranch_scc1 L_w0_567
  s_cmp_ge_u32 s54, 28
  s_cbranch_scc1 L_w0_567
  buffer_store_dword v8, v31, s[48:51], s66 offen sc1
  s_mov_b64 exec, -1
L_w0_567:
  s_sleep 16
  buffer_load_dwordx4 v[32:35], v30, s[48:51], s72 offen sc1
  buffer_load_dwordx4 v[36:39], v30, s[48:51], s73 offen sc1
  buffer_load_dwordx4 v[80:83], v30, s[48:51], s74 offen sc1
  buffer_load_dwordx4 v[84:87], v30, s[48:51], s75 offen sc1
  s_waitcnt vmcnt(0)
  v_max3_u32 v26, v32, v33, v34
  v_max3_u32 v26, v26, v35, v36
  v_max3_u32 v26, v26, v37, v38
  v_max3_u32 v26, v26, v39, v80
  v_max3_u32 v26, v26, v81, v82
  v_max3_u32 v26, v26, v83, v84
  v_max3_u32 v26, v26, v85, v86
  v_max_u32 v26, v26, v87
  v_cmp_eq_u32 vcc, -1, v26
  s_cbranch_vccz L_hb_566_ok
  s_mov_b64 s[76:77], -1
  s_mov_b64 s[78:79], -1
  s_mov_b64 s[80:81], -1
  s_mov_b64 s[82:83], -1
L_hb_566:
  s_mov_b64 exec, s[76:77]
  s_cbranch_execz L_hb_566_c0
  v_max3_u32 v26, v32, v33, v34
  v_max_u32 v26, v26, v35
  v_cmp_eq_u32 vcc, -1, v26
  s_mov_b64 s[76:77], vcc
L_hb_566_c0:
  s_mov_b64 exec, s[78:79]
  s_cbranch_execz L_hb_566_c1
  v_max3_u32 v26, v36, v37, v38
  v_max_u32 v26, v26, v39
  v_cmp_eq_u32 vcc, -1, v26
  s_mov_b64 s[78:79], vcc
L_hb_566_c1:
  s_mov_b64 exec, s[80:81]
  s_cbranch_execz L_hb_566_c2
  v_max3_u32 v26, v80, v81, v82
  v_max_u32 v26, v26, v83
  v_cmp_eq_u32 vcc, -1, v26
  s_mov_b64 s[80:81], vcc
L_hb_566_c2:
  s_mov_b64 exec, s[82:83]
  s_cbranch_execz L_hb_566_c3
  v_max3_u32 v26, v84, v85, v86
  v_max_u32 v26, v26, v87
  v_cmp_eq_u32 vcc, -1, v26
  s_mov_b64 s[82:83], vcc
L_hb_566_c3:
  s_mov_b64 s[60:61], s[76:77]
  s_or_b64 s[60:61], s[60:61], s[78:79]
  s_or_b64 s[60:61], s[60:61], s[80:81]
  s_or_b64 s[60:61], s[60:61], s[82:83]
  s_cmp_eq_u64 s[60:61], 0
  s_cbranch_scc1 L_hb_566_x
  s_mov_b64 exec, s[76:77]
  s_cbranch_execz L_hb_566_l0
  buffer_load_dwordx4 v[32:35], v30, s[48:51], s72 offen sc1
L_hb_566_l0:
  s_mov_b64 exec, s[78:79]
  s_cbranch_execz L_hb_566_l1
  buffer_load_dwordx4 v[36:39], v30, s[48:51], s73 offen sc1
L_hb_566_l1:
  s_mov_b64 exec, s[80:81]
  s_cbranch_execz L_hb_566_l2
  buffer_load_dwordx4 v[80:83], v30, s[48:51], s74 offen sc1
L_hb_566_l2:
  s_mov_b64 exec, s[82:83]
  s_cbranch_execz L_hb_566_l3
  buffer_load_dwordx4 v[84:87], v30, s[48:51], s75 offen sc1
L_hb_566_l3:
  s_waitcnt vmcnt(0)
  s_sub_u32 s58, s58, 1
  s_cmp_gt_i32 s58, 0
  s_cbranch_scc1 L_hb_566
L_hb_566_x:
  s_mov_b64 exec, -1
  s_branch L_hb_566_ok
L_hb_566_lok:
  s_cmp_lg_u32 s52, 0
  s_cbranch_scc1 L_w0_568
  s_cmp_ge_u32 s54, 28
  s_cbranch_scc1 L_w0_568
  buffer_store_dword v8, v31, s[48:51], s66 offen sc1
  s_mov_b64 exec, -1
L_w0_568:
L_hb_566_ok:
  v_pk_add_f32 v[32:33], v[32:33], v[36:37]
  v_pk_add_f32 v[80:81], v[80:81], v[84:85]
  v_pk_add_f32 v[34:35], v[34:35], v[38:39]
  v_pk_add_f32 v[82:83], v[82:83], v[86:87]
  v_pk_add_f32 v[32:33], v[32:33], v[80:81]
  v_pk_add_f32 v[34:35], v[34:35], v[82:83]
  v_cvt_pk_bf16_f32 v80, v32, v33
  v_cvt_pk_bf16_f32 v81, v34, v35
  v_lshlrev_b32 v32, 16, v80
  v_lshlrev_b32 v34, 16, v81
  v_and_b32 v33, 0xffff0000, v80
  v_and_b32 v35, 0xffff0000, v81
  v_mul_f32 v80, 0xbfb8aa3b, v32
  v_mul_f32 v81, 0xbfb8aa3b, v34
  v_exp_f32 v80, v80
  v_exp_f32 v81, v81
  s_nop 0
  v_add_f32 v80, 1.0, v80
  v_add_f32 v81, 1.0, v81
  v_rcp_f32 v80, v80
  v_rcp_f32 v81, v81
  s_nop 0
  v_mul_f32 v32, v32, v80
  v_mul_f32 v34, v34, v81
  v_cvt_pk_bf16_f32 v80, v32, v34
  v_lshlrev_b32 v32, 16, v80
  v_and_b32 v34, 0xffff0000, v80
  v_mul_f32 v32, v32, v33
  v_mul_f32 v34, v34, v35
  v_cvt_pk_bf16_f32 v80, v32, v34
  v_cmp_gt_u32 vcc, 56, v1
  s_nop 1
  v_cndmask_b32 v80, 0, v80, vcc
  v_lshlrev_b32 v16, 16, v80
  v_and_b32 v17, 0xffff0000, v80
  v_lshrrev_b32 v18, 16, v16
  v_lshrrev_b32 v19, 16, v17
  v_dot2_f32_bf16 v8, v136, v18, 0
  v_dot2_f32_bf16 v9, v136, v16, 0
  v_dot2_f32_bf16 v10, v137, v18, 0
  v_dot2_f32_bf16 v11, v137, v16, 0
  v_dot2_f32_bf16 v12, v138, v18, 0
  v_dot2_f32_bf16 v13, v138, v16, 0
  v_dot2_f32_bf16 v14, v139, v18, 0
  v_dot2_f32_bf16 v15, v139, v16, 0
  v_dot2c_f32_bf16 v8, v140, v19
  v_dot2c_f32_bf16 v9, v140, v17
  v_dot2c_f32_bf16 v10, v141, v19
  v_dot2c_f32_bf16 v11, v141, v17
  v_dot2c_f32_bf16 v12, v142, v19
  v_dot2c_f32_bf16 v13, v142, v17
  v_dot2c_f32_bf16 v14, v143, v19
  v_dot2c_f32_bf16 v15, v143, v17
  s_nop 2
  v_permlane32_swap_b32 v8, v12
  v_permlane32_swap_b32 v9, v13
  v_permlane32_swap_b32 v10, v14
  v_permlane32_swap_b32 v11, v15
  s_nop 0
  v_add_f32 v8, v8, v12
  v_add_f32 v9, v9, v13
  v_add_f32 v10, v10, v14
  v_add_f32 v11, v11, v15
  s_nop 0
  v_permlane16_swap_b32 v8, v10
  v_permlane16_swap_b32 v9, v11
  s_nop 0
  v_add_f32 v8, v8, v10
  v_add_f32 v9, v9, v11
  s_nop 0
  v_add_f32_dpp v8, v8, v8 row_ror:8 row_mask:0xf bank_mask:0xf
  v_add_f32_dpp v9, v9, v9 row_ror:8 row_mask:0xf bank_mask:0xf
  s_nop 0
  v_add_f32_dpp v8, v8, v8 row_ror:4 row_mask:0xf bank_mask:0xf
  v_add_f32_dpp v9, v9, v9 row_ror:4 row_mask:0xf bank_mask:0xf
  s_nop 0
  v_add_f32_dpp v8, v8, v8 row_ror:2 row_mask:0xf bank_mask:0xf
  v_add_f32_dpp v9, v9, v9 row_ror:2 row_mask:0xf bank_mask:0xf
  ds_write_b64 v28, v[8:9] offset:2560
  s_waitcnt lgkmcnt(0)
  s_barrier
  ds_read_b64 v[8:9], v29 offset:2560
  ds_read_b64 v[10:11], v29 offset:2624
  ds_read_b64 v[12:13], v29 offset:2688
  ds_read_b64 v[14:15], v29 offset:2752
  s_waitcnt lgkmcnt(0)
  v_pk_add_f32 v[8:9], v[8:9], v[10:11]
  v_pk_add_f32 v[12:13], v[12:13], v[14:15]
  v_pk_add_f32 v[80:81], v[8:9], v[12:13]
  v_min_u32 v80, -2, v80
  v_min_u32 v81, -2, v81
  s_cmp_lg_u32 s52, 0
  s_cbranch_scc1 L_w0_569
  s_mov_b64 exec, 0xff
  buffer_store_dwordx2 v[80:81], v29, s[48:51], s97 offen sc1
  s_mov_b64 exec, -1
L_w0_569:
  v_lshlrev_b32 v30, 3, v0
  s_mov_b32 s72, 0x18000
  s_mov_b32 s73, 0x19000
  s_mov_b32 s74, 0x1a000
  s_mov_b32 s75, 0x1b000
  s_sleep 16
  buffer_load_dwordx2 v[8:9], v30, s[48:51], s72 offen offset:0 sc1
  buffer_load_dwordx2 v[10:11], v30, s[48:51], s72 offen offset:2048 sc1
  buffer_load_dwordx2 v[12:13], v30, s[48:51], s73 offen offset:0 sc1
  buffer_load_dwordx2 v[14:15], v30, s[48:51], s73 offen offset:2048 sc1
  buffer_load_dwordx2 v[80:81], v30, s[48:51], s74 offen offset:0 sc1
  buffer_load_dwordx2 v[82:83], v30, s[48:51], s74 offen offset:2048 sc1
  buffer_load_dwordx2 v[84:85], v30, s[48:51], s75 offen offset:0 sc1
  buffer_load_dwordx2 v[86:87], v30, s[48:51], s75 offen offset:2048 sc1
  s_waitcnt vmcnt(0)
  v_max3_u32 v26, v8, v9, v10
  v_max3_u32 v26, v26, v11, v12
  v_max3_u32 v26, v26, v13, v14
  v_max3_u32 v26, v26, v15, v80
  v_max3_u32 v26, v26, v81, v82
  v_max3_u32 v26, v26, v83, v84
  v_max3_u32 v26, v26, v85, v86
  v_max_u32 v26, v26, v87
  v_cmp_eq_u32 vcc, -1, v26
  s_cbranch_vccz L_xg_570_ok
  s_mov_b64 s[76:77], -1
  s_mov_b64 s[78:79], -1
  s_mov_b64 s[80:81], -1
  s_mov_b64 s[82:83], -1
  s_mov_b64 s[84:85], -1
  s_mov_b64 s[86:87], -1
  s_mov_b64 s[88:89], -1
  s_mov_b64 s[90:91], -1
L_xg_570:
  s_mov_b64 exec, s[76:77]
  s_cbranch_execz L_xg_570_c0
  v_max_u32 v26, v8, v9
  v_cmp_eq_u32 vcc, -1, v26
  s_mov_b64 s[76:77], vcc
L_xg_570_c0:
  s_mov_b64 exec, s[78:79]
  s_cbranch_execz L_xg_570_c1
  v_max_u32 v26, v10, v11
  v_cmp_eq_u32 vcc, -1, v26
  s_mov_b64 s[78:79], vcc
L_xg_570_c1:
  s_mov_b64 exec, s[80:81]
  s_cbranch_execz L_xg_570_c2
  v_max_u32 v26, v12, v13
  v_cmp_eq_u32 vcc, -1, v26
  s_mov_b64 s[80:81], vcc
L_xg_570_c2:
  s_mov_b64 exec, s[82:83]
  s_cbranch_execz L_xg_570_c3
  v_max_u32 v26, v14, v15
  v_cmp_eq_u32 vcc, -1, v26
  s_mov_b64 s[82:83], vcc
L_xg_570_c3:
  s_mov_b64 exec, s[84:85]
  s_cbranch_execz L_xg_570_c4
  v_max_u32 v26, v80, v81
  v_cmp_eq_u32 vcc, -1, v26
  s_mov_b64 s[84:85], vcc
L_xg_570_c4:
  s_mov_b64 exec, s[86:87]
  s_cbranch_execz L_xg_570_c5
  v_max_u32 v26, v82, v83
  v_cmp_eq_u32 vcc, -1, v26
  s_mov_b64 s[86:87], vcc
L_xg_570_c5:
  s_mov_b64 exec, s[88:89]
  s_cbranch_execz L_xg_570_c6
  v_max_u32 v26, v84, v85
  v_cmp_eq_u32 vcc, -1, v26
  s_mov_b64 s[88:89], vcc
L_xg_570_c6:
  s_mov_b64 exec, s[90:91]
  s_cbranch_execz L_xg_570_c7
  v_max_u32 v26, v86, v87
  v_cmp_eq_u32 vcc, -1, v26
  s_mov_b64 s[90:91], vcc
L_xg_570_c7:
  s_mov_b64 s[60:61], s[76:77]
  s_or_b64 s[60:61], s[60:61], s[78:79]
  s_or_b64 s[60:61], s[60:61], s[80:81]
  s_or_b64 s[60:61], s[60:61], s[82:83]
  s_or_b64 s[60:61], s[60:61], s[84:85]
  s_or_b64 s[60:61], s[60:61], s[86:87]
  s_or_b64 s[60:61], s[60:61], s[88:89]
  s_or_b64 s[60:61], s[60:61], s[90:91]
  s_cmp_eq_u64 s[60:61], 0
  s_cbranch_scc1 L_xg_570_x
  s_mov_b64 exec, s[76:77]
  s_cbranch_execz L_xg_570_l0
  buffer_load_dwordx2 v[8:9], v30, s[48:51], s72 offen offset:0 sc1
L_xg_570_l0:
  s_mov_b64 exec, s[78:79]
  s_cbranch_execz L_xg_570_l1
  buffer_load_dwordx2 v[10:11], v30, s[48:51], s72 offen offset:2048 sc1
L_xg_570_l1:
  s_mov_b64 exec, s[80:81]
  s_cbranch_execz L_xg_570_l2
  buffer_load_dwordx2 v[12:13], v30, s[48:51], s73 offen offset:0 sc1
L_xg_570_l2:
  s_mov_b64 exec, s[82:83]
  s_cbranch_execz L_xg_570_l3
  buffer_load_dwordx2 v[14:15], v30, s[48:51], s73 offen offset:2048 sc1
L_xg_570_l3:
  s_mov_b64 exec, s[84:85]
  s_cbranch_execz L_xg_570_l4
  buffer_load_dwordx2 v[80:81], v30, s[48:51], s74 offen offset:0 sc1
L_xg_570_l4:
  s_mov_b64 exec, s[86:87]
  s_cbranch_execz L_xg_570_l5
  buffer_load_dwordx2 v[82:83], v30, s[48:51], s74 offen offset:2048 sc1
L_xg_570_l5:
  s_mov_b64 exec, s[88:89]
  s_cbranch_execz L_xg_570_l6
  buffer_load_dwordx2 v[84:85], v30, s[48:51], s75 offen offset:0 sc1
L_xg_570_l6:
  s_mov_b64 exec, s[90:91]
  s_cbranch_execz L_xg_570_l7
  buffer_load_dwordx2 v[86:87], v30, s[48:51], s75 offen offset:2048 sc1
L_xg_570_l7:
  s_waitcnt vmcnt(0)
  s_sub_u32 s58, s58, 1
  s_cmp_gt_i32 s58, 0
  s_cbranch_scc1 L_xg_570
L_xg_570_x:
  s_mov_b64 exec, -1
L_xg_570_ok:
  v_pk_add_f32 v[8:9], v[8:9], v[10:11]
  v_pk_add_f32 v[12:13], v[12:13], v[14:15]
  v_pk_add_f32 v[80:81], v[80:81], v[82:83]
  v_pk_add_f32 v[84:85], v[84:85], v[86:87]
  v_pk_add_f32 v[8:9], v[8:9], v[12:13]
  v_pk_add_f32 v[80:81], v[80:81], v[84:85]
  v_pk_add_f32 v[8:9], v[8:9], v[80:81]
  v_cvt_pk_bf16_f32 v26, v8, v9
  v_lshlrev_b32 v8, 16, v26
  v_and_b32 v9, 0xffff0000, v26
  v_pk_add_f32 v[22:23], v[22:23], v[8:9]
  v_cvt_pk_bf16_f32 v26, v22, v23
  v_lshlrev_b32 v22, 16, v26
  v_and_b32 v23, 0xffff0000, v26
  v_lshlrev_b32 v30, 3, v0
  ds_write_b64 v30, v[22:23] offset:0
  v_subrev_f32 v26, s70, v22
  v_subrev_f32 v27, s70, v23
  v_add_f32 v28, v26, v27
  v_mul_f32 v29, v26, v26
  v_fmac_f32 v29, v27, v27
  v_lshrrev_b32 v30, 4, v0
  v_lshlrev_b32 v30, 3, v30
  s_nop 0
  v_add_f32_dpp v28, v28, v28 row_ror:8 row_mask:0xf bank_mask:0xf
  v_add_f32_dpp v29, v29, v29 row_ror:8 row_mask:0xf bank_mask:0xf
  s_nop 0
  v_add_f32_dpp v28, v28, v28 row_ror:4 row_mask:0xf bank_mask:0xf
  v_add_f32_dpp v29, v29, v29 row_ror:4 row_mask:0xf bank_mask:0xf
  s_nop 0
  v_add_f32_dpp v28, v28, v28 row_ror:2 row_mask:0xf bank_mask:0xf
  v_add_f32_dpp v29, v29, v29 row_ror:2 row_mask:0xf bank_mask:0xf
  s_nop 0
  v_add_f32_dpp v28, v28, v28 row_ror:1 row_mask:0xf bank_mask:0xf
  v_add_f32_dpp v29, v29, v29 row_ror:1 row_mask:0xf bank_mask:0xf
  ds_write_b64 v30, v[28:29] offset:2816
  s_waitcnt lgkmcnt(0)
  s_barrier
  v_and_b32 v26, 15, v1
  v_lshlrev_b32 v26, 3, v26
  ds_read_b64 v[80:81], v26 offset:2816
  v_lshrrev_b32 v27, 1, v1
  v_lshlrev_b32 v27, 4, v27
  s_lshl_b32 s55, s52, 9
  v_add_u32 v27, s55, v27
  ds_read_b128 v[16:19], v27 offset:0
  v_and_b32 v28, 1, v1
  v_lshlrev_b32 v28, 5, v28
  v_lshrrev_b32 v29, 4, v1
  v_lshl_add_u32 v28, v29, 3, v28
  s_lshl_b32 s55, s52, 6
  v_add_u32 v28, s55, v28
  v_and_b32 v29, 7, v1
  v_lshlrev_b32 v29, 3, v29
  s_waitcnt lgkmcnt(0)
  s_nop 0
  v_add_f32_dpp v80, v80, v80 row_ror:8 row_mask:0xf bank_mask:0xf
  v_add_f32_dpp v81, v81, v81 row_ror:8 row_mask:0xf bank_mask:0xf
  s_nop 0
  v_add_f32_dpp v80, v80, v80 row_ror:4 row_mask:0xf bank_mask:0xf
  v_add_f32_dpp v81, v81, v81 row_ror:4 row_mask:0xf bank_mask:0xf
  s_nop 0
  v_add_f32_dpp v80, v80, v80 row_ror:2 row_mask:0xf bank_mask:0xf
  v_add_f32_dpp v81, v81, v81 row_ror:2 row_mask:0xf bank_mask:0xf
  s_nop 0
  v_add_f32_dpp v80, v80, v80 row_ror:1 row_mask:0xf bank_mask:0xf
  v_add_f32_dpp v81, v81, v81 row_ror:1 row_mask:0xf bank_mask:0xf
  v_mul_f32 v80, 0x3b000000, v80
  v_mul_f32 v81, 0x3b000000, v81
  v_fma_f32 v81, -v80, v80, v81
  v_max_f32 v81, 0, v81
  v_add_f32 v80, s70, v80
  v_cvt_pk_bf16_f32 v82, v80, v81
  v_lshlrev_b32 v80, 16, v82
  v_and_b32 v81, 0xffff0000, v82
  v_add_f32 v81, 0x3727c5ac, v81
  v_cvt_pk_bf16_f32 v82, v81, v81
  v_lshlrev_b32 v81, 16, v82
  v_sqrt_f32 v81, v81
  v_sub_f32 v16, v16, v80
  v_sub_f32 v17, v17, v80
  v_sub_f32 v18, v18, v80
  v_sub_f32 v19, v19, v80
  v_cvt_pk_bf16_f32 v82, v81, v81
  v_lshlrev_b32 v81, 16, v82
  v_rcp_f32 v81, v81
  v_cvt_pk_bf16_f32 v82, v16, v17
  v_lshlrev_b32 v16, 16, v82
  v_and_b32 v17, 0xffff0000, v82
  v_cvt_pk_bf16_f32 v82, v18, v19
  v_lshlrev_b32 v18, 16, v82
  v_and_b32 v19, 0xffff0000, v82
  v_mul_f32 v16, v16, v81
  v_mul_f32 v17, v17, v81
  v_mul_f32 v18, v18, v81
  v_mul_f32 v19, v19, v81
  v_cvt_pk_bf16_f32 v82, v16, v17
  v_lshlrev_b32 v16, 16, v82
  v_and_b32 v17, 0xffff0000, v82
  v_cvt_pk_bf16_f32 v82, v18, v19
  v_lshlrev_b32 v18, 16, v82
  v_and_b32 v19, 0xffff0000, v82
  v_lshrrev_b32 v32, 16, v16
  v_lshrrev_b32 v33, 16, v17
  v_lshrrev_b32 v34, 16, v18
  v_lshrrev_b32 v35, 16, v19
  v_dot2_f32_bf16 v8, v88, v32, 0
  v_dot2_f32_bf16 v9, v88, v16, 0
  v_dot2_f32_bf16 v10, v89, v32, 0
  v_dot2_f32_bf16 v11, v89, v16, 0
  v_dot2_f32_bf16 v12, v90, v32, 0
  v_dot2_f32_bf16 v13, v90, v16, 0
  v_dot2_f32_bf16 v14, v91, v32, 0
  v_dot2_f32_bf16 v15, v91, v16, 0
  v_dot2c_f32_bf16 v8, v92, v33
  v_dot2c_f32_bf16 v9, v92, v17
  v_dot2c_f32_bf16 v10, v93, v33
  v_dot2c_f32_bf16 v11, v93, v17
  v_dot2c_f32_bf16 v12, v94, v33
  v_dot2c_f32_bf16 v13, v94, v17
  v_dot2c_f32_bf16 v14, v95, v33
  v_dot2c_f32_bf16 v15, v95, v17
  v_dot2c_f32_bf16 v8, v96, v34
  v_dot2c_f32_bf16 v9, v96, v18
  v_dot2c_f32_bf16 v10, v97, v34
  v_dot2c_f32_bf16 v11, v97, v18
  v_dot2c_f32_bf16 v12, v98, v34
  v_dot2c_f32_bf16 v13, v98, v18
  v_dot2c_f32_bf16 v14, v99, v34
  v_dot2c_f32_bf16 v15, v99, v18
  v_dot2c_f32_bf16 v8, v100, v35
  v_dot2c_f32_bf16 v9, v100, v19
  v_dot2c_f32_bf16 v10, v101, v35
  v_dot2c_f32_bf16 v11, v101, v19
  v_dot2c_f32_bf16 v12, v102, v35
  v_dot2c_f32_bf16 v13, v102, v19
  v_dot2c_f32_bf16 v14, v103, v35
  v_dot2c_f32_bf16 v15, v103, v19
  s_nop 2
  v_permlane32_swap_b32 v8, v12
  v_permlane32_swap_b32 v9, v13
  v_permlane32_swap_b32 v10, v14
  v_permlane32_swap_b32 v11, v15
  s_nop 0
  v_add_f32 v8, v8, v12
  v_add_f32 v9, v9, v13
  v_add_f32 v10, v10, v14
  v_add_f32 v11, v11, v15
  s_nop 0
  v_permlane16_swap_b32 v8, v10
  v_permlane16_swap_b32 v9, v11
  s_nop 0
  v_add_f32 v8, v8, v10
  v_add_f32 v9, v9, v11
  s_nop 0
  v_add_f32_dpp v8, v8, v8 row_ror:8 row_mask:0xf bank_mask:0xf
  v_add_f32_dpp v9, v9, v9 row_ror:8 row_mask:0xf bank_mask:0xf
  s_nop 0
  v_add_f32_dpp v8, v8, v8 row_ror:4 row_mask:0xf bank_mask:0xf
  v_add_f32_dpp v9, v9, v9 row_ror:4 row_mask:0xf bank_mask:0xf
  s_nop 0
  v_add_f32_dpp v8, v8, v8 row_ror:2 row_mask:0xf bank_mask:0xf
  v_add_f32_dpp v9, v9, v9 row_ror:2 row_mask:0xf bank_mask:0xf
  ds_write_b64 v28, v[8:9] offset:2048
  s_waitcnt lgkmcnt(0)
  s_barrier
  ds_read_b64 v[8:9], v29 offset:2048
  ds_read_b64 v[10:11], v29 offset:2112
  ds_read_b64 v[12:13], v29 offset:2176
  ds_read_b64 v[14:15], v29 offset:2240
  s_waitcnt lgkmcnt(0)
  v_pk_add_f32 v[8:9], v[8:9], v[10:11]
  v_pk_add_f32 v[12:13], v[12:13], v[14:15]
  v_pk_add_f32 v[80:81], v[8:9], v[12:13]
  v_cvt_pk_bf16_f32 v82, v80, v81
  v_min_u32 v82, -2, v82
  v_lshlrev_b32 v83, 2, v1
  s_lshl_b32 s97, s53, 10
  s_lshl_b32 s56, s54, 5
  s_add_u32 s97, s97, s56
  s_add_u32 s97, s97, 0x280000
  s_add_u32 s72, s97, 0x16000
  s_cmp_lg_u32 s52, 0
  s_cbranch_scc1 L_w0_571
  s_mov_b64 exec, 0xff
  buffer_store_dword v82, v83, s[48:51], s72 offen
  s_mov_b64 exec, -1
L_w0_571:
  v_and_b32 v30, 3, v1
  v_lshlrev_b32 v30, 8, v30
  v_lshrrev_b32 v31, 2, v1
  v_lshl_add_u32 v30, v31, 4, v30
  s_lshl_b32 s65, s53, 10
  s_add_u32 s65, s65, 0x280000
  s_add_u32 s72, s65, 0x16000
  s_cmp_eq_u32 s95, 0
  s_cbranch_scc1 L_q1_572_g
  s_mov_b32 s57, 40
L_q1_572_l:
  buffer_load_dwordx4 v[4:7], v30, s[48:51], s72 offen sc1
  s_waitcnt vmcnt(0)
  v_max3_u32 v26, v4, v5, v6
  v_max_u32 v26, v26, v7
  v_cmp_eq_u32 vcc, -1, v26
  s_cbranch_vccz L_q1_572_lok
  s_sub_u32 s57, s57, 1
  s_cmp_gt_i32 s57, 0
  s_cbranch_scc1 L_q1_572_l
L_q1_572_g:
  s_cmp_lg_u32 s52, 0
  s_cbranch_scc1 L_w0_573
  s_mov_b64 exec, 0xff
  buffer_store_dword v82, v83, s[48:51], s97 offen sc1
  s_mov_b64 exec, -1
L_w0_573:
  s_sleep 14
  buffer_load_dwordx4 v[4:7], v30, s[48:51], s65 offen sc1
  s_waitcnt vmcnt(0)
  v_max3_u32 v26, v4, v5, v6
  v_max_u32 v26, v26, v7
  v_cmp_eq_u32 vcc, -1, v26
  s_cbranch_vccz L_q1_572_ok
  s_mov_b64 s[76:77], -1
L_q1_572:
  s_mov_b64 exec, s[76:77]
  s_cbranch_execz L_q1_572_c0
  v_max3_u32 v26, v4, v5, v6
  v_max_u32 v26, v26, v7
  v_cmp_eq_u32 vcc, -1, v26
  s_mov_b64 s[76:77], vcc
L_q1_572_c0:
  s_mov_b64 s[60:61], s[76:77]
  s_cmp_eq_u64 s[60:61], 0
  s_cbranch_scc1 L_q1_572_x
  s_mov_b64 exec, s[76:77]
  s_cbranch_execz L_q1_572_l0
  buffer_load_dwordx4 v[4:7], v30, s[48:51], s65 offen sc1
L_q1_572_l0:
  s_waitcnt vmcnt(0)
  s_sub_u32 s58, s58, 1
  s_cmp_gt_i32 s58, 0
  s_cbranch_scc1 L_q1_572
L_q1_572_x:
  s_mov_b64 exec, -1
  s_branch L_q1_572_ok
L_q1_572_lok:
  s_cmp_lg_u32 s52, 0
  s_cbranch_scc1 L_w0_574
  s_mov_b64 exec, 0xff
  buffer_store_dword v82, v83, s[48:51], s97 offen sc1
  s_mov_b64 exec, -1
L_w0_574:
L_q1_572_ok:
  v_mfma_f32_16x16x32_bf16 v[80:83], a[92:95], v[4:7], 0
  s_nop 2
  v_mfma_f32_16x16x32_bf16 v[8:11], a[96:99], v[4:7], 0
  s_nop 2
  v_mfma_f32_16x16x32_bf16 v[84:87], a[100:103], v[4:7], 0
  v_add_f32_dpp v60, v81, v80 row_ror:12 row_mask:0xf bank_mask:0x1
  v_add_f32_dpp v60, v82, v60 row_ror:8 row_mask:0xf bank_mask:0x1
  v_add_f32_dpp v60, v83, v60 row_ror:4 row_mask:0xf bank_mask:0x1
  v_mfma_f32_16x16x32_bf16 v[12:15], a[104:107], v[4:7], 0
  v_add_f32_dpp v60, v8, v9 row_ror:4 row_mask:0xf bank_mask:0x2
  v_add_f32_dpp v60, v10, v60 row_ror:12 row_mask:0xf bank_mask:0x2
  v_add_f32_dpp v60, v11, v60 row_ror:8 row_mask:0xf bank_mask:0x2
  v_mfma_f32_16x16x32_bf16 v[80:83], a[108:111], v[4:7], 0
  v_accvgpr_write_b32 a108, v56
  v_accvgpr_write_b32 a109, v57
  v_accvgpr_write_b32 a110, v58
  v_accvgpr_write_b32 a111, v59
  v_add_f32_dpp v60, v84, v86 row_ror:8 row_mask:0xf bank_mask:0x4
  v_add_f32_dpp v60, v85, v60 row_ror:4 row_mask:0xf bank_mask:0x4
  v_add_f32_dpp v60, v87, v60 row_ror:12 row_mask:0xf bank_mask:0x4
  v_mfma_f32_16x16x32_bf16 v[8:11], a[112:115], v[4:7], 0
  v_accvgpr_write_b32 a112, v52
  v_accvgpr_write_b32 a113, v53
  v_accvgpr_write_b32 a114, v54
  v_accvgpr_write_b32 a115, v55
  v_add_f32_dpp v60, v12, v15 row_ror:12 row_mask:0xf bank_mask:0x8
  v_add_f32_dpp v60, v13, v60 row_ror:8 row_mask:0xf bank_mask:0x8
  v_add_f32_dpp v60, v14, v60 row_ror:4 row_mask:0xf bank_mask:0x8
  v_mfma_f32_16x16x32_bf16 v[84:87], a[116:119], v[4:7], 0
  v_accvgpr_write_b32 a116, v48
  v_accvgpr_write_b32 a117, v49
  v_accvgpr_write_b32 a118, v50
  v_accvgpr_write_b32 a119, v51
  ds_read_b128 a[92:95], v25 offset:0
  ds_read_b128 a[96:99], v25 offset:1024
  ds_read_b128 a[100:103], v25 offset:2048
  ds_read_b128 a[104:107], v25 offset:3072
  v_add_f32_dpp v61, v81, v80 row_ror:12 row_mask:0xf bank_mask:0x1
  v_add_f32_dpp v61, v82, v61 row_ror:8 row_mask:0xf bank_mask:0x1
  v_add_f32_dpp v61, v83, v61 row_ror:4 row_mask:0xf bank_mask:0x1
  v_mfma_f32_16x16x32_bf16 v[12:15], a[120:123], v[4:7], 0
  v_accvgpr_write_b32 a120, v44
  v_accvgpr_write_b32 a121, v45
  v_accvgpr_write_b32 a122, v46
  v_accvgpr_write_b32 a123, v47
  v_add_f32_dpp v61, v8, v9 row_ror:4 row_mask:0xf bank_mask:0x2
  v_add_f32_dpp v61, v10, v61 row_ror:12 row_mask:0xf bank_mask:0x2
  v_add_f32_dpp v61, v11, v61 row_ror:8 row_mask:0xf bank_mask:0x2
  v_mfma_f32_16x16x32_bf16 v[80:83], a[124:127], v[4:7], 0
  v_accvgpr_write_b32 a124, v40
  v_accvgpr_write_b32 a125, v41
  v_accvgpr_write_b32 a126, v42
  v_accvgpr_write_b32 a127, v43
  v_add_f32_dpp v61, v84, v86 row_ror:8 row_mask:0xf bank_mask:0x4
  v_add_f32_dpp v61, v85, v61 row_ror:4 row_mask:0xf bank_mask:0x4
  v_add_f32_dpp v61, v87, v61 row_ror:12 row_mask:0xf bank_mask:0x4
  v_mfma_f32_16x16x32_bf16 v[8:11], a[128:131], v[4:7], 0
  s_mov_b32 s59, 0x1c000
  s_bitcmp1_b32 s99, 0
  s_cbranch_scc1 L_th_575
  s_waitcnt vmcnt(5)
L_th_575:
  buffer_load_dwordx4 a[128:131], v3, s[12:15], s59 offen offset:3072
  v_add_f32_dpp v61, v12, v15 row_ror:12 row_mask:0xf bank_mask:0x8
  v_add_f32_dpp v61, v13, v61 row_ror:8 row_mask:0xf bank_mask:0x8
  v_add_f32_dpp v61, v14, v61 row_ror:4 row_mask:0xf bank_mask:0x8
  v_mfma_f32_16x16x32_bf16 v[84:87], a[132:135], v[4:7], 0
  s_bitcmp1_b32 s99, 0
  s_cbranch_scc1 L_th_577
  s_waitcnt vmcnt(5)
L_th_577:
  buffer_load_dwordx4 a[132:135], v3, s[12:15], s59 offen offset:2048
  v_add_f32_dpp v62, v81, v80 row_ror:12 row_mask:0xf bank_mask:0x1
  v_add_f32_dpp v62, v82, v62 row_ror:8 row_mask:0xf bank_mask:0x1
  v_add_f32_dpp v62, v83, v62 row_ror:4 row_mask:0xf bank_mask:0x1
  v_mfma_f32_16x16x32_bf16 v[12:15], a[136:139], v[4:7], 0
  s_bitcmp1_b32 s99, 0
  s_cbranch_scc1 L_th_579
  s_waitcnt vmcnt(5)
L_th_579:
  buffer_load_dwordx4 a[136:139], v3, s[12:15], s59 offen offset:1024
  v_add_f32_dpp v62, v8, v9 row_ror:4 row_mask:0xf bank_mask:0x2
  v_add_f32_dpp v62, v10, v62 row_ror:12 row_mask:0xf bank_mask:0x2
  v_add_f32_dpp v62, v11, v62 row_ror:8 row_mask:0xf bank_mask:0x2
  v_mfma_f32_16x16x32_bf16 v[80:83], a[140:143], v[4:7], 0
  s_bitcmp1_b32 s99, 0
  s_cbranch_scc1 L_th_581
  s_waitcnt vmcnt(5)
L_th_581:
  buffer_load_dwordx4 a[140:143], v3, s[12:15], s59 offen offset:0
  v_add_f32_dpp v62, v84, v86 row_ror:8 row_mask:0xf bank_mask:0x4
  v_add_f32_dpp v62, v85, v62 row_ror:4 row_mask:0xf bank_mask:0x4
  v_add_f32_dpp v62, v87, v62 row_ror:12 row_mask:0xf bank_mask:0x4
  v_mfma_f32_16x16x32_bf16 v[8:11], a[144:147], v[4:7], 0
  s_mov_b32 s59, 0x1b000
  s_bitcmp1_b32 s99, 0
  s_cbranch_scc1 L_th_583
  s_waitcnt vmcnt(5)
L_th_583:
  buffer_load_dwordx4 a[144:147], v3, s[12:15], s59 offen offset:3072
  v_add_f32_dpp v62, v12, v15 row_ror:12 row_mask:0xf bank_mask:0x8
  v_add_f32_dpp v62, v13, v62 row_ror:8 row_mask:0xf bank_mask:0x8
  v_add_f32_dpp v62, v14, v62 row_ror:4 row_mask:0xf bank_mask:0x8
  v_mfma_f32_16x16x32_bf16 v[84:87], a[148:151], v[4:7], 0
  s_bitcmp1_b32 s99, 0
  s_cbranch_scc1 L_th_585
  s_waitcnt vmcnt(5)
L_th_585:
  buffer_load_dwordx4 a[148:151], v3, s[12:15], s59 offen offset:2048
  v_add_f32_dpp v63, v81, v80 row_ror:12 row_mask:0xf bank_mask:0x1
  v_add_f32_dpp v63, v82, v63 row_ror:8 row_mask:0xf bank_mask:0x1
  v_add_f32_dpp v63, v83, v63 row_ror:4 row_mask:0xf bank_mask:0x1
  v_mfma_f32_16x16x32_bf16 v[12:15], a[152:155], v[4:7], 0
  s_bitcmp1_b32 s99, 0
  s_cbranch_scc1 L_th_587
  s_waitcnt vmcnt(5)
L_th_587:
  buffer_load_dwordx4 a[152:155], v3, s[12:15], s59 offen offset:1024
  v_add_f32_dpp v63, v8, v9 row_ror:4 row_mask:0xf bank_mask:0x2
  v_add_f32_dpp v63, v10, v63 row_ror:12 row_mask:0xf bank_mask:0x2
  v_add_f32_dpp v63, v11, v63 row_ror:8 row_mask:0xf bank_mask:0x2
  v_mfma_f32_16x16x32_bf16 v[80:83], a[156:159], v[4:7], 0
  s_bitcmp1_b32 s99, 0
  s_cbranch_scc1 L_th_589
  s_waitcnt vmcnt(5)
L_th_589:
  buffer_load_dwordx4 a[156:159], v3, s[12:15], s59 offen offset:0
  v_add_f32_dpp v63, v84, v86 row_ror:8 row_mask:0xf bank_mask:0x4
  v_add_f32_dpp v63, v85, v63 row_ror:4 row_mask:0xf bank_mask:0x4
  v_add_f32_dpp v63, v87, v63 row_ror:12 row_mask:0xf bank_mask:0x4
  v_mfma_f32_16x16x32_bf16 v[8:11], a[160:163], v[4:7], 0
  s_mov_b32 s59, 0x1a000
  s_bitcmp1_b32 s99, 0
  s_cbranch_scc1 L_th_591
  s_waitcnt vmcnt(5)
L_th_591:
  buffer_load_dwordx4 a[160:163], v3, s[12:15], s59 offen offset:3072
  v_add_f32_dpp v63, v12, v15 row_ror:12 row_mask:0xf bank_mask:0x8
  v_add_f32_dpp v63, v13, v63 row_ror:8 row_mask:0xf bank_mask:0x8
  v_add_f32_dpp v63, v14, v63 row_ror:4 row_mask:0xf bank_mask:0x8
  v_mfma_f32_16x16x32_bf16 v[84:87], a[164:167], v[4:7], 0
  s_bitcmp1_b32 s99, 0
  s_cbranch_scc1 L_th_593
  s_waitcnt vmcnt(5)
L_th_593:
  buffer_load_dwordx4 a[164:167], v3, s[12:15], s59 offen offset:2048
  v_add_f32_dpp v41, v80, v83 row_ror:12 row_mask:0xf bank_mask:0x8
  v_add_f32_dpp v41, v81, v41 row_ror:8 row_mask:0xf bank_mask:0x8
  v_add_f32_dpp v41, v82, v41 row_ror:4 row_mask:0xf bank_mask:0x8
  v_mfma_f32_16x16x32_bf16 v[12:15], a[168:171], v[4:7], 0
  s_bitcmp1_b32 s99, 0
  s_cbranch_scc1 L_th_595
  s_waitcnt vmcnt(5)
L_th_595:
  buffer_load_dwordx4 a[168:171], v3, s[12:15], s59 offen offset:1024
  v_add_f32_dpp v42, v9, v8 row_ror:12 row_mask:0xf bank_mask:0x1
  v_add_f32_dpp v42, v10, v42 row_ror:8 row_mask:0xf bank_mask:0x1
  v_add_f32_dpp v42, v11, v42 row_ror:4 row_mask:0xf bank_mask:0x1
  v_mfma_f32_16x16x32_bf16 v[80:83], a[172:175], v[4:7], 0
  s_bitcmp1_b32 s99, 0
  s_cbranch_scc1 L_th_597
  s_waitcnt vmcnt(5)
L_th_597:
  buffer_load_dwordx4 a[172:175], v3, s[12:15], s59 offen offset:0
  v_add_f32_dpp v42, v84, v85 row_ror:4 row_mask:0xf bank_mask:0x2
  v_add_f32_dpp v42, v86, v42 row_ror:12 row_mask:0xf bank_mask:0x2
  v_add_f32_dpp v42, v87, v42 row_ror:8 row_mask:0xf bank_mask:0x2
  v_mfma_f32_16x16x32_bf16 v[8:11], a[176:179], v[4:7], 0
  s_mov_b32 s59, 0x19000
  s_bitcmp1_b32 s99, 0
  s_cbranch_scc1 L_th_599
  s_waitcnt vmcnt(5)
L_th_599:
  buffer_load_dwordx4 a[176:179], v3, s[12:15], s59 offen offset:3072
  v_add_f32_dpp v42, v12, v14 row_ror:8 row_mask:0xf bank_mask:0x4
  v_add_f32_dpp v42, v13, v42 row_ror:4 row_mask:0xf bank_mask:0x4
  v_add_f32_dpp v42, v15, v42 row_ror:12 row_mask:0xf bank_mask:0x4
  v_mfma_f32_16x16x32_bf16 v[84:87], a[180:183], v[4:7], 0
  s_bitcmp1_b32 s99, 0
  s_cbranch_scc1 L_th_601
  s_waitcnt vmcnt(5)
L_th_601:
  buffer_load_dwordx4 a[180:183], v3, s[12:15], s59 offen offset:2048
  v_add_f32_dpp v42, v80, v83 row_ror:12 row_mask:0xf bank_mask:0x8
  v_add_f32_dpp v42, v81, v42 row_ror:8 row_mask:0xf bank_mask:0x8
  v_add_f32_dpp v42, v82, v42 row_ror:4 row_mask:0xf bank_mask:0x8
  v_mfma_f32_16x16x32_bf16 v[12:15], a[184:187], v[4:7], 0
  s_bitcmp1_b32 s99, 0
  s_cbranch_scc1 L_th_603
  s_waitcnt vmcnt(5)
L_th_603:
  buffer_load_dwordx4 a[184:187], v3, s[12:15], s59 offen offset:1024
  v_add_f32_dpp v43, v9, v8 row_ror:12 row_mask:0xf bank_mask:0x1
  v_add_f32_dpp v43, v10, v43 row_ror:8 row_mask:0xf bank_mask:0x1
  v_add_f32_dpp v43, v11, v43 row_ror:4 row_mask:0xf bank_mask:0x1
  v_mfma_f32_16x16x32_bf16 v[80:83], a[188:191], v[4:7], 0
  s_bitcmp1_b32 s99, 0
  s_cbranch_scc1 L_th_605
  s_waitcnt vmcnt(5)
L_th_605:
  buffer_load_dwordx4 a[188:191], v3, s[12:15], s59 offen offset:0
  v_add_f32_dpp v43, v84, v85 row_ror:4 row_mask:0xf bank_mask:0x2
  v_add_f32_dpp v43, v86, v43 row_ror:12 row_mask:0xf bank_mask:0x2
  v_add_f32_dpp v43, v87, v43 row_ror:8 row_mask:0xf bank_mask:0x2
  v_mfma_f32_16x16x32_bf16 v[8:11], a[192:195], v[4:7], 0
  s_mov_b32 s59, 0x18000
  s_bitcmp1_b32 s99, 0
  s_cbranch_scc1 L_th_607
  s_waitcnt vmcnt(5)
L_th_607:
  buffer_load_dwordx4 a[192:195], v3, s[12:15], s59 offen offset:3072
  v_add_f32_dpp v43, v12, v14 row_ror:8 row_mask:0xf bank_mask:0x4
  v_add_f32_dpp v43, v13, v43 row_ror:4 row_mask:0xf bank_mask:0x4
  v_add_f32_dpp v43, v15, v43 row_ror:12 row_mask:0xf bank_mask:0x4
  v_mfma_f32_16x16x32_bf16 v[84:87], a[196:199], v[4:7], 0
  s_bitcmp1_b32 s99, 0
  s_cbranch_scc1 L_th_609
  s_waitcnt vmcnt(5)
L_th_609:
  buffer_load_dwordx4 a[196:199], v3, s[12:15], s59 offen offset:2048
  v_add_f32_dpp v43, v80, v83 row_ror:12 row_mask:0xf bank_mask:0x8
  v_add_f32_dpp v43, v81, v43 row_ror:8 row_mask:0xf bank_mask:0x8
  v_add_f32_dpp v43, v82, v43 row_ror:4 row_mask:0xf bank_mask:0x8
  v_mfma_f32_16x16x32_bf16 v[12:15], a[200:203], v[4:7], 0
  s_bitcmp1_b32 s99, 0
  s_cbranch_scc1 L_th_611
  s_waitcnt vmcnt(5)
L_th_611:
  buffer_load_dwordx4 a[200:203], v3, s[12:15], s59 offen offset:1024
  v_add_f32_dpp v44, v9, v8 row_ror:12 row_mask:0xf bank_mask:0x1
  v_add_f32_dpp v44, v10, v44 row_ror:8 row_mask:0xf bank_mask:0x1
  v_add_f32_dpp v44, v11, v44 row_ror:4 row_mask:0xf bank_mask:0x1
  v_mfma_f32_16x16x32_bf16 v[80:83], a[204:207], v[4:7], 0
  s_bitcmp1_b32 s99, 0
  s_cbranch_scc1 L_th_613
  s_waitcnt vmcnt(5)
L_th_613:
  buffer_load_dwordx4 a[204:207], v3, s[12:15], s59 offen offset:0
  v_add_f32_dpp v44, v84, v85 row_ror:4 row_mask:0xf bank_mask:0x2
  v_add_f32_dpp v44, v86, v44 row_ror:12 row_mask:0xf bank_mask:0x2
  v_add_f32_dpp v44, v87, v44 row_ror:8 row_mask:0xf bank_mask:0x2
  v_mfma_f32_16x16x32_bf16 v[8:11], a[208:211], v[4:7], 0
  s_mov_b32 s59, 0x17000
  s_bitcmp1_b32 s99, 0
  s_cbranch_scc1 L_th_615
  s_waitcnt vmcnt(5)
L_th_615:
  buffer_load_dwordx4 a[208:211], v3, s[12:15], s59 offen offset:3072
  v_add_f32_dpp v44, v12, v14 row_ror:8 row_mask:0xf bank_mask:0x4
  v_add_f32_dpp v44, v13, v44 row_ror:4 row_mask:0xf bank_mask:0x4
  v_add_f32_dpp v44, v15, v44 row_ror:12 row_mask:0xf bank_mask:0x4
  v_mfma_f32_16x16x32_bf16 v[84:87], a[212:215], v[4:7], 0
  s_bitcmp1_b32 s99, 0
  s_cbranch_scc1 L_th_617
  s_waitcnt vmcnt(5)
L_th_617:
  buffer_load_dwordx4 a[212:215], v3, s[12:15], s59 offen offset:2048
  v_add_f32_dpp v44, v80, v83 row_ror:12 row_mask:0xf bank_mask:0x8
  v_add_f32_dpp v44, v81, v44 row_ror:8 row_mask:0xf bank_mask:0x8
  v_add_f32_dpp v44, v82, v44 row_ror:4 row_mask:0xf bank_mask:0x8
  v_mfma_f32_16x16x32_bf16 v[12:15], a[216:219], v[4:7], 0
  s_bitcmp1_b32 s99, 0
  s_cbranch_scc1 L_th_619
  s_waitcnt vmcnt(5)
L_th_619:
  buffer_load_dwordx4 a[216:219], v3, s[12:15], s59 offen offset:1024
  v_add_f32_dpp v45, v9, v8 row_ror:12 row_mask:0xf bank_mask:0x1
  v_add_f32_dpp v45, v10, v45 row_ror:8 row_mask:0xf bank_mask:0x1
  v_add_f32_dpp v45, v11, v45 row_ror:4 row_mask:0xf bank_mask:0x1
  v_mfma_f32_16x16x32_bf16 v[80:83], a[220:223], v[4:7], 0
  s_bitcmp1_b32 s99, 0
  s_cbranch_scc1 L_th_621
  s_waitcnt vmcnt(5)
L_th_621:
  buffer_load_dwordx4 a[220:223], v3, s[12:15], s59 offen offset:0
  v_add_f32_dpp v45, v84, v85 row_ror:4 row_mask:0xf bank_mask:0x2
  v_add_f32_dpp v45, v86, v45 row_ror:12 row_mask:0xf bank_mask:0x2
  v_add_f32_dpp v45, v87, v45 row_ror:8 row_mask:0xf bank_mask:0x2
  v_mfma_f32_16x16x32_bf16 v[8:11], a[224:227], v[4:7], 0
  s_mov_b32 s59, 0x16000
  s_bitcmp1_b32 s99, 0
  s_cbranch_scc1 L_th_623
  s_waitcnt vmcnt(5)
L_th_623:
  buffer_load_dwordx4 a[224:227], v3, s[12:15], s59 offen offset:3072
  v_add_f32_dpp v45, v12, v14 row_ror:8 row_mask:0xf bank_mask:0x4
  v_add_f32_dpp v45, v13, v45 row_ror:4 row_mask:0xf bank_mask:0x4
  v_add_f32_dpp v45, v15, v45 row_ror:12 row_mask:0xf bank_mask:0x4
  v_mfma_f32_16x16x32_bf16 v[84:87], a[228:231], v[4:7], 0
  s_bitcmp1_b32 s99, 0
  s_cbranch_scc1 L_th_625
  s_waitcnt vmcnt(5)
L_th_625:
  buffer_load_dwordx4 a[228:231], v3, s[12:15], s59 offen offset:2048
  v_add_f32_dpp v45, v80, v83 row_ror:12 row_mask:0xf bank_mask:0x8
  v_add_f32_dpp v45, v81, v45 row_ror:8 row_mask:0xf bank_mask:0x8
  v_add_f32_dpp v45, v82, v45 row_ror:4 row_mask:0xf bank_mask:0x8
  v_mfma_f32_16x16x32_bf16 v[12:15], a[232:235], v[4:7], 0
  s_bitcmp1_b32 s99, 0
  s_cbranch_scc1 L_th_627
  s_waitcnt vmcnt(5)
L_th_627:
  buffer_load_dwordx4 a[232:235], v3, s[12:15], s59 offen offset:1024
  v_add_f32_dpp v46, v9, v8 row_ror:12 row_mask:0xf bank_mask:0x1
  v_add_f32_dpp v46, v10, v46 row_ror:8 row_mask:0xf bank_mask:0x1
  v_add_f32_dpp v46, v11, v46 row_ror:4 row_mask:0xf bank_mask:0x1
  v_mfma_f32_16x16x32_bf16 v[80:83], a[236:239], v[4:7], 0
  s_bitcmp1_b32 s99, 0
  s_cbranch_scc1 L_th_629
  s_waitcnt vmcnt(5)
L_th_629:
  buffer_load_dwordx4 a[236:239], v3, s[12:15], s59 offen offset:0
  v_add_f32_dpp v46, v84, v85 row_ror:4 row_mask:0xf bank_mask:0x2
  v_add_f32_dpp v46, v86, v46 row_ror:12 row_mask:0xf bank_mask:0x2
  v_add_f32_dpp v46, v87, v46 row_ror:8 row_mask:0xf bank_mask:0x2
  v_mfma_f32_16x16x32_bf16 v[8:11], a[240:243], v[4:7], 0
  s_mov_b32 s59, 0x15000
  s_bitcmp1_b32 s99, 0
  s_cbranch_scc1 L_th_631
  s_waitcnt vmcnt(5)
L_th_631:
  buffer_load_dwordx4 a[240:243], v3, s[12:15], s59 offen offset:3072
  v_add_f32_dpp v46, v12, v14 row_ror:8 row_mask:0xf bank_mask:0x4
  v_add_f32_dpp v46, v13, v46 row_ror:4 row_mask:0xf bank_mask:0x4
  v_add_f32_dpp v46, v15, v46 row_ror:12 row_mask:0xf bank_mask:0x4
  v_mfma_f32_16x16x32_bf16 v[84:87], a[244:247], v[4:7], 0
  s_bitcmp1_b32 s99, 0
  s_cbranch_scc1 L_th_633
  s_waitcnt vmcnt(5)
L_th_633:
  buffer_load_dwordx4 a[244:247], v3, s[12:15], s59 offen offset:2048
  v_add_f32_dpp v46, v80, v83 row_ror:12 row_mask:0xf bank_mask:0x8
  v_add_f32_dpp v46, v81, v46 row_ror:8 row_mask:0xf bank_mask:0x8
  v_add_f32_dpp v46, v82, v46 row_ror:4 row_mask:0xf bank_mask:0x8
  v_mfma_f32_16x16x32_bf16 v[12:15], a[248:251], v[4:7], 0
  s_bitcmp1_b32 s99, 0
  s_cbranch_scc1 L_th_635
  s_waitcnt vmcnt(5)
L_th_635:
  buffer_load_dwordx4 a[248:251], v3, s[12:15], s59 offen offset:1024
  v_add_f32_dpp v47, v9, v8 row_ror:12 row_mask:0xf bank_mask:0x1
  v_add_f32_dpp v47, v10, v47 row_ror:8 row_mask:0xf bank_mask:0x1
  v_add_f32_dpp v47, v11, v47 row_ror:4 row_mask:0xf bank_mask:0x1
  v_mfma_f32_16x16x32_bf16 v[80:83], a[252:255], v[4:7], 0
  s_bitcmp1_b32 s99, 0
  s_cbranch_scc1 L_th_637
  s_waitcnt vmcnt(5)
L_th_637:
  buffer_load_dwordx4 a[252:255], v3, s[12:15], s59 offen offset:0
  v_add_f32_dpp v47, v84, v85 row_ror:4 row_mask:0xf bank_mask:0x2
  v_add_f32_dpp v47, v86, v47 row_ror:12 row_mask:0xf bank_mask:0x2
  v_add_f32_dpp v47, v87, v47 row_ror:8 row_mask:0xf bank_mask:0x2
  v_mfma_f32_16x16x32_bf16 v[8:11], v[144:147], v[4:7], 0
  s_mov_b32 s59, 0x14000
  s_bitcmp1_b32 s99, 0
  s_cbranch_scc1 L_th_639
  s_waitcnt vmcnt(5)
L_th_639:
  buffer_load_dwordx4 v[144:147], v3, s[12:15], s59 offen offset:3072
  v_add_f32_dpp v47, v12, v14 row_ror:8 row_mask:0xf bank_mask:0x4
  v_add_f32_dpp v47, v13, v47 row_ror:4 row_mask:0xf bank_mask:0x4
  v_add_f32_dpp v47, v15, v47 row_ror:12 row_mask:0xf bank_mask:0x4
  v_mfma_f32_16x16x32_bf16 v[84:87], v[148:151], v[4:7], 0
  s_bitcmp1_b32 s99, 0
  s_cbranch_scc1 L_th_641
  s_waitcnt vmcnt(5)
L_th_641:
  buffer_load_dwordx4 v[148:151], v3, s[12:15], s59 offen offset:2048
  v_add_f32_dpp v47, v80, v83 row_ror:12 row_mask:0xf bank_mask:0x8
  v_add_f32_dpp v47, v81, v47 row_ror:8 row_mask:0xf bank_mask:0x8
  v_add_f32_dpp v47, v82, v47 row_ror:4 row_mask:0xf bank_mask:0x8
  v_mfma_f32_16x16x32_bf16 v[12:15], v[152:155], v[4:7], 0
  s_bitcmp1_b32 s99, 0
  s_cbranch_scc1 L_th_643
  s_waitcnt vmcnt(5)
L_th_643:
  buffer_load_dwordx4 v[152:155], v3, s[12:15], s59 offen offset:1024
  v_add_f32_dpp v48, v9, v8 row_ror:12 row_mask:0xf bank_mask:0x1
  v_add_f32_dpp v48, v10, v48 row_ror:8 row_mask:0xf bank_mask:0x1
  v_add_f32_dpp v48, v11, v48 row_ror:4 row_mask:0xf bank_mask:0x1
  v_mfma_f32_16x16x32_bf16 v[80:83], v[156:159], v[4:7], 0
  s_bitcmp1_b32 s99, 0
  s_cbranch_scc1 L_th_645
  s_waitcnt vmcnt(5)
L_th_645:
  buffer_load_dwordx4 v[156:159], v3, s[12:15], s59 offen offset:0
  v_add_f32_dpp v48, v84, v85 row_ror:4 row_mask:0xf bank_mask:0x2
  v_add_f32_dpp v48, v86, v48 row_ror:12 row_mask:0xf bank_mask:0x2
  v_add_f32_dpp v48, v87, v48 row_ror:8 row_mask:0xf bank_mask:0x2
  v_mfma_f32_16x16x32_bf16 v[8:11], v[160:163], v[4:7], 0
  s_mov_b32 s59, 0x13000
  s_bitcmp1_b32 s99, 0
  s_cbranch_scc1 L_th_647
  s_waitcnt vmcnt(5)
L_th_647:
  buffer_load_dwordx4 v[160:163], v3, s[12:15], s59 offen offset:3072
  v_add_f32_dpp v48, v12, v14 row_ror:8 row_mask:0xf bank_mask:0x4
  v_add_f32_dpp v48, v13, v48 row_ror:4 row_mask:0xf bank_mask:0x4
  v_add_f32_dpp v48, v15, v48 row_ror:12 row_mask:0xf bank_mask:0x4
  v_mfma_f32_16x16x32_bf16 v[84:87], v[164:167], v[4:7], 0
  s_bitcmp1_b32 s99, 0
  s_cbranch_scc1 L_th_649
  s_waitcnt vmcnt(5)
L_th_649:
  buffer_load_dwordx4 v[164:167], v3, s[12:15], s59 offen offset:2048
  v_add_f32_dpp v48, v80, v83 row_ror:12 row_mask:0xf bank_mask:0x8
  v_add_f32_dpp v48, v81, v48 row_ror:8 row_mask:0xf bank_mask:0x8
  v_add_f32_dpp v48, v82, v48 row_ror:4 row_mask:0xf bank_mask:0x8
  v_mfma_f32_16x16x32_bf16 v[12:15], v[168:171], v[4:7], 0
  s_bitcmp1_b32 s99, 0
  s_cbranch_scc1 L_th_651
  s_waitcnt vmcnt(5)
L_th_651:
  buffer_load_dwordx4 v[168:171], v3, s[12:15], s59 offen offset:1024
  v_add_f32_dpp v49, v9, v8 row_ror:12 row_mask:0xf bank_mask:0x1
  v_add_f32_dpp v49, v10, v49 row_ror:8 row_mask:0xf bank_mask:0x1
  v_add_f32_dpp v49, v11, v49 row_ror:4 row_mask:0xf bank_mask:0x1
  v_mfma_f32_16x16x32_bf16 v[80:83], v[172:175], v[4:7], 0
  s_bitcmp1_b32 s99, 0
  s_cbranch_scc1 L_th_653
  s_waitcnt vmcnt(5)
L_th_653:
  buffer_load_dwordx4 v[172:175], v3, s[12:15], s59 offen offset:0
  v_add_f32_dpp v49, v84, v85 row_ror:4 row_mask:0xf bank_mask:0x2
  v_add_f32_dpp v49, v86, v49 row_ror:12 row_mask:0xf bank_mask:0x2
  v_add_f32_dpp v49, v87, v49 row_ror:8 row_mask:0xf bank_mask:0x2
  v_mfma_f32_16x16x32_bf16 v[8:11], v[176:179], v[4:7], 0
  s_mov_b32 s59, 0x12000
  s_bitcmp1_b32 s99, 0
  s_cbranch_scc1 L_th_655
  s_waitcnt vmcnt(5)
L_th_655:
  buffer_load_dwordx4 v[176:179], v3, s[12:15], s59 offen offset:3072
  v_add_f32_dpp v49, v12, v14 row_ror:8 row_mask:0xf bank_mask:0x4
  v_add_f32_dpp v49, v13, v49 row_ror:4 row_mask:0xf bank_mask:0x4
  v_add_f32_dpp v49, v15, v49 row_ror:12 row_mask:0xf bank_mask:0x4
  v_mfma_f32_16x16x32_bf16 v[84:87], v[180:183], v[4:7], 0
  s_bitcmp1_b32 s99, 0
  s_cbranch_scc1 L_th_657
  s_waitcnt vmcnt(5)
L_th_657:
  buffer_load_dwordx4 v[180:183], v3, s[12:15], s59 offen offset:2048
  v_add_f32_dpp v49, v80, v83 row_ror:12 row_mask:0xf bank_mask:0x8
  v_add_f32_dpp v49, v81, v49 row_ror:8 row_mask:0xf bank_mask:0x8
  v_add_f32_dpp v49, v82, v49 row_ror:4 row_mask:0xf bank_mask:0x8
  v_mfma_f32_16x16x32_bf16 v[12:15], v[184:187], v[4:7], 0
  s_bitcmp1_b32 s99, 0
  s_cbranch_scc1 L_th_659
  s_waitcnt vmcnt(5)
L_th_659:
  buffer_load_dwordx4 v[184:187], v3, s[12:15], s59 offen offset:1024
  v_add_f32_dpp v50, v9, v8 row_ror:12 row_mask:0xf bank_mask:0x1
  v_add_f32_dpp v50, v10, v50 row_ror:8 row_mask:0xf bank_mask:0x1
  v_add_f32_dpp v50, v11, v50 row_ror:4 row_mask:0xf bank_mask:0x1
  v_mfma_f32_16x16x32_bf16 v[80:83], v[188:191], v[4:7], 0
  s_bitcmp1_b32 s99, 0
  s_cbranch_scc1 L_th_661
  s_waitcnt vmcnt(5)
L_th_661:
  buffer_load_dwordx4 v[188:191], v3, s[12:15], s59 offen offset:0
  v_add_f32_dpp v50, v84, v85 row_ror:4 row_mask:0xf bank_mask:0x2
  v_add_f32_dpp v50, v86, v50 row_ror:12 row_mask:0xf bank_mask:0x2
  v_add_f32_dpp v50, v87, v50 row_ror:8 row_mask:0xf bank_mask:0x2
  v_mfma_f32_16x16x32_bf16 v[8:11], v[192:195], v[4:7], 0
  s_mov_b32 s59, 0x11000
  s_bitcmp1_b32 s99, 0
  s_cbranch_scc1 L_th_663
  s_waitcnt vmcnt(5)
L_th_663:
  buffer_load_dwordx4 v[192:195], v3, s[12:15], s59 offen offset:3072
  v_add_f32_dpp v50, v12, v14 row_ror:8 row_mask:0xf bank_mask:0x4
  v_add_f32_dpp v50, v13, v50 row_ror:4 row_mask:0xf bank_mask:0x4
  v_add_f32_dpp v50, v15, v50 row_ror:12 row_mask:0xf bank_mask:0x4
  v_mfma_f32_16x16x32_bf16 v[84:87], v[196:199], v[4:7], 0
  s_bitcmp1_b32 s99, 0
  s_cbranch_scc1 L_th_665
  s_waitcnt vmcnt(5)
L_th_665:
  buffer_load_dwordx4 v[196:199], v3, s[12:15], s59 offen offset:2048
  v_add_f32_dpp v50, v80, v83 row_ror:12 row_mask:0xf bank_mask:0x8
  v_add_f32_dpp v50, v81, v50 row_ror:8 row_mask:0xf bank_mask:0x8
  v_add_f32_dpp v50, v82, v50 row_ror:4 row_mask:0xf bank_mask:0x8
  v_mfma_f32_16x16x32_bf16 v[12:15], v[200:203], v[4:7], 0
  s_bitcmp1_b32 s99, 0
  s_cbranch_scc1 L_th_667
  s_waitcnt vmcnt(5)
L_th_667:
  buffer_load_dwordx4 v[200:203], v3, s[12:15], s59 offen offset:1024
  v_add_f32_dpp v51, v9, v8 row_ror:12 row_mask:0xf bank_mask:0x1
  v_add_f32_dpp v51, v10, v51 row_ror:8 row_mask:0xf bank_mask:0x1
  v_add_f32_dpp v51, v11, v51 row_ror:4 row_mask:0xf bank_mask:0x1
  v_mfma_f32_16x16x32_bf16 v[80:83], v[204:207], v[4:7], 0
  s_bitcmp1_b32 s99, 0
  s_cbranch_scc1 L_th_669
  s_waitcnt vmcnt(5)
L_th_669:
  buffer_load_dwordx4 v[204:207], v3, s[12:15], s59 offen offset:0
  v_add_f32_dpp v51, v84, v85 row_ror:4 row_mask:0xf bank_mask:0x2
  v_add_f32_dpp v51, v86, v51 row_ror:12 row_mask:0xf bank_mask:0x2
  v_add_f32_dpp v51, v87, v51 row_ror:8 row_mask:0xf bank_mask:0x2
  v_mfma_f32_16x16x32_bf16 v[8:11], v[208:211], v[4:7], 0
  s_mov_b32 s59, 0x10000
  s_bitcmp1_b32 s99, 0
  s_cbranch_scc1 L_th_671
  s_waitcnt vmcnt(5)
L_th_671:
  buffer_load_dwordx4 v[208:211], v3, s[12:15], s59 offen offset:3072
  v_add_f32_dpp v51, v12, v14 row_ror:8 row_mask:0xf bank_mask:0x4
  v_add_f32_dpp v51, v13, v51 row_ror:4 row_mask:0xf bank_mask:0x4
  v_add_f32_dpp v51, v15, v51 row_ror:12 row_mask:0xf bank_mask:0x4
  v_mfma_f32_16x16x32_bf16 v[84:87], v[212:215], v[4:7], 0
  s_bitcmp1_b32 s99, 0
  s_cbranch_scc1 L_th_673
  s_waitcnt vmcnt(5)
L_th_673:
  buffer_load_dwordx4 v[212:215], v3, s[12:15], s59 offen offset:2048
  v_add_f32_dpp v51, v80, v83 row_ror:12 row_mask:0xf bank_mask:0x8
  v_add_f32_dpp v51, v81, v51 row_ror:8 row_mask:0xf bank_mask:0x8
  v_add_f32_dpp v51, v82, v51 row_ror:4 row_mask:0xf bank_mask:0x8
  v_mfma_f32_16x16x32_bf16 v[12:15], v[216:219], v[4:7], 0
  s_bitcmp1_b32 s99, 0
  s_cbranch_scc1 L_th_675
  s_waitcnt vmcnt(5)
L_th_675:
  buffer_load_dwordx4 v[216:219], v3, s[12:15], s59 offen offset:1024
  v_add_f32_dpp v52, v9, v8 row_ror:12 row_mask:0xf bank_mask:0x1
  v_add_f32_dpp v52, v10, v52 row_ror:8 row_mask:0xf bank_mask:0x1
  v_add_f32_dpp v52, v11, v52 row_ror:4 row_mask:0xf bank_mask:0x1
  v_mfma_f32_16x16x32_bf16 v[80:83], v[220:223], v[4:7], 0
  s_bitcmp1_b32 s99, 0
  s_cbranch_scc1 L_th_677
  s_waitcnt vmcnt(5)
L_th_677:
  buffer_load_dwordx4 v[220:223], v3, s[12:15], s59 offen offset:0
  v_add_f32_dpp v52, v84, v85 row_ror:4 row_mask:0xf bank_mask:0x2
  v_add_f32_dpp v52, v86, v52 row_ror:12 row_mask:0xf bank_mask:0x2
  v_add_f32_dpp v52, v87, v52 row_ror:8 row_mask:0xf bank_mask:0x2
  v_mfma_f32_16x16x32_bf16 v[8:11], v[224:227], v[4:7], 0
  s_mov_b32 s59, 0xf000
  s_bitcmp1_b32 s99, 0
  s_cbranch_scc1 L_th_679
  s_waitcnt vmcnt(5)
L_th_679:
  buffer_load_dwordx4 v[224:227], v3, s[12:15], s59 offen offset:3072
  v_add_f32_dpp v52, v12, v14 row_ror:8 row_mask:0xf bank_mask:0x4
  v_add_f32_dpp v52, v13, v52 row_ror:4 row_mask:0xf bank_mask:0x4
  v_add_f32_dpp v52, v15, v52 row_ror:12 row_mask:0xf bank_mask:0x4
  v_mfma_f32_16x16x32_bf16 v[84:87], v[228:231], v[4:7], 0
  s_bitcmp1_b32 s99, 0
  s_cbranch_scc1 L_th_681
  s_waitcnt vmcnt(5)
L_th_681:
  buffer_load_dwordx4 v[228:231], v3, s[12:15], s59 offen offset:2048
  v_add_f32_dpp v52, v80, v83 row_ror:12 row_mask:0xf bank_mask:0x8
  v_add_f32_dpp v52, v81, v52 row_ror:8 row_mask:0xf bank_mask:0x8
  v_add_f32_dpp v52, v82, v52 row_ror:4 row_mask:0xf bank_mask:0x8
  v_mfma_f32_16x16x32_bf16 v[12:15], v[232:235], v[4:7], 0
  s_bitcmp1_b32 s99, 0
  s_cbranch_scc1 L_th_683
  s_waitcnt vmcnt(5)
L_th_683:
  buffer_load_dwordx4 v[232:235], v3, s[12:15], s59 offen offset:1024
  v_add_f32_dpp v53, v9, v8 row_ror:12 row_mask:0xf bank_mask:0x1
  v_add_f32_dpp v53, v10, v53 row_ror:8 row_mask:0xf bank_mask:0x1
  v_add_f32_dpp v53, v11, v53 row_ror:4 row_mask:0xf bank_mask:0x1
  v_mfma_f32_16x16x32_bf16 v[80:83], v[236:239], v[4:7], 0
  s_bitcmp1_b32 s99, 0
  s_cbranch_scc1 L_th_685
  s_waitcnt vmcnt(5)
L_th_685:
  buffer_load_dwordx4 v[236:239], v3, s[12:15], s59 offen offset:0
  v_add_f32_dpp v53, v84, v85 row_ror:4 row_mask:0xf bank_mask:0x2
  v_add_f32_dpp v53, v86, v53 row_ror:12 row_mask:0xf bank_mask:0x2
  v_add_f32_dpp v53, v87, v53 row_ror:8 row_mask:0xf bank_mask:0x2
  v_mfma_f32_16x16x32_bf16 v[8:11], v[240:243], v[4:7], 0
  v_add_f32_dpp v53, v12, v14 row_ror:8 row_mask:0xf bank_mask:0x4
  v_add_f32_dpp v53, v13, v53 row_ror:4 row_mask:0xf bank_mask:0x4
  v_add_f32_dpp v53, v15, v53 row_ror:12 row_mask:0xf bank_mask:0x4
  v_mfma_f32_16x16x32_bf16 v[84:87], a[0:3], v[4:7], 0
  v_add_f32_dpp v53, v80, v83 row_ror:12 row_mask:0xf bank_mask:0x8
  v_add_f32_dpp v53, v81, v53 row_ror:8 row_mask:0xf bank_mask:0x8
  v_add_f32_dpp v53, v82, v53 row_ror:4 row_mask:0xf bank_mask:0x8
  v_mfma_f32_16x16x32_bf16 v[12:15], a[4:7], v[4:7], 0
  v_add_f32_dpp v54, v9, v8 row_ror:12 row_mask:0xf bank_mask:0x1
  v_add_f32_dpp v54, v10, v54 row_ror:8 row_mask:0xf bank_mask:0x1
  v_add_f32_dpp v54, v11, v54 row_ror:4 row_mask:0xf bank_mask:0x1
  v_mfma_f32_16x16x32_bf16 v[80:83], a[8:11], v[4:7], 0
  v_add_f32_dpp v54, v84, v85 row_ror:4 row_mask:0xf bank_mask:0x2
  v_add_f32_dpp v54, v86, v54 row_ror:12 row_mask:0xf bank_mask:0x2
  v_add_f32_dpp v54, v87, v54 row_ror:8 row_mask:0xf bank_mask:0x2
  v_mfma_f32_16x16x32_bf16 v[8:11], a[12:15], v[4:7], 0
  v_add_f32_dpp v54, v12, v14 row_ror:8 row_mask:0xf bank_mask:0x4
  v_add_f32_dpp v54, v13, v54 row_ror:4 row_mask:0xf bank_mask:0x4
  v_add_f32_dpp v54, v15, v54 row_ror:12 row_mask:0xf bank_mask:0x4
  v_mfma_f32_16x16x32_bf16 v[84:87], a[16:19], v[4:7], 0
  v_add_f32_dpp v54, v80, v83 row_ror:12 row_mask:0xf bank_mask:0x8
  v_add_f32_dpp v54, v81, v54 row_ror:8 row_mask:0xf bank_mask:0x8
  v_add_f32_dpp v54, v82, v54 row_ror:4 row_mask:0xf bank_mask:0x8
  v_mfma_f32_16x16x32_bf16 v[12:15], a[20:23], v[4:7], 0
  v_add_f32_dpp v55, v9, v8 row_ror:12 row_mask:0xf bank_mask:0x1
  v_add_f32_dpp v55, v10, v55 row_ror:8 row_mask:0xf bank_mask:0x1
  v_add_f32_dpp v55, v11, v55 row_ror:4 row_mask:0xf bank_mask:0x1
  v_mfma_f32_16x16x32_bf16 v[80:83], a[24:27], v[4:7], 0
  v_add_f32_dpp v55, v84, v85 row_ror:4 row_mask:0xf bank_mask:0x2
  v_add_f32_dpp v55, v86, v55 row_ror:12 row_mask:0xf bank_mask:0x2
  v_add_f32_dpp v55, v87, v55 row_ror:8 row_mask:0xf bank_mask:0x2
  v_mfma_f32_16x16x32_bf16 v[8:11], a[28:31], v[4:7], 0
  v_add_f32_dpp v55, v12, v14 row_ror:8 row_mask:0xf bank_mask:0x4
  v_add_f32_dpp v55, v13, v55 row_ror:4 row_mask:0xf bank_mask:0x4
  v_add_f32_dpp v55, v15, v55 row_ror:12 row_mask:0xf bank_mask:0x4
  v_mfma_f32_16x16x32_bf16 v[84:87], a[32:35], v[4:7], 0
  v_add_f32_dpp v55, v80, v83 row_ror:12 row_mask:0xf bank_mask:0x8
  v_add_f32_dpp v55, v81, v55 row_ror:8 row_mask:0xf bank_mask:0x8
  v_add_f32_dpp v55, v82, v55 row_ror:4 row_mask:0xf bank_mask:0x8
  v_mfma_f32_16x16x32_bf16 v[12:15], a[36:39], v[4:7], 0
  v_add_f32_dpp v56, v9, v8 row_ror:12 row_mask:0xf bank_mask:0x1
  v_add_f32_dpp v56, v10, v56 row_ror:8 row_mask:0xf bank_mask:0x1
  v_add_f32_dpp v56, v11, v56 row_ror:4 row_mask:0xf bank_mask:0x1
  v_mfma_f32_16x16x32_bf16 v[80:83], a[40:43], v[4:7], 0
  v_add_f32_dpp v56, v84, v85 row_ror:4 row_mask:0xf bank_mask:0x2
  v_add_f32_dpp v56, v86, v56 row_ror:12 row_mask:0xf bank_mask:0x2
  v_add_f32_dpp v56, v87, v56 row_ror:8 row_mask:0xf bank_mask:0x2
  v_mfma_f32_16x16x32_bf16 v[8:11], a[44:47], v[4:7], 0
  v_add_f32_dpp v56, v12, v14 row_ror:8 row_mask:0xf bank_mask:0x4
  v_add_f32_dpp v56, v13, v56 row_ror:4 row_mask:0xf bank_mask:0x4
  v_add_f32_dpp v56, v15, v56 row_ror:12 row_mask:0xf bank_mask:0x4
  v_mfma_f32_16x16x32_bf16 v[84:87], a[48:51], v[4:7], 0
  v_add_f32_dpp v56, v80, v83 row_ror:12 row_mask:0xf bank_mask:0x8
  v_add_f32_dpp v56, v81, v56 row_ror:8 row_mask:0xf bank_mask:0x8
  v_add_f32_dpp v56, v82, v56 row_ror:4 row_mask:0xf bank_mask:0x8
  v_mfma_f32_16x16x32_bf16 v[12:15], a[52:55], v[4:7], 0
  v_add_f32_dpp v57, v9, v8 row_ror:12 row_mask:0xf bank_mask:0x1
  v_add_f32_dpp v57, v10, v57 row_ror:8 row_mask:0xf bank_mask:0x1
  v_add_f32_dpp v57, v11, v57 row_ror:4 row_mask:0xf bank_mask:0x1
  v_mfma_f32_16x16x32_bf16 v[80:83], a[56:59], v[4:7], 0
  v_add_f32_dpp v57, v84, v85 row_ror:4 row_mask:0xf bank_mask:0x2
  v_add_f32_dpp v57, v86, v57 row_ror:12 row_mask:0xf bank_mask:0x2
  v_add_f32_dpp v57, v87, v57 row_ror:8 row_mask:0xf bank_mask:0x2
  v_mfma_f32_16x16x32_bf16 v[8:11], a[60:63], v[4:7], 0
  v_add_f32_dpp v57, v12, v14 row_ror:8 row_mask:0xf bank_mask:0x4
  v_add_f32_dpp v57, v13, v57 row_ror:4 row_mask:0xf bank_mask:0x4
  v_add_f32_dpp v57, v15, v57 row_ror:12 row_mask:0xf bank_mask:0x4
  v_mfma_f32_16x16x32_bf16 v[84:87], a[64:67], v[4:7], 0
  v_add_f32_dpp v57, v80, v83 row_ror:12 row_mask:0xf bank_mask:0x8
  v_add_f32_dpp v57, v81, v57 row_ror:8 row_mask:0xf bank_mask:0x8
  v_add_f32_dpp v57, v82, v57 row_ror:4 row_mask:0xf bank_mask:0x8
  v_mfma_f32_16x16x32_bf16 v[12:15], a[68:71], v[4:7], 0
  v_add_f32_dpp v58, v9, v8 row_ror:12 row_mask:0xf bank_mask:0x1
  v_add_f32_dpp v58, v10, v58 row_ror:8 row_mask:0xf bank_mask:0x1
  v_add_f32_dpp v58, v11, v58 row_ror:4 row_mask:0xf bank_mask:0x1
  v_mfma_f32_16x16x32_bf16 v[80:83], a[72:75], v[4:7], 0
  v_add_f32_dpp v58, v84, v85 row_ror:4 row_mask:0xf bank_mask:0x2
  v_add_f32_dpp v58, v86, v58 row_ror:12 row_mask:0xf bank_mask:0x2
  v_add_f32_dpp v58, v87, v58 row_ror:8 row_mask:0xf bank_mask:0x2
  v_mfma_f32_16x16x32_bf16 v[8:11], a[76:79], v[4:7], 0
  v_add_f32_dpp v58, v12, v14 row_ror:8 row_mask:0xf bank_mask:0x4
  v_add_f32_dpp v58, v13, v58 row_ror:4 row_mask:0xf bank_mask:0x4
  v_add_f32_dpp v58, v15, v58 row_ror:12 row_mask:0xf bank_mask:0x4
  v_mfma_f32_16x16x32_bf16 v[84:87], a[80:83], v[4:7], 0
  v_add_f32_dpp v58, v80, v83 row_ror:12 row_mask:0xf bank_mask:0x8
  v_add_f32_dpp v58, v81, v58 row_ror:8 row_mask:0xf bank_mask:0x8
  v_add_f32_dpp v58, v82, v58 row_ror:4 row_mask:0xf bank_mask:0x8
  v_mfma_f32_16x16x32_bf16 v[12:15], a[84:87], v[4:7], 0
  v_add_f32_dpp v59, v9, v8 row_ror:12 row_mask:0xf bank_mask:0x1
  v_add_f32_dpp v59, v10, v59 row_ror:8 row_mask:0xf bank_mask:0x1
  v_add_f32_dpp v59, v11, v59 row_ror:4 row_mask:0xf bank_mask:0x1
  v_mfma_f32_16x16x32_bf16 v[80:83], a[88:91], v[4:7], 0
  v_add_f32_dpp v59, v84, v85 row_ror:4 row_mask:0xf bank_mask:0x2
  v_add_f32_dpp v59, v86, v59 row_ror:12 row_mask:0xf bank_mask:0x2
  v_add_f32_dpp v59, v87, v59 row_ror:8 row_mask:0xf bank_mask:0x2
  s_waitcnt lgkmcnt(3)
  v_mfma_f32_16x16x32_bf16 v[8:11], a[92:95], v[4:7], 0
  ds_read_b128 a[92:95], v25 offset:4096
  v_add_f32_dpp v59, v12, v14 row_ror:8 row_mask:0xf bank_mask:0x4
  v_add_f32_dpp v59, v13, v59 row_ror:4 row_mask:0xf bank_mask:0x4
  v_add_f32_dpp v59, v15, v59 row_ror:12 row_mask:0xf bank_mask:0x4
  s_waitcnt lgkmcnt(3)
  v_mfma_f32_16x16x32_bf16 v[84:87], a[96:99], v[4:7], 0
  ds_read_b128 a[96:99], v25 offset:5120
  v_add_f32_dpp v59, v80, v83 row_ror:12 row_mask:0xf bank_mask:0x8
  v_add_f32_dpp v59, v81, v59 row_ror:8 row_mask:0xf bank_mask:0x8
  v_add_f32_dpp v59, v82, v59 row_ror:4 row_mask:0xf bank_mask:0x8
  s_waitcnt lgkmcnt(3)
  v_mfma_f32_16x16x32_bf16 v[12:15], a[100:103], v[4:7], 0
  ds_read_b128 a[100:103], v25 offset:6144
  v_add_f32_dpp v32, v9, v8 row_ror:12 row_mask:0xf bank_mask:0x1
  v_add_f32_dpp v32, v10, v32 row_ror:8 row_mask:0xf bank_mask:0x1
  v_add_f32_dpp v32, v11, v32 row_ror:4 row_mask:0xf bank_mask:0x1
  s_waitcnt lgkmcnt(3)
  v_mfma_f32_16x16x32_bf16 v[80:83], a[104:107], v[4:7], 0
  ds_read_b128 a[104:107], v25 offset:7168
  v_add_f32_dpp v32, v84, v85 row_ror:4 row_mask:0xf bank_mask:0x2
  v_add_f32_dpp v32, v86, v32 row_ror:12 row_mask:0xf bank_mask:0x2
  v_add_f32_dpp v32, v87, v32 row_ror:8 row_mask:0xf bank_mask:0x2
  s_waitcnt lgkmcnt(3)
  v_mfma_f32_16x16x32_bf16 v[8:11], a[92:95], v[4:7], 0
  ds_read_b128 a[92:95], v25 offset:8192
  v_add_f32_dpp v32, v12, v14 row_ror:8 row_mask:0xf bank_mask:0x4
  v_add_f32_dpp v32, v13, v32 row_ror:4 row_mask:0xf bank_mask:0x4
  v_add_f32_dpp v32, v15, v32 row_ror:12 row_mask:0xf bank_mask:0x4
  s_waitcnt lgkmcnt(3)
  v_mfma_f32_16x16x32_bf16 v[84:87], a[96:99], v[4:7], 0
  ds_read_b128 a[96:99], v25 offset:9216
  v_add_f32_dpp v32, v80, v83 row_ror:12 row_mask:0xf bank_mask:0x8
  v_add_f32_dpp v32, v81, v32 row_ror:8 row_mask:0xf bank_mask:0x8
  v_add_f32_dpp v32, v82, v32 row_ror:4 row_mask:0xf bank_mask:0x8
  s_waitcnt lgkmcnt(3)
  v_mfma_f32_16x16x32_bf16 v[12:15], a[100:103], v[4:7], 0
  ds_read_b128 a[100:103], v25 offset:10240
  v_add_f32_dpp v33, v9, v8 row_ror:12 row_mask:0xf bank_mask:0x1
  v_add_f32_dpp v33, v10, v33 row_ror:8 row_mask:0xf bank_mask:0x1
  v_add_f32_dpp v33, v11, v33 row_ror:4 row_mask:0xf bank_mask:0x1
  s_waitcnt lgkmcnt(3)
  v_mfma_f32_16x16x32_bf16 v[80:83], a[104:107], v[4:7], 0
  ds_read_b128 a[104:107], v25 offset:11264
  v_add_f32_dpp v33, v84, v85 row_ror:4 row_mask:0xf bank_mask:0x2
  v_add_f32_dpp v33, v86, v33 row_ror:12 row_mask:0xf bank_mask:0x2
  v_add_f32_dpp v33, v87, v33 row_ror:8 row_mask:0xf bank_mask:0x2
  s_waitcnt lgkmcnt(3)
  v_mfma_f32_16x16x32_bf16 v[8:11], a[92:95], v[4:7], 0
  ds_read_b128 a[92:95], v25 offset:12288
  v_add_f32_dpp v33, v12, v14 row_ror:8 row_mask:0xf bank_mask:0x4
  v_add_f32_dpp v33, v13, v33 row_ror:4 row_mask:0xf bank_mask:0x4
  v_add_f32_dpp v33, v15, v33 row_ror:12 row_mask:0xf bank_mask:0x4
  s_waitcnt lgkmcnt(3)
  v_mfma_f32_16x16x32_bf16 v[84:87], a[96:99], v[4:7], 0
  ds_read_b128 a[96:99], v25 offset:13312
  v_add_f32_dpp v33, v80, v83 row_ror:12 row_mask:0xf bank_mask:0x8
  v_add_f32_dpp v33, v81, v33 row_ror:8 row_mask:0xf bank_mask:0x8
  v_add_f32_dpp v33, v82, v33 row_ror:4 row_mask:0xf bank_mask:0x8
  s_waitcnt lgkmcnt(3)
  v_mfma_f32_16x16x32_bf16 v[12:15], a[100:103], v[4:7], 0
  ds_read_b128 a[100:103], v25 offset:14336
  v_add_f32_dpp v34, v9, v8 row_ror:12 row_mask:0xf bank_mask:0x1
  v_add_f32_dpp v34, v10, v34 row_ror:8 row_mask:0xf bank_mask:0x1
  v_add_f32_dpp v34, v11, v34 row_ror:4 row_mask:0xf bank_mask:0x1
  s_waitcnt lgkmcnt(3)
  v_mfma_f32_16x16x32_bf16 v[80:83], a[104:107], v[4:7], 0
  ds_read_b128 a[104:107], v25 offset:15360
  v_add_f32_dpp v34, v84, v85 row_ror:4 row_mask:0xf bank_mask:0x2
  v_add_f32_dpp v34, v86, v34 row_ror:12 row_mask:0xf bank_mask:0x2
  v_add_f32_dpp v34, v87, v34 row_ror:8 row_mask:0xf bank_mask:0x2
  s_waitcnt lgkmcnt(3)
  v_mfma_f32_16x16x32_bf16 v[8:11], a[92:95], v[4:7], 0
  ds_read_b128 a[92:95], v25 offset:16384
  v_add_f32_dpp v34, v12, v14 row_ror:8 row_mask:0xf bank_mask:0x4
  v_add_f32_dpp v34, v13, v34 row_ror:4 row_mask:0xf bank_mask:0x4
  v_add_f32_dpp v34, v15, v34 row_ror:12 row_mask:0xf bank_mask:0x4
  s_waitcnt lgkmcnt(3)
  v_mfma_f32_16x16x32_bf16 v[84:87], a[96:99], v[4:7], 0
  ds_read_b128 a[96:99], v25 offset:17408
  v_add_f32_dpp v34, v80, v83 row_ror:12 row_mask:0xf bank_mask:0x8
  v_add_f32_dpp v34, v81, v34 row_ror:8 row_mask:0xf bank_mask:0x8
  v_add_f32_dpp v34, v82, v34 row_ror:4 row_mask:0xf bank_mask:0x8
  s_waitcnt lgkmcnt(3)
  v_mfma_f32_16x16x32_bf16 v[12:15], a[100:103], v[4:7], 0
  ds_read_b128 a[100:103], v25 offset:18432
  v_add_f32_dpp v35, v9, v8 row_ror:12 row_mask:0xf bank_mask:0x1
  v_add_f32_dpp v35, v10, v35 row_ror:8 row_mask:0xf bank_mask:0x1
  v_add_f32_dpp v35, v11, v35 row_ror:4 row_mask:0xf bank_mask:0x1
  s_waitcnt lgkmcnt(3)
  v_mfma_f32_16x16x32_bf16 v[80:83], a[104:107], v[4:7], 0
  ds_read_b128 a[104:107], v25 offset:19456
  v_add_f32_dpp v35, v84, v85 row_ror:4 row_mask:0xf bank_mask:0x2
  v_add_f32_dpp v35, v86, v35 row_ror:12 row_mask:0xf bank_mask:0x2
  v_add_f32_dpp v35, v87, v35 row_ror:8 row_mask:0xf bank_mask:0x2
  s_waitcnt lgkmcnt(3)
  v_mfma_f32_16x16x32_bf16 v[8:11], a[92:95], v[4:7], 0
  ds_read_b128 a[92:95], v25 offset:20480
  v_add_f32_dpp v35, v12, v14 row_ror:8 row_mask:0xf bank_mask:0x4
  v_add_f32_dpp v35, v13, v35 row_ror:4 row_mask:0xf bank_mask:0x4
  v_add_f32_dpp v35, v15, v35 row_ror:12 row_mask:0xf bank_mask:0x4
  s_waitcnt lgkmcnt(3)
  v_mfma_f32_16x16x32_bf16 v[84:87], a[96:99], v[4:7], 0
  ds_read_b128 a[96:99], v25 offset:21504
  v_add_f32_dpp v35, v80, v83 row_ror:12 row_mask:0xf bank_mask:0x8
  v_add_f32_dpp v35, v81, v35 row_ror:8 row_mask:0xf bank_mask:0x8
  v_add_f32_dpp v35, v82, v35 row_ror:4 row_mask:0xf bank_mask:0x8
  s_waitcnt lgkmcnt(3)
  v_mfma_f32_16x16x32_bf16 v[12:15], a[100:103], v[4:7], 0
  ds_read_b128 a[100:103], v25 offset:22528
  v_add_f32_dpp v36, v9, v8 row_ror:12 row_mask:0xf bank_mask:0x1
  v_add_f32_dpp v36, v10, v36 row_ror:8 row_mask:0xf bank_mask:0x1
  v_add_f32_dpp v36, v11, v36 row_ror:4 row_mask:0xf bank_mask:0x1
  s_waitcnt lgkmcnt(3)
  v_mfma_f32_16x16x32_bf16 v[80:83], a[104:107], v[4:7], 0
  ds_read_b128 a[104:107], v25 offset:23552
  v_add_f32_dpp v36, v84, v85 row_ror:4 row_mask:0xf bank_mask:0x2
  v_add_f32_dpp v36, v86, v36 row_ror:12 row_mask:0xf bank_mask:0x2
  v_add_f32_dpp v36, v87, v36 row_ror:8 row_mask:0xf bank_mask:0x2
  s_waitcnt lgkmcnt(3)
  v_mfma_f32_16x16x32_bf16 v[8:11], a[92:95], v[4:7], 0
  ds_read_b128 a[92:95], v25 offset:24576
  v_add_f32_dpp v36, v12, v14 row_ror:8 row_mask:0xf bank_mask:0x4
  v_add_f32_dpp v36, v13, v36 row_ror:4 row_mask:0xf bank_mask:0x4
  v_add_f32_dpp v36, v15, v36 row_ror:12 row_mask:0xf bank_mask:0x4
  s_waitcnt lgkmcnt(3)
  v_mfma_f32_16x16x32_bf16 v[84:87], a[96:99], v[4:7], 0
  ds_read_b128 a[96:99], v25 offset:25600
  v_add_f32_dpp v36, v80, v83 row_ror:12 row_mask:0xf bank_mask:0x8
  v_add_f32_dpp v36, v81, v36 row_ror:8 row_mask:0xf bank_mask:0x8
  v_add_f32_dpp v36, v82, v36 row_ror:4 row_mask:0xf bank_mask:0x8
  s_waitcnt lgkmcnt(3)
  v_mfma_f32_16x16x32_bf16 v[12:15], a[100:103], v[4:7], 0
  ds_read_b128 a[100:103], v25 offset:26624
  v_add_f32_dpp v37, v9, v8 row_ror:12 row_mask:0xf bank_mask:0x1
  v_add_f32_dpp v37, v10, v37 row_ror:8 row_mask:0xf bank_mask:0x1
  v_add_f32_dpp v37, v11, v37 row_ror:4 row_mask:0xf bank_mask:0x1
  s_waitcnt lgkmcnt(3)
  v_mfma_f32_16x16x32_bf16 v[80:83], a[104:107], v[4:7], 0
  ds_read_b128 a[104:107], v25 offset:27648
  v_add_f32_dpp v37, v84, v85 row_ror:4 row_mask:0xf bank_mask:0x2
  v_add_f32_dpp v37, v86, v37 row_ror:12 row_mask:0xf bank_mask:0x2
  v_add_f32_dpp v37, v87, v37 row_ror:8 row_mask:0xf bank_mask:0x2
  s_waitcnt lgkmcnt(3)
  v_mfma_f32_16x16x32_bf16 v[8:11], a[92:95], v[4:7], 0
  ds_read_b128 a[92:95], v25 offset:28672
  v_add_f32_dpp v37, v12, v14 row_ror:8 row_mask:0xf bank_mask:0x4
  v_add_f32_dpp v37, v13, v37 row_ror:4 row_mask:0xf bank_mask:0x4
  v_add_f32_dpp v37, v15, v37 row_ror:12 row_mask:0xf bank_mask:0x4
  s_waitcnt lgkmcnt(3)
  v_mfma_f32_16x16x32_bf16 v[84:87], a[96:99], v[4:7], 0
  ds_read_b128 a[96:99], v25 offset:29696
  v_add_f32_dpp v37, v80, v83 row_ror:12 row_mask:0xf bank_mask:0x8
  v_add_f32_dpp v37, v81, v37 row_ror:8 row_mask:0xf bank_mask:0x8
  v_add_f32_dpp v37, v82, v37 row_ror:4 row_mask:0xf bank_mask:0x8
  s_waitcnt lgkmcnt(3)
  v_mfma_f32_16x16x32_bf16 v[12:15], a[100:103], v[4:7], 0
  ds_read_b128 a[100:103], v25 offset:30720
  v_add_f32_dpp v38, v9, v8 row_ror:12 row_mask:0xf bank_mask:0x1
  v_add_f32_dpp v38, v10, v38 row_ror:8 row_mask:0xf bank_mask:0x1
  v_add_f32_dpp v38, v11, v38 row_ror:4 row_mask:0xf bank_mask:0x1
  s_waitcnt lgkmcnt(3)
  v_mfma_f32_16x16x32_bf16 v[80:83], a[104:107], v[4:7], 0
  ds_read_b128 a[104:107], v25 offset:31744
  v_add_f32_dpp v38, v84, v85 row_ror:4 row_mask:0xf bank_mask:0x2
  v_add_f32_dpp v38, v86, v38 row_ror:12 row_mask:0xf bank_mask:0x2
  v_add_f32_dpp v38, v87, v38 row_ror:8 row_mask:0xf bank_mask:0x2
  s_waitcnt lgkmcnt(3)
  v_mfma_f32_16x16x32_bf16 v[8:11], a[92:95], v[4:7], 0
  ds_read_b128 a[92:95], v25 offset:32768
  v_add_f32_dpp v38, v12, v14 row_ror:8 row_mask:0xf bank_mask:0x4
  v_add_f32_dpp v38, v13, v38 row_ror:4 row_mask:0xf bank_mask:0x4
  v_add_f32_dpp v38, v15, v38 row_ror:12 row_mask:0xf bank_mask:0x4
  s_waitcnt lgkmcnt(3)
  v_mfma_f32_16x16x32_bf16 v[84:87], a[96:99], v[4:7], 0
  ds_read_b128 a[96:99], v25 offset:33792
  v_add_f32_dpp v38, v80, v83 row_ror:12 row_mask:0xf bank_mask:0x8
  v_add_f32_dpp v38, v81, v38 row_ror:8 row_mask:0xf bank_mask:0x8
  v_add_f32_dpp v38, v82, v38 row_ror:4 row_mask:0xf bank_mask:0x8
  s_waitcnt lgkmcnt(3)
  v_mfma_f32_16x16x32_bf16 v[12:15], a[100:103], v[4:7], 0
  ds_read_b128 a[100:103], v25 offset:34816
  v_add_f32_dpp v39, v9, v8 row_ror:12 row_mask:0xf bank_mask:0x1
  v_add_f32_dpp v39, v10, v39 row_ror:8 row_mask:0xf bank_mask:0x1
  v_add_f32_dpp v39, v11, v39 row_ror:4 row_mask:0xf bank_mask:0x1
  s_waitcnt lgkmcnt(3)
  v_mfma_f32_16x16x32_bf16 v[80:83], a[104:107], v[4:7], 0
  ds_read_b128 a[104:107], v25 offset:35840
  v_add_f32_dpp v39, v84, v85 row_ror:4 row_mask:0xf bank_mask:0x2
  v_add_f32_dpp v39, v86, v39 row_ror:12 row_mask:0xf bank_mask:0x2
  v_add_f32_dpp v39, v87, v39 row_ror:8 row_mask:0xf bank_mask:0x2
  s_waitcnt lgkmcnt(3)
  v_mfma_f32_16x16x32_bf16 v[8:11], a[92:95], v[4:7], 0
  ds_read_b128 a[92:95], v25 offset:36864
  v_add_f32_dpp v39, v12, v14 row_ror:8 row_mask:0xf bank_mask:0x4
  v_add_f32_dpp v39, v13, v39 row_ror:4 row_mask:0xf bank_mask:0x4
  v_add_f32_dpp v39, v15, v39 row_ror:12 row_mask:0xf bank_mask:0x4
  s_waitcnt lgkmcnt(3)
  v_mfma_f32_16x16x32_bf16 v[84:87], a[96:99], v[4:7], 0
  ds_read_b128 a[96:99], v25 offset:37888
  v_add_f32_dpp v39, v80, v83 row_ror:12 row_mask:0xf bank_mask:0x8
  v_add_f32_dpp v39, v81, v39 row_ror:8 row_mask:0xf bank_mask:0x8
  v_add_f32_dpp v39, v82, v39 row_ror:4 row_mask:0xf bank_mask:0x8
  s_waitcnt lgkmcnt(3)
  v_mfma_f32_16x16x32_bf16 v[12:15], a[100:103], v[4:7], 0
  ds_read_b128 a[100:103], v25 offset:38912
  v_add_f32_dpp v40, v9, v8 row_ror:12 row_mask:0xf bank_mask:0x1
  v_add_f32_dpp v40, v10, v40 row_ror:8 row_mask:0xf bank_mask:0x1
  v_add_f32_dpp v40, v11, v40 row_ror:4 row_mask:0xf bank_mask:0x1
  s_waitcnt lgkmcnt(3)
  v_mfma_f32_16x16x32_bf16 v[80:83], a[104:107], v[4:7], 0
  v_add_f32_dpp v40, v84, v85 row_ror:4 row_mask:0xf bank_mask:0x2
  v_add_f32_dpp v40, v86, v40 row_ror:12 row_mask:0xf bank_mask:0x2
  v_add_f32_dpp v40, v87, v40 row_ror:8 row_mask:0xf bank_mask:0x2
  s_waitcnt lgkmcnt(2)
  v_mfma_f32_16x16x32_bf16 v[8:11], a[92:95], v[4:7], 0
  v_add_f32_dpp v40, v12, v14 row_ror:8 row_mask:0xf bank_mask:0x4
  v_add_f32_dpp v40, v13, v40 row_ror:4 row_mask:0xf bank_mask:0x4
  v_add_f32_dpp v40, v15, v40 row_ror:12 row_mask:0xf bank_mask:0x4
  s_waitcnt lgkmcnt(1)
  v_mfma_f32_16x16x32_bf16 v[84:87], a[96:99], v[4:7], 0
  v_add_f32_dpp v40, v80, v83 row_ror:12 row_mask:0xf bank_mask:0x8
  v_add_f32_dpp v40, v81, v40 row_ror:8 row_mask:0xf bank_mask:0x8
  v_add_f32_dpp v40, v82, v40 row_ror:4 row_mask:0xf bank_mask:0x8
  s_waitcnt lgkmcnt(0)
  v_mfma_f32_16x16x32_bf16 v[12:15], a[100:103], v[4:7], 0
  v_add_f32_dpp v41, v9, v8 row_ror:12 row_mask:0xf bank_mask:0x1
  v_add_f32_dpp v41, v10, v41 row_ror:8 row_mask:0xf bank_mask:0x1
  v_add_f32_dpp v41, v11, v41 row_ror:4 row_mask:0xf bank_mask:0x1
  s_nop 3
  v_add_f32_dpp v41, v84, v85 row_ror:4 row_mask:0xf bank_mask:0x2
  v_add_f32_dpp v41, v86, v41 row_ror:12 row_mask:0xf bank_mask:0x2
  v_add_f32_dpp v41, v87, v41 row_ror:8 row_mask:0xf bank_mask:0x2
  s_nop 3
  v_add_f32_dpp v41, v12, v14 row_ror:8 row_mask:0xf bank_mask:0x4
  v_add_f32_dpp v41, v13, v41 row_ror:4 row_mask:0xf bank_mask:0x4
  v_add_f32_dpp v41, v15, v41 row_ror:12 row_mask:0xf bank_mask:0x4
  v_max3_f32 v26, v32, v33, v34
  v_max3_f32 v26, v26, v35, v36
  v_max3_f32 v26, v26, v37, v38
  v_max3_f32 v26, v26, v39, v40
  v_max3_f32 v26, v26, v41, v42
  v_max3_f32 v26, v26, v43, v44
  v_max3_f32 v26, v26, v45, v46
  v_max3_f32 v26, v26, v47, v48
  v_max3_f32 v26, v26, v49, v50
  v_max3_f32 v26, v26, v51, v52
  v_max3_f32 v26, v26, v53, v54
  v_max3_f32 v26, v26, v55, v56
  v_max3_f32 v26, v26, v57, v58
  v_max3_f32 v26, v26, v59, v60
  v_max3_f32 v26, v26, v61, v62
  v_max_f32 v26, v26, v63
  s_nop 1
  v_max_f32_dpp v26, v26, v26 row_ror:8 row_mask:0xf bank_mask:0xf
  s_nop 1
  v_max_f32_dpp v26, v26, v26 row_ror:4 row_mask:0xf bank_mask:0xf
  v_mov_b32 v28, v26
  s_nop 1
  v_permlane32_swap_b32 v26, v28
  s_nop 0
  v_max_f32 v26, v26, v28
  v_mov_b32 v28, v26
  s_nop 1
  v_permlane16_swap_b32 v26, v28
  s_nop 0
  v_max_f32 v26, v26, v28
  v_mul_f32 v28, s96, v26
  v_mov_b32 v27, 0
  v_fma_f32 v32, v32, s96, -v28
  v_fma_f32 v33, v33, s96, -v28
  v_fma_f32 v34, v34, s96, -v28
  v_fma_f32 v35, v35, s96, -v28
  v_fma_f32 v36, v36, s96, -v28
  v_fma_f32 v37, v37, s96, -v28
  v_fma_f32 v38, v38, s96, -v28
  v_fma_f32 v39, v39, s96, -v28
  v_fma_f32 v40, v40, s96, -v28
  v_fma_f32 v41, v41, s96, -v28
  v_fma_f32 v42, v42, s96, -v28
  v_fma_f32 v43, v43, s96, -v28
  v_fma_f32 v44, v44, s96, -v28
  v_fma_f32 v45, v45, s96, -v28
  v_fma_f32 v46, v46, s96, -v28
  v_fma_f32 v47, v47, s96, -v28
  v_fma_f32 v48, v48, s96, -v28
  v_fma_f32 v49, v49, s96, -v28
  v_fma_f32 v50, v50, s96, -v28
  v_fma_f32 v51, v51, s96, -v28
  v_fma_f32 v52, v52, s96, -v28
  v_fma_f32 v53, v53, s96, -v28
  v_fma_f32 v54, v54, s96, -v28
  v_fma_f32 v55, v55, s96, -v28
  v_fma_f32 v56, v56, s96, -v28
  v_fma_f32 v57, v57, s96, -v28
  v_fma_f32 v58, v58, s96, -v28
  v_fma_f32 v59, v59, s96, -v28
  v_fma_f32 v60, v60, s96, -v28
  v_fma_f32 v61, v61, s96, -v28
  v_fma_f32 v62, v62, s96, -v28
  v_fma_f32 v63, v63, s96, -v28
  v_exp_f32 v32, v32
  v_exp_f32 v33, v33
  v_exp_f32 v34, v34
  v_exp_f32 v35, v35
  v_exp_f32 v36, v36
  v_exp_f32 v37, v37
  v_exp_f32 v38, v38
  v_exp_f32 v39, v39
  v_exp_f32 v40, v40
  v_exp_f32 v41, v41
  v_exp_f32 v42, v42
  v_exp_f32 v43, v43
  v_exp_f32 v44, v44
  v_exp_f32 v45, v45
  v_exp_f32 v46, v46
  v_exp_f32 v47, v47
  v_exp_f32 v48, v48
  v_exp_f32 v49, v49
  v_exp_f32 v50, v50
  v_exp_f32 v51, v51
  v_exp_f32 v52, v52
  v_exp_f32 v53, v53
  v_exp_f32 v54, v54
  v_exp_f32 v55, v55
  v_exp_f32 v56, v56
  v_exp_f32 v57, v57
  v_exp_f32 v58, v58
  v_exp_f32 v59, v59
  v_exp_f32 v60, v60
  v_exp_f32 v61, v61
  v_exp_f32 v62, v62
  v_exp_f32 v63, v63
  v_add_f32 v27, v27, v32
  v_cvt_pk_bf16_f32 v32, v32, v32
  v_add_f32 v27, v27, v33
  v_cvt_pk_bf16_f32 v33, v33, v33
  v_add_f32 v27, v27, v34
  v_cvt_pk_bf16_f32 v34, v34, v34
  v_add_f32 v27, v27, v35
  v_cvt_pk_bf16_f32 v35, v35, v35
  v_add_f32 v27, v27, v36
  v_cvt_pk_bf16_f32 v36, v36, v36
  v_add_f32 v27, v27, v37
  v_cvt_pk_bf16_f32 v37, v37, v37
  v_add_f32 v27, v27, v38
  v_cvt_pk_bf16_f32 v38, v38, v38
  v_add_f32 v27, v27, v39
  v_cvt_pk_bf16_f32 v39, v39, v39
  v_add_f32 v27, v27, v40
  v_cvt_pk_bf16_f32 v40, v40, v40
  v_add_f32 v27, v27, v41
  v_cvt_pk_bf16_f32 v41, v41, v41
  v_add_f32 v27, v27, v42
  v_cvt_pk_bf16_f32 v42, v42, v42
  v_add_f32 v27, v27, v43
  v_cvt_pk_bf16_f32 v43, v43, v43
  v_add_f32 v27, v27, v44
  v_cvt_pk_bf16_f32 v44, v44, v44
  v_add_f32 v27, v27, v45
  v_cvt_pk_bf16_f32 v45, v45, v45
  v_add_f32 v27, v27, v46
  v_cvt_pk_bf16_f32 v46, v46, v46
  v_add_f32 v27, v27, v47
  v_cvt_pk_bf16_f32 v47, v47, v47
  v_add_f32 v27, v27, v48
  v_cvt_pk_bf16_f32 v48, v48, v48
  v_add_f32 v27, v27, v49
  v_cvt_pk_bf16_f32 v49, v49, v49
  v_add_f32 v27, v27, v50
  v_cvt_pk_bf16_f32 v50, v50, v50
  v_add_f32 v27, v27, v51
  v_cvt_pk_bf16_f32 v51, v51, v51
  v_add_f32 v27, v27, v52
  v_cvt_pk_bf16_f32 v52, v52, v52
  v_add_f32 v27, v27, v53
  v_cvt_pk_bf16_f32 v53, v53, v53
  v_add_f32 v27, v27, v54
  v_cvt_pk_bf16_f32 v54, v54, v54
  v_add_f32 v27, v27, v55
  v_cvt_pk_bf16_f32 v55, v55, v55
  v_add_f32 v27, v27, v56
  v_cvt_pk_bf16_f32 v56, v56, v56
  v_add_f32 v27, v27, v57
  v_cvt_pk_bf16_f32 v57, v57, v57
  v_add_f32 v27, v27, v58
  v_cvt_pk_bf16_f32 v58, v58, v58
  v_add_f32 v27, v27, v59
  v_cvt_pk_bf16_f32 v59, v59, v59
  v_add_f32 v27, v27, v60
  v_cvt_pk_bf16_f32 v60, v60, v60
  v_add_f32 v27, v27, v61
  v_cvt_pk_bf16_f32 v61, v61, v61
  v_add_f32 v27, v27, v62
  v_cvt_pk_bf16_f32 v62, v62, v62
  v_add_f32 v27, v27, v63
  v_cvt_pk_bf16_f32 v63, v63, v63
  ds_bpermute_b32 v32, v24, v32
  ds_bpermute_b32 v33, v24, v33
  ds_bpermute_b32 v34, v24, v34
  ds_bpermute_b32 v35, v24, v35
  ds_bpermute_b32 v36, v24, v36
  ds_bpermute_b32 v37, v24, v37
  ds_bpermute_b32 v38, v24, v38
  ds_bpermute_b32 v39, v24, v39
  s_waitcnt lgkmcnt(0)
  ds_bpermute_b32 v40, v24, v40
  ds_bpermute_b32 v41, v24, v41
  ds_bpermute_b32 v42, v24, v42
  ds_bpermute_b32 v43, v24, v43
  ds_bpermute_b32 v44, v24, v44
  ds_bpermute_b32 v45, v24, v45
  ds_bpermute_b32 v46, v24, v46
  ds_bpermute_b32 v47, v24, v47
  s_waitcnt lgkmcnt(0)
  ds_bpermute_b32 v48, v24, v48
  ds_bpermute_b32 v49, v24, v49
  ds_bpermute_b32 v50, v24, v50
  ds_bpermute_b32 v51, v24, v51
  ds_bpermute_b32 v52, v24, v52
  ds_bpermute_b32 v53, v24, v53
  ds_bpermute_b32 v54, v24, v54
  ds_bpermute_b32 v55, v24, v55
  s_waitcnt lgkmcnt(0)
  ds_bpermute_b32 v56, v24, v56
  ds_bpermute_b32 v57, v24, v57
  ds_bpermute_b32 v58, v24, v58
  ds_bpermute_b32 v59, v24, v59
  ds_bpermute_b32 v60, v24, v60
  ds_bpermute_b32 v61, v24, v61
  ds_bpermute_b32 v62, v24, v62
  ds_bpermute_b32 v63, v24, v63
  s_waitcnt lgkmcnt(0)
  s_nop 1
  v_add_f32_dpp v27, v27, v27 row_ror:8 row_mask:0xf bank_mask:0xf
  s_nop 1
  v_add_f32_dpp v27, v27, v27 row_ror:4 row_mask:0xf bank_mask:0xf
  v_mov_b32 v28, v27
  s_nop 1
  v_permlane32_swap_b32 v27, v28
  s_nop 0
  v_add_f32 v27, v27, v28
  v_mov_b32 v28, v27
  s_nop 1
  v_permlane16_swap_b32 v27, v28
  s_nop 0
  v_add_f32 v27, v27, v28
  v_min_u32 v26, -2, v26
  v_min_u32 v27, -2, v27
  v_lshlrev_b32 v28, 10, v1
  s_lshl_b32 s55, s53, 12
  s_lshl_b32 s56, s54, 5
  s_add_u32 s55, s55, s56
  s_lshl_b32 s56, s52, 3
  s_add_u32 s55, s55, s56
  s_add_u32 s55, s55, 0x29c000
  s_mov_b64 exec, 0xf
  buffer_store_dwordx2 v[26:27], v28, s[48:51], s55 offen sc1
  s_mov_b64 exec, -1
  v_mov_b32 v8, 0
  v_mov_b32 v9, 0
  v_mov_b32 v10, 0
  v_mov_b32 v11, 0
  v_mov_b32 v12, 0
  v_mov_b32 v13, 0
  v_mov_b32 v14, 0
  v_mov_b32 v15, 0
  s_waitcnt lgkmcnt(0)
  v_and_b32_dpp v16, v63, v20 quad_perm:[3,3,3,3] row_mask:0xf bank_mask:0xf
  v_and_b32_dpp v17, v63, v21 quad_perm:[3,3,3,3] row_mask:0xf bank_mask:0xf
  v_and_b32_dpp v18, v63, v20 quad_perm:[2,2,2,2] row_mask:0xf bank_mask:0xf
  v_and_b32_dpp v19, v63, v21 quad_perm:[2,2,2,2] row_mask:0xf bank_mask:0xf
  v_mfma_f32_16x16x16_bf16 v[8:11], a[108:109], v[16:17], v[8:11]
  v_mfma_f32_16x16x16_bf16 v[12:15], a[110:111], v[16:17], v[12:15]
  v_and_b32_dpp v16, v63, v20 quad_perm:[1,1,1,1] row_mask:0xf bank_mask:0xf
  v_and_b32_dpp v17, v63, v21 quad_perm:[1,1,1,1] row_mask:0xf bank_mask:0xf
  v_mfma_f32_16x16x16_bf16 v[8:11], v[252:253], v[18:19], v[8:11]
  v_mfma_f32_16x16x16_bf16 v[12:15], v[254:255], v[18:19], v[12:15]
  v_and_b32_dpp v18, v63, v20 quad_perm:[0,0,0,0] row_mask:0xf bank_mask:0xf
  v_and_b32_dpp v19, v63, v21 quad_perm:[0,0,0,0] row_mask:0xf bank_mask:0xf
  v_mfma_f32_16x16x16_bf16 v[8:11], v[248:249], v[16:17], v[8:11]
  v_mfma_f32_16x16x16_bf16 v[12:15], v[250:251], v[16:17], v[12:15]
  v_and_b32_dpp v16, v62, v20 quad_perm:[3,3,3,3] row_mask:0xf bank_mask:0xf
  v_and_b32_dpp v17, v62, v21 quad_perm:[3,3,3,3] row_mask:0xf bank_mask:0xf
  v_mfma_f32_16x16x16_bf16 v[8:11], v[244:245], v[18:19], v[8:11]
  v_mfma_f32_16x16x16_bf16 v[12:15], v[246:247], v[18:19], v[12:15]
  v_and_b32_dpp v18, v62, v20 quad_perm:[2,2,2,2] row_mask:0xf bank_mask:0xf
  v_and_b32_dpp v19, v62, v21 quad_perm:[2,2,2,2] row_mask:0xf bank_mask:0xf
  v_mfma_f32_16x16x16_bf16 v[8:11], v[76:77], v[16:17], v[8:11]
  v_mfma_f32_16x16x16_bf16 v[12:15], v[78:79], v[16:17], v[12:15]
  v_and_b32_dpp v16, v62, v20 quad_perm:[1,1,1,1] row_mask:0xf bank_mask:0xf
  v_and_b32_dpp v17, v62, v21 quad_perm:[1,1,1,1] row_mask:0xf bank_mask:0xf
  v_mfma_f32_16x16x16_bf16 v[8:11], v[72:73], v[18:19], v[8:11]
  v_mfma_f32_16x16x16_bf16 v[12:15], v[74:75], v[18:19], v[12:15]
  v_and_b32_dpp v18, v62, v20 quad_perm:[0,0,0,0] row_mask:0xf bank_mask:0xf
  v_and_b32_dpp v19, v62, v21 quad_perm:[0,0,0,0] row_mask:0xf bank_mask:0xf
  v_mfma_f32_16x16x16_bf16 v[8:11], v[68:69], v[16:17], v[8:11]
  v_mfma_f32_16x16x16_bf16 v[12:15], v[70:71], v[16:17], v[12:15]
  v_and_b32_dpp v16, v61, v20 quad_perm:[3,3,3,3] row_mask:0xf bank_mask:0xf
  v_and_b32_dpp v17, v61, v21 quad_perm:[3,3,3,3] row_mask:0xf bank_mask:0xf
  v_mfma_f32_16x16x16_bf16 v[8:11], v[64:65], v[18:19], v[8:11]
  v_mfma_f32_16x16x16_bf16 v[12:15], v[66:67], v[18:19], v[12:15]
  v_and_b32_dpp v18, v61, v20 quad_perm:[2,2,2,2] row_mask:0xf bank_mask:0xf
  v_and_b32_dpp v19, v61, v21 quad_perm:[2,2,2,2] row_mask:0xf bank_mask:0xf
  v_mfma_f32_16x16x16_bf16 v[8:11], a[112:113], v[16:17], v[8:11]
  v_mfma_f32_16x16x16_bf16 v[12:15], a[114:115], v[16:17], v[12:15]
  v_and_b32_dpp v16, v61, v20 quad_perm:[1,1,1,1] row_mask:0xf bank_mask:0xf
  v_and_b32_dpp v17, v61, v21 quad_perm:[1,1,1,1] row_mask:0xf bank_mask:0xf
  v_mfma_f32_16x16x16_bf16 v[8:11], a[116:117], v[18:19], v[8:11]
  v_mfma_f32_16x16x16_bf16 v[12:15], a[118:119], v[18:19], v[12:15]
  v_and_b32_dpp v18, v61, v20 quad_perm:[0,0,0,0] row_mask:0xf bank_mask:0xf
  v_and_b32_dpp v19, v61, v21 quad_perm:[0,0,0,0] row_mask:0xf bank_mask:0xf
  v_mfma_f32_16x16x16_bf16 v[8:11], a[120:121], v[16:17], v[8:11]
  v_mfma_f32_16x16x16_bf16 v[12:15], a[122:123], v[16:17], v[12:15]
  v_and_b32_dpp v16, v60, v20 quad_perm:[3,3,3,3] row_mask:0xf bank_mask:0xf
  v_and_b32_dpp v17, v60, v21 quad_perm:[3,3,3,3] row_mask:0xf bank_mask:0xf
  v_mfma_f32_16x16x16_bf16 v[8:11], a[124:125], v[18:19], v[8:11]
  v_mfma_f32_16x16x16_bf16 v[12:15], a[126:127], v[18:19], v[12:15]
  v_and_b32_dpp v18, v60, v20 quad_perm:[2,2,2,2] row_mask:0xf bank_mask:0xf
  v_and_b32_dpp v19, v60, v21 quad_perm:[2,2,2,2] row_mask:0xf bank_mask:0xf
  s_waitcnt vmcnt(55)
  v_mfma_f32_16x16x16_bf16 v[8:11], a[128:129], v[16:17], v[8:11]
  v_mfma_f32_16x16x16_bf16 v[12:15], a[130:131], v[16:17], v[12:15]
  s_mov_b32 s59, 0xe000
  s_bitcmp1_b32 s99, 0
  s_cbranch_scc1 L_th_687
  s_waitcnt vmcnt(5)
L_th_687:
  buffer_load_dwordx4 v[240:243], v3, s[12:15], s59 offen offset:3072
  v_and_b32_dpp v16, v60, v20 quad_perm:[1,1,1,1] row_mask:0xf bank_mask:0xf
  v_and_b32_dpp v17, v60, v21 quad_perm:[1,1,1,1] row_mask:0xf bank_mask:0xf
  s_waitcnt vmcnt(55)
  v_mfma_f32_16x16x16_bf16 v[8:11], a[132:133], v[18:19], v[8:11]
  v_mfma_f32_16x16x16_bf16 v[12:15], a[134:135], v[18:19], v[12:15]
  s_bitcmp1_b32 s99, 0
  s_cbranch_scc1 L_th_689
  s_waitcnt vmcnt(5)
L_th_689:
  buffer_load_dwordx4 a[0:3], v3, s[12:15], s59 offen offset:2048
  v_and_b32_dpp v18, v60, v20 quad_perm:[0,0,0,0] row_mask:0xf bank_mask:0xf
  v_and_b32_dpp v19, v60, v21 quad_perm:[0,0,0,0] row_mask:0xf bank_mask:0xf
  s_waitcnt vmcnt(55)
  v_mfma_f32_16x16x16_bf16 v[8:11], a[136:137], v[16:17], v[8:11]
  v_mfma_f32_16x16x16_bf16 v[12:15], a[138:139], v[16:17], v[12:15]
  s_bitcmp1_b32 s99, 0
  s_cbranch_scc1 L_th_691
  s_waitcnt vmcnt(5)
L_th_691:
  buffer_load_dwordx4 a[4:7], v3, s[12:15], s59 offen offset:1024
  v_and_b32_dpp v16, v59, v20 quad_perm:[3,3,3,3] row_mask:0xf bank_mask:0xf
  v_and_b32_dpp v17, v59, v21 quad_perm:[3,3,3,3] row_mask:0xf bank_mask:0xf
  s_waitcnt vmcnt(55)
  v_mfma_f32_16x16x16_bf16 v[8:11], a[140:141], v[18:19], v[8:11]
  v_mfma_f32_16x16x16_bf16 v[12:15], a[142:143], v[18:19], v[12:15]
  s_bitcmp1_b32 s99, 0
  s_cbranch_scc1 L_th_693
  s_waitcnt vmcnt(5)
L_th_693:
  buffer_load_dwordx4 a[8:11], v3, s[12:15], s59 offen offset:0
  v_and_b32_dpp v18, v59, v20 quad_perm:[2,2,2,2] row_mask:0xf bank_mask:0xf
  v_and_b32_dpp v19, v59, v21 quad_perm:[2,2,2,2] row_mask:0xf bank_mask:0xf
  s_waitcnt vmcnt(55)
  v_mfma_f32_16x16x16_bf16 v[8:11], a[144:145], v[16:17], v[8:11]
  v_mfma_f32_16x16x16_bf16 v[12:15], a[146:147], v[16:17], v[12:15]
  s_mov_b32 s59, 0xd000
  s_bitcmp1_b32 s99, 0
  s_cbranch_scc1 L_th_695
  s_waitcnt vmcnt(5)
L_th_695:
  buffer_load_dwordx4 a[12:15], v3, s[12:15], s59 offen offset:3072
  v_and_b32_dpp v16, v59, v20 quad_perm:[1,1,1,1] row_mask:0xf bank_mask:0xf
  v_and_b32_dpp v17, v59, v21 quad_perm:[1,1,1,1] row_mask:0xf bank_mask:0xf
  s_waitcnt vmcnt(55)
  v_mfma_f32_16x16x16_bf16 v[8:11], a[148:149], v[18:19], v[8:11]
  v_mfma_f32_16x16x16_bf16 v[12:15], a[150:151], v[18:19], v[12:15]
  s_bitcmp1_b32 s99, 0
  s_cbranch_scc1 L_th_697
  s_waitcnt vmcnt(5)
L_th_697:
  buffer_load_dwordx4 a[16:19], v3, s[12:15], s59 offen offset:2048
  v_and_b32_dpp v18, v59, v20 quad_perm:[0,0,0,0] row_mask:0xf bank_mask:0xf
  v_and_b32_dpp v19, v59, v21 quad_perm:[0,0,0,0] row_mask:0xf bank_mask:0xf
  s_waitcnt vmcnt(55)
  v_mfma_f32_16x16x16_bf16 v[8:11], a[152:153], v[16:17], v[8:11]
  v_mfma_f32_16x16x16_bf16 v[12:15], a[154:155], v[16:17], v[12:15]
  s_bitcmp1_b32 s99, 0
  s_cbranch_scc1 L_th_699
  s_waitcnt vmcnt(5)
L_th_699:
  buffer_load_dwordx4 a[20:23], v3, s[12:15], s59 offen offset:1024
  v_and_b32_dpp v16, v58, v20 quad_perm:[3,3,3,3] row_mask:0xf bank_mask:0xf
  v_and_b32_dpp v17, v58, v21 quad_perm:[3,3,3,3] row_mask:0xf bank_mask:0xf
  s_waitcnt vmcnt(55)
  v_mfma_f32_16x16x16_bf16 v[8:11], a[156:157], v[18:19], v[8:11]
  v_mfma_f32_16x16x16_bf16 v[12:15], a[158:159], v[18:19], v[12:15]
  s_bitcmp1_b32 s99, 0
  s_cbranch_scc1 L_th_701
  s_waitcnt vmcnt(5)
L_th_701:
  buffer_load_dwordx4 a[24:27], v3, s[12:15], s59 offen offset:0
  v_and_b32_dpp v18, v58, v20 quad_perm:[2,2,2,2] row_mask:0xf bank_mask:0xf
  v_and_b32_dpp v19, v58, v21 quad_perm:[2,2,2,2] row_mask:0xf bank_mask:0xf
  s_waitcnt vmcnt(55)
  v_mfma_f32_16x16x16_bf16 v[8:11], a[160:161], v[16:17], v[8:11]
  v_mfma_f32_16x16x16_bf16 v[12:15], a[162:163], v[16:17], v[12:15]
  s_mov_b32 s59, 0xc000
  s_bitcmp1_b32 s99, 0
  s_cbranch_scc1 L_th_703
  s_waitcnt vmcnt(5)
L_th_703:
  buffer_load_dwordx4 a[28:31], v3, s[12:15], s59 offen offset:3072
  v_and_b32_dpp v16, v58, v20 quad_perm:[1,1,1,1] row_mask:0xf bank_mask:0xf
  v_and_b32_dpp v17, v58, v21 quad_perm:[1,1,1,1] row_mask:0xf bank_mask:0xf
  s_waitcnt vmcnt(55)
  v_mfma_f32_16x16x16_bf16 v[8:11], a[164:165], v[18:19], v[8:11]
  v_mfma_f32_16x16x16_bf16 v[12:15], a[166:167], v[18:19], v[12:15]
  s_bitcmp1_b32 s99, 0
  s_cbranch_scc1 L_th_705
  s_waitcnt vmcnt(5)
L_th_705:
  buffer_load_dwordx4 a[32:35], v3, s[12:15], s59 offen offset:2048
  v_and_b32_dpp v18, v58, v20 quad_perm:[0,0,0,0] row_mask:0xf bank_mask:0xf
  v_and_b32_dpp v19, v58, v21 quad_perm:[0,0,0,0] row_mask:0xf bank_mask:0xf
  s_waitcnt vmcnt(55)
  v_mfma_f32_16x16x16_bf16 v[8:11], a[168:169], v[16:17], v[8:11]
  v_mfma_f32_16x16x16_bf16 v[12:15], a[170:171], v[16:17], v[12:15]
  s_bitcmp1_b32 s99, 0
  s_cbranch_scc1 L_th_707
  s_waitcnt vmcnt(5)
L_th_707:
  buffer_load_dwordx4 a[36:39], v3, s[12:15], s59 offen offset:1024
  v_and_b32_dpp v16, v57, v20 quad_perm:[3,3,3,3] row_mask:0xf bank_mask:0xf
  v_and_b32_dpp v17, v57, v21 quad_perm:[3,3,3,3] row_mask:0xf bank_mask:0xf
  s_waitcnt vmcnt(55)
  v_mfma_f32_16x16x16_bf16 v[8:11], a[172:173], v[18:19], v[8:11]
  v_mfma_f32_16x16x16_bf16 v[12:15], a[174:175], v[18:19], v[12:15]
  s_bitcmp1_b32 s99, 0
  s_cbranch_scc1 L_th_709
  s_waitcnt vmcnt(5)
L_th_709:
  buffer_load_dwordx4 a[40:43], v3, s[12:15], s59 offen offset:0
  v_and_b32_dpp v18, v57, v20 quad_perm:[2,2,2,2] row_mask:0xf bank_mask:0xf
  v_and_b32_dpp v19, v57, v21 quad_perm:[2,2,2,2] row_mask:0xf bank_mask:0xf
  s_waitcnt vmcnt(55)
  v_mfma_f32_16x16x16_bf16 v[8:11], a[176:177], v[16:17], v[8:11]
  v_mfma_f32_16x16x16_bf16 v[12:15], a[178:179], v[16:17], v[12:15]
  s_mov_b32 s59, 0xb000
  s_bitcmp1_b32 s99, 0
  s_cbranch_scc1 L_th_711
  s_waitcnt vmcnt(5)
L_th_711:
  buffer_load_dwordx4 a[44:47], v3, s[12:15], s59 offen offset:3072
  v_and_b32_dpp v16, v57, v20 quad_perm:[1,1,1,1] row_mask:0xf bank_mask:0xf
  v_and_b32_dpp v17, v57, v21 quad_perm:[1,1,1,1] row_mask:0xf bank_mask:0xf
  s_waitcnt vmcnt(55)
  v_mfma_f32_16x16x16_bf16 v[8:11], a[180:181], v[18:19], v[8:11]
  v_mfma_f32_16x16x16_bf16 v[12:15], a[182:183], v[18:19], v[12:15]
  s_bitcmp1_b32 s99, 0
  s_cbranch_scc1 L_th_713
  s_waitcnt vmcnt(5)
L_th_713:
  buffer_load_dwordx4 a[48:51], v3, s[12:15], s59 offen offset:2048
  v_and_b32_dpp v18, v57, v20 quad_perm:[0,0,0,0] row_mask:0xf bank_mask:0xf
  v_and_b32_dpp v19, v57, v21 quad_perm:[0,0,0,0] row_mask:0xf bank_mask:0xf
  s_waitcnt vmcnt(55)
  v_mfma_f32_16x16x16_bf16 v[8:11], a[184:185], v[16:17], v[8:11]
  v_mfma_f32_16x16x16_bf16 v[12:15], a[186:187], v[16:17], v[12:15]
  s_bitcmp1_b32 s99, 0
  s_cbranch_scc1 L_th_715
  s_waitcnt vmcnt(5)
L_th_715:
  buffer_load_dwordx4 a[52:55], v3, s[12:15], s59 offen offset:1024
  v_and_b32_dpp v16, v56, v20 quad_perm:[3,3,3,3] row_mask:0xf bank_mask:0xf
  v_and_b32_dpp v17, v56, v21 quad_perm:[3,3,3,3] row_mask:0xf bank_mask:0xf
  s_waitcnt vmcnt(55)
  v_mfma_f32_16x16x16_bf16 v[8:11], a[188:189], v[18:19], v[8:11]
  v_mfma_f32_16x16x16_bf16 v[12:15], a[190:191], v[18:19], v[12:15]
  s_bitcmp1_b32 s99, 0
  s_cbranch_scc1 L_th_717
  s_waitcnt vmcnt(5)
L_th_717:
  buffer_load_dwordx4 a[56:59], v3, s[12:15], s59 offen offset:0
  v_and_b32_dpp v18, v56, v20 quad_perm:[2,2,2,2] row_mask:0xf bank_mask:0xf
  v_and_b32_dpp v19, v56, v21 quad_perm:[2,2,2,2] row_mask:0xf bank_mask:0xf
  s_waitcnt vmcnt(55)
  v_mfma_f32_16x16x16_bf16 v[8:11], a[192:193], v[16:17], v[8:11]
  v_mfma_f32_16x16x16_bf16 v[12:15], a[194:195], v[16:17], v[12:15]
  s_mov_b32 s59, 0xa000
  s_bitcmp1_b32 s99, 0
  s_cbranch_scc1 L_th_719
  s_waitcnt vmcnt(5)
L_th_719:
  buffer_load_dwordx4 a[60:63], v3, s[12:15], s59 offen offset:3072
  v_and_b32_dpp v16, v56, v20 quad_perm:[1,1,1,1] row_mask:0xf bank_mask:0xf
  v_and_b32_dpp v17, v56, v21 quad_perm:[1,1,1,1] row_mask:0xf bank_mask:0xf
  s_waitcnt vmcnt(55)
  v_mfma_f32_16x16x16_bf16 v[8:11], a[196:197], v[18:19], v[8:11]
  v_mfma_f32_16x16x16_bf16 v[12:15], a[198:199], v[18:19], v[12:15]
  s_bitcmp1_b32 s99, 0
  s_cbranch_scc1 L_th_721
  s_waitcnt vmcnt(5)
L_th_721:
  buffer_load_dwordx4 a[64:67], v3, s[12:15], s59 offen offset:2048
  v_and_b32_dpp v18, v56, v20 quad_perm:[0,0,0,0] row_mask:0xf bank_mask:0xf
  v_and_b32_dpp v19, v56, v21 quad_perm:[0,0,0,0] row_mask:0xf bank_mask:0xf
  s_waitcnt vmcnt(55)
  v_mfma_f32_16x16x16_bf16 v[8:11], a[200:201], v[16:17], v[8:11]
  v_mfma_f32_16x16x16_bf16 v[12:15], a[202:203], v[16:17], v[12:15]
  s_bitcmp1_b32 s99, 0
  s_cbranch_scc1 L_th_723
  s_waitcnt vmcnt(5)
L_th_723:
  buffer_load_dwordx4 a[68:71], v3, s[12:15], s59 offen offset:1024
  v_and_b32_dpp v16, v55, v20 quad_perm:[3,3,3,3] row_mask:0xf bank_mask:0xf
  v_and_b32_dpp v17, v55, v21 quad_perm:[3,3,3,3] row_mask:0xf bank_mask:0xf
  s_waitcnt vmcnt(55)
  v_mfma_f32_16x16x16_bf16 v[8:11], a[204:205], v[18:19], v[8:11]
  v_mfma_f32_16x16x16_bf16 v[12:15], a[206:207], v[18:19], v[12:15]
  s_bitcmp1_b32 s99, 0
  s_cbranch_scc1 L_th_725
  s_waitcnt vmcnt(5)
L_th_725:
  buffer_load_dwordx4 a[72:75], v3, s[12:15], s59 offen offset:0
  v_and_b32_dpp v18, v55, v20 quad_perm:[2,2,2,2] row_mask:0xf bank_mask:0xf
  v_and_b32_dpp v19, v55, v21 quad_perm:[2,2,2,2] row_mask:0xf bank_mask:0xf
  s_waitcnt vmcnt(55)
  v_mfma_f32_16x16x16_bf16 v[8:11], a[208:209], v[16:17], v[8:11]
  v_mfma_f32_16x16x16_bf16 v[12:15], a[210:211], v[16:17], v[12:15]
  s_mov_b32 s59, 0x9000
  s_bitcmp1_b32 s99, 0
  s_cbranch_scc1 L_th_727
  s_waitcnt vmcnt(5)
L_th_727:
  buffer_load_dwordx4 a[76:79], v3, s[12:15], s59 offen offset:3072
  v_and_b32_dpp v16, v55, v20 quad_perm:[1,1,1,1] row_mask:0xf bank_mask:0xf
  v_and_b32_dpp v17, v55, v21 quad_perm:[1,1,1,1] row_mask:0xf bank_mask:0xf
  s_waitcnt vmcnt(55)
  v_mfma_f32_16x16x16_bf16 v[8:11], a[212:213], v[18:19], v[8:11]
  v_mfma_f32_16x16x16_bf16 v[12:15], a[214:215], v[18:19], v[12:15]
  s_bitcmp1_b32 s99, 0
  s_cbranch_scc1 L_th_729
  s_waitcnt vmcnt(5)
L_th_729:
  buffer_load_dwordx4 a[80:83], v3, s[12:15], s59 offen offset:2048
  v_and_b32_dpp v18, v55, v20 quad_perm:[0,0,0,0] row_mask:0xf bank_mask:0xf
  v_and_b32_dpp v19, v55, v21 quad_perm:[0,0,0,0] row_mask:0xf bank_mask:0xf
  s_waitcnt vmcnt(55)
  v_mfma_f32_16x16x16_bf16 v[8:11], a[216:217], v[16:17], v[8:11]
  v_mfma_f32_16x16x16_bf16 v[12:15], a[218:219], v[16:17], v[12:15]
  s_bitcmp1_b32 s99, 0
  s_cbranch_scc1 L_th_731
  s_waitcnt vmcnt(5)
L_th_731:
  buffer_load_dwordx4 a[84:87], v3, s[12:15], s59 offen offset:1024
  v_and_b32_dpp v16, v54, v20 quad_perm:[3,3,3,3] row_mask:0xf bank_mask:0xf
  v_and_b32_dpp v17, v54, v21 quad_perm:[3,3,3,3] row_mask:0xf bank_mask:0xf
  s_waitcnt vmcnt(55)
  v_mfma_f32_16x16x16_bf16 v[8:11], a[220:221], v[18:19], v[8:11]
  v_mfma_f32_16x16x16_bf16 v[12:15], a[222:223], v[18:19], v[12:15]
  s_bitcmp1_b32 s99, 0
  s_cbranch_scc1 L_th_733
  s_waitcnt vmcnt(5)
L_th_733:
  buffer_load_dwordx4 a[88:91], v3, s[12:15], s59 offen offset:0
  v_and_b32_dpp v18, v54, v20 quad_perm:[2,2,2,2] row_mask:0xf bank_mask:0xf
  v_and_b32_dpp v19, v54, v21 quad_perm:[2,2,2,2] row_mask:0xf bank_mask:0xf
  s_waitcnt vmcnt(55)
  v_mfma_f32_16x16x16_bf16 v[8:11], a[224:225], v[16:17], v[8:11]
  v_mfma_f32_16x16x16_bf16 v[12:15], a[226:227], v[16:17], v[12:15]
  s_mov_b32 s59, 0x8000
  s_bitcmp1_b32 s99, 0
  s_cbranch_scc1 L_th_735
  s_waitcnt vmcnt(5)
L_th_735:
  buffer_load_dwordx4 a[92:95], v3, s[12:15], s59 offen offset:3072
  v_and_b32_dpp v16, v54, v20 quad_perm:[1,1,1,1] row_mask:0xf bank_mask:0xf
  v_and_b32_dpp v17, v54, v21 quad_perm:[1,1,1,1] row_mask:0xf bank_mask:0xf
  s_waitcnt vmcnt(55)
  v_mfma_f32_16x16x16_bf16 v[8:11], a[228:229], v[18:19], v[8:11]
  v_mfma_f32_16x16x16_bf16 v[12:15], a[230:231], v[18:19], v[12:15]
  s_bitcmp1_b32 s99, 0
  s_cbranch_scc1 L_th_737
  s_waitcnt vmcnt(5)
L_th_737:
  buffer_load_dwordx4 a[96:99], v3, s[12:15], s59 offen offset:2048
  v_and_b32_dpp v18, v54, v20 quad_perm:[0,0,0,0] row_mask:0xf bank_mask:0xf
  v_and_b32_dpp v19, v54, v21 quad_perm:[0,0,0,0] row_mask:0xf bank_mask:0xf
  s_waitcnt vmcnt(55)
  v_mfma_f32_16x16x16_bf16 v[8:11], a[232:233], v[16:17], v[8:11]
  v_mfma_f32_16x16x16_bf16 v[12:15], a[234:235], v[16:17], v[12:15]
  s_bitcmp1_b32 s99, 0
  s_cbranch_scc1 L_th_739
  s_waitcnt vmcnt(5)
L_th_739:
  buffer_load_dwordx4 a[100:103], v3, s[12:15], s59 offen offset:1024
  v_and_b32_dpp v16, v53, v20 quad_perm:[3,3,3,3] row_mask:0xf bank_mask:0xf
  v_and_b32_dpp v17, v53, v21 quad_perm:[3,3,3,3] row_mask:0xf bank_mask:0xf
  s_waitcnt vmcnt(55)
  v_mfma_f32_16x16x16_bf16 v[8:11], a[236:237], v[18:19], v[8:11]
  v_mfma_f32_16x16x16_bf16 v[12:15], a[238:239], v[18:19], v[12:15]
  s_bitcmp1_b32 s99, 0
  s_cbranch_scc1 L_th_741
  s_waitcnt vmcnt(5)
L_th_741:
  buffer_load_dwordx4 a[104:107], v3, s[12:15], s59 offen offset:0
  v_and_b32_dpp v18, v53, v20 quad_perm:[2,2,2,2] row_mask:0xf bank_mask:0xf
  v_and_b32_dpp v19, v53, v21 quad_perm:[2,2,2,2] row_mask:0xf bank_mask:0xf
  s_waitcnt vmcnt(55)
  v_mfma_f32_16x16x16_bf16 v[8:11], a[240:241], v[16:17], v[8:11]
  v_mfma_f32_16x16x16_bf16 v[12:15], a[242:243], v[16:17], v[12:15]
  s_mov_b32 s59, 0x7000
  s_bitcmp1_b32 s99, 0
  s_cbranch_scc1 L_th_743
  s_waitcnt vmcnt(5)
L_th_743:
  buffer_load_dwordx4 a[108:111], v3, s[12:15], s59 offen offset:3072
  v_and_b32_dpp v16, v53, v20 quad_perm:[1,1,1,1] row_mask:0xf bank_mask:0xf
  v_and_b32_dpp v17, v53, v21 quad_perm:[1,1,1,1] row_mask:0xf bank_mask:0xf
  s_waitcnt vmcnt(55)
  v_mfma_f32_16x16x16_bf16 v[8:11], a[244:245], v[18:19], v[8:11]
  v_mfma_f32_16x16x16_bf16 v[12:15], a[246:247], v[18:19], v[12:15]
  s_bitcmp1_b32 s99, 0
  s_cbranch_scc1 L_th_745
  s_waitcnt vmcnt(5)
L_th_745:
  buffer_load_dwordx4 v[252:255], v3, s[12:15], s59 offen offset:2048
  v_and_b32_dpp v18, v53, v20 quad_perm:[0,0,0,0] row_mask:0xf bank_mask:0xf
  v_and_b32_dpp v19, v53, v21 quad_perm:[0,0,0,0] row_mask:0xf bank_mask:0xf
  s_waitcnt vmcnt(55)
  v_mfma_f32_16x16x16_bf16 v[8:11], a[248:249], v[16:17], v[8:11]
  v_mfma_f32_16x16x16_bf16 v[12:15], a[250:251], v[16:17], v[12:15]
  s_bitcmp1_b32 s99, 0
  s_cbranch_scc1 L_th_747
  s_waitcnt vmcnt(5)
L_th_747:
  buffer_load_dwordx4 v[248:251], v3, s[12:15], s59 offen offset:1024
  v_and_b32_dpp v16, v52, v20 quad_perm:[3,3,3,3] row_mask:0xf bank_mask:0xf
  v_and_b32_dpp v17, v52, v21 quad_perm:[3,3,3,3] row_mask:0xf bank_mask:0xf
  s_waitcnt vmcnt(55)
  v_mfma_f32_16x16x16_bf16 v[8:11], a[252:253], v[18:19], v[8:11]
  v_mfma_f32_16x16x16_bf16 v[12:15], a[254:255], v[18:19], v[12:15]
  s_bitcmp1_b32 s99, 0
  s_cbranch_scc1 L_th_749
  s_waitcnt vmcnt(5)
L_th_749:
  buffer_load_dwordx4 v[244:247], v3, s[12:15], s59 offen offset:0
  v_and_b32_dpp v18, v52, v20 quad_perm:[2,2,2,2] row_mask:0xf bank_mask:0xf
  v_and_b32_dpp v19, v52, v21 quad_perm:[2,2,2,2] row_mask:0xf bank_mask:0xf
  s_waitcnt vmcnt(55)
  v_mfma_f32_16x16x16_bf16 v[8:11], v[144:145], v[16:17], v[8:11]
  v_mfma_f32_16x16x16_bf16 v[12:15], v[146:147], v[16:17], v[12:15]
  s_mov_b32 s59, 0x6000
  s_bitcmp1_b32 s99, 0
  s_cbranch_scc1 L_th_751
  s_waitcnt vmcnt(5)
L_th_751:
  buffer_load_dwordx4 v[76:79], v3, s[12:15], s59 offen offset:3072
  v_and_b32_dpp v16, v52, v20 quad_perm:[1,1,1,1] row_mask:0xf bank_mask:0xf
  v_and_b32_dpp v17, v52, v21 quad_perm:[1,1,1,1] row_mask:0xf bank_mask:0xf
  s_waitcnt vmcnt(55)
  v_mfma_f32_16x16x16_bf16 v[8:11], v[148:149], v[18:19], v[8:11]
  v_mfma_f32_16x16x16_bf16 v[12:15], v[150:151], v[18:19], v[12:15]
  s_bitcmp1_b32 s99, 0
  s_cbranch_scc1 L_th_753
  s_waitcnt vmcnt(5)
L_th_753:
  buffer_load_dwordx4 v[72:75], v3, s[12:15], s59 offen offset:2048
  v_and_b32_dpp v18, v52, v20 quad_perm:[0,0,0,0] row_mask:0xf bank_mask:0xf
  v_and_b32_dpp v19, v52, v21 quad_perm:[0,0,0,0] row_mask:0xf bank_mask:0xf
  s_waitcnt vmcnt(55)
  v_mfma_f32_16x16x16_bf16 v[8:11], v[152:153], v[16:17], v[8:11]
  v_mfma_f32_16x16x16_bf16 v[12:15], v[154:155], v[16:17], v[12:15]
  s_bitcmp1_b32 s99, 0
  s_cbranch_scc1 L_th_755
  s_waitcnt vmcnt(5)
L_th_755:
  buffer_load_dwordx4 v[68:71], v3, s[12:15], s59 offen offset:1024
  v_and_b32_dpp v16, v51, v20 quad_perm:[3,3,3,3] row_mask:0xf bank_mask:0xf
  v_and_b32_dpp v17, v51, v21 quad_perm:[3,3,3,3] row_mask:0xf bank_mask:0xf
  s_waitcnt vmcnt(55)
  v_mfma_f32_16x16x16_bf16 v[8:11], v[156:157], v[18:19], v[8:11]
  v_mfma_f32_16x16x16_bf16 v[12:15], v[158:159], v[18:19], v[12:15]
  s_bitcmp1_b32 s99, 0
  s_cbranch_scc1 L_th_757
  s_waitcnt vmcnt(5)
L_th_757:
  buffer_load_dwordx4 v[64:67], v3, s[12:15], s59 offen offset:0
  v_and_b32_dpp v18, v51, v20 quad_perm:[2,2,2,2] row_mask:0xf bank_mask:0xf
  v_and_b32_dpp v19, v51, v21 quad_perm:[2,2,2,2] row_mask:0xf bank_mask:0xf
  s_waitcnt vmcnt(55)
  v_mfma_f32_16x16x16_bf16 v[8:11], v[160:161], v[16:17], v[8:11]
  v_mfma_f32_16x16x16_bf16 v[12:15], v[162:163], v[16:17], v[12:15]
  s_mov_b32 s59, 0x5000
  s_bitcmp1_b32 s99, 0
  s_cbranch_scc1 L_th_759
  s_waitcnt vmcnt(5)
L_th_759:
  buffer_load_dwordx4 a[112:115], v3, s[12:15], s59 offen offset:3072
  v_and_b32_dpp v16, v51, v20 quad_perm:[1,1,1,1] row_mask:0xf bank_mask:0xf
  v_and_b32_dpp v17, v51, v21 quad_perm:[1,1,1,1] row_mask:0xf bank_mask:0xf
  s_waitcnt vmcnt(55)
  v_mfma_f32_16x16x16_bf16 v[8:11], v[164:165], v[18:19], v[8:11]
  v_mfma_f32_16x16x16_bf16 v[12:15], v[166:167], v[18:19], v[12:15]
  s_bitcmp1_b32 s99, 0
  s_cbranch_scc1 L_th_761
  s_waitcnt vmcnt(5)
L_th_761:
  buffer_load_dwordx4 a[116:119], v3, s[12:15], s59 offen offset:2048
  v_and_b32_dpp v18, v51, v20 quad_perm:[0,0,0,0] row_mask:0xf bank_mask:0xf
  v_and_b32_dpp v19, v51, v21 quad_perm:[0,0,0,0] row_mask:0xf bank_mask:0xf
  s_waitcnt vmcnt(55)
  v_mfma_f32_16x16x16_bf16 v[8:11], v[168:169], v[16:17], v[8:11]
  v_mfma_f32_16x16x16_bf16 v[12:15], v[170:171], v[16:17], v[12:15]
  s_bitcmp1_b32 s99, 0
  s_cbranch_scc1 L_th_763
  s_waitcnt vmcnt(5)
L_th_763:
  buffer_load_dwordx4 a[120:123], v3, s[12:15], s59 offen offset:1024
  v_and_b32_dpp v16, v50, v20 quad_perm:[3,3,3,3] row_mask:0xf bank_mask:0xf
  v_and_b32_dpp v17, v50, v21 quad_perm:[3,3,3,3] row_mask:0xf bank_mask:0xf
  s_waitcnt vmcnt(55)
  v_mfma_f32_16x16x16_bf16 v[8:11], v[172:173], v[18:19], v[8:11]
  v_mfma_f32_16x16x16_bf16 v[12:15], v[174:175], v[18:19], v[12:15]
  s_bitcmp1_b32 s99, 0
  s_cbranch_scc1 L_th_765
  s_waitcnt vmcnt(5)
L_th_765:
  buffer_load_dwordx4 a[124:127], v3, s[12:15], s59 offen offset:0
  v_and_b32_dpp v18, v50, v20 quad_perm:[2,2,2,2] row_mask:0xf bank_mask:0xf
  v_and_b32_dpp v19, v50, v21 quad_perm:[2,2,2,2] row_mask:0xf bank_mask:0xf
  s_waitcnt vmcnt(55)
  v_mfma_f32_16x16x16_bf16 v[8:11], v[176:177], v[16:17], v[8:11]
  v_mfma_f32_16x16x16_bf16 v[12:15], v[178:179], v[16:17], v[12:15]
  s_mov_b32 s59, 0x4000
  s_bitcmp1_b32 s99, 0
  s_cbranch_scc1 L_th_767
  s_waitcnt vmcnt(5)
L_th_767:
  buffer_load_dwordx4 a[128:131], v3, s[12:15], s59 offen offset:3072
  v_and_b32_dpp v16, v50, v20 quad_perm:[1,1,1,1] row_mask:0xf bank_mask:0xf
  v_and_b32_dpp v17, v50, v21 quad_perm:[1,1,1,1] row_mask:0xf bank_mask:0xf
  s_waitcnt vmcnt(55)
  v_mfma_f32_16x16x16_bf16 v[8:11], v[180:181], v[18:19], v[8:11]
  v_mfma_f32_16x16x16_bf16 v[12:15], v[182:183], v[18:19], v[12:15]
  s_bitcmp1_b32 s99, 0
  s_cbranch_scc1 L_th_769
  s_waitcnt vmcnt(5)
L_th_769:
  buffer_load_dwordx4 a[132:135], v3, s[12:15], s59 offen offset:2048
  v_and_b32_dpp v18, v50, v20 quad_perm:[0,0,0,0] row_mask:0xf bank_mask:0xf
  v_and_b32_dpp v19, v50, v21 quad_perm:[0,0,0,0] row_mask:0xf bank_mask:0xf
  s_waitcnt vmcnt(55)
  v_mfma_f32_16x16x16_bf16 v[8:11], v[184:185], v[16:17], v[8:11]
  v_mfma_f32_16x16x16_bf16 v[12:15], v[186:187], v[16:17], v[12:15]
  s_bitcmp1_b32 s99, 0
  s_cbranch_scc1 L_th_771
  s_waitcnt vmcnt(5)
L_th_771:
  buffer_load_dwordx4 a[136:139], v3, s[12:15], s59 offen offset:1024
  v_and_b32_dpp v16, v49, v20 quad_perm:[3,3,3,3] row_mask:0xf bank_mask:0xf
  v_and_b32_dpp v17, v49, v21 quad_perm:[3,3,3,3] row_mask:0xf bank_mask:0xf
  s_waitcnt vmcnt(55)
  v_mfma_f32_16x16x16_bf16 v[8:11], v[188:189], v[18:19], v[8:11]
  v_mfma_f32_16x16x16_bf16 v[12:15], v[190:191], v[18:19], v[12:15]
  s_bitcmp1_b32 s99, 0
  s_cbranch_scc1 L_th_773
  s_waitcnt vmcnt(5)
L_th_773:
  buffer_load_dwordx4 a[140:143], v3, s[12:15], s59 offen offset:0
  v_and_b32_dpp v18, v49, v20 quad_perm:[2,2,2,2] row_mask:0xf bank_mask:0xf
  v_and_b32_dpp v19, v49, v21 quad_perm:[2,2,2,2] row_mask:0xf bank_mask:0xf
  s_waitcnt vmcnt(55)
  v_mfma_f32_16x16x16_bf16 v[8:11], v[192:193], v[16:17], v[8:11]
  v_mfma_f32_16x16x16_bf16 v[12:15], v[194:195], v[16:17], v[12:15]
  s_mov_b32 s59, 0x3000
  s_bitcmp1_b32 s99, 0
  s_cbranch_scc1 L_th_775
  s_waitcnt vmcnt(5)
L_th_775:
  buffer_load_dwordx4 a[144:147], v3, s[12:15], s59 offen offset:3072
  v_and_b32_dpp v16, v49, v20 quad_perm:[1,1,1,1] row_mask:0xf bank_mask:0xf
  v_and_b32_dpp v17, v49, v21 quad_perm:[1,1,1,1] row_mask:0xf bank_mask:0xf
  s_waitcnt vmcnt(55)
  v_mfma_f32_16x16x16_bf16 v[8:11], v[196:197], v[18:19], v[8:11]
  v_mfma_f32_16x16x16_bf16 v[12:15], v[198:199], v[18:19], v[12:15]
  s_bitcmp1_b32 s99, 0
  s_cbranch_scc1 L_th_777
  s_waitcnt vmcnt(5)
L_th_777:
  buffer_load_dwordx4 a[148:151], v3, s[12:15], s59 offen offset:2048
  v_and_b32_dpp v18, v49, v20 quad_perm:[0,0,0,0] row_mask:0xf bank_mask:0xf
  v_and_b32_dpp v19, v49, v21 quad_perm:[0,0,0,0] row_mask:0xf bank_mask:0xf
  s_waitcnt vmcnt(55)
  v_mfma_f32_16x16x16_bf16 v[8:11], v[200:201], v[16:17], v[8:11]
  v_mfma_f32_16x16x16_bf16 v[12:15], v[202:203], v[16:17], v[12:15]
  s_bitcmp1_b32 s99, 0
  s_cbranch_scc1 L_th_779
  s_waitcnt vmcnt(5)
L_th_779:
  buffer_load_dwordx4 a[152:155], v3, s[12:15], s59 offen offset:1024
  v_and_b32_dpp v16, v48, v20 quad_perm:[3,3,3,3] row_mask:0xf bank_mask:0xf
  v_and_b32_dpp v17, v48, v21 quad_perm:[3,3,3,3] row_mask:0xf bank_mask:0xf
  s_waitcnt vmcnt(55)
  v_mfma_f32_16x16x16_bf16 v[8:11], v[204:205], v[18:19], v[8:11]
  v_mfma_f32_16x16x16_bf16 v[12:15], v[206:207], v[18:19], v[12:15]
  s_bitcmp1_b32 s99, 0
  s_cbranch_scc1 L_th_781
  s_waitcnt vmcnt(5)
L_th_781:
  buffer_load_dwordx4 a[156:159], v3, s[12:15], s59 offen offset:0
  v_and_b32_dpp v18, v48, v20 quad_perm:[2,2,2,2] row_mask:0xf bank_mask:0xf
  v_and_b32_dpp v19, v48, v21 quad_perm:[2,2,2,2] row_mask:0xf bank_mask:0xf
  s_waitcnt vmcnt(55)
  v_mfma_f32_16x16x16_bf16 v[8:11], v[208:209], v[16:17], v[8:11]
  v_mfma_f32_16x16x16_bf16 v[12:15], v[210:211], v[16:17], v[12:15]
  s_mov_b32 s59, 0x2000
  s_bitcmp1_b32 s99, 0
  s_cbranch_scc1 L_th_783
  s_waitcnt vmcnt(5)
L_th_783:
  buffer_load_dwordx4 a[160:163], v3, s[12:15], s59 offen offset:3072
  v_and_b32_dpp v16, v48, v20 quad_perm:[1,1,1,1] row_mask:0xf bank_mask:0xf
  v_and_b32_dpp v17, v48, v21 quad_perm:[1,1,1,1] row_mask:0xf bank_mask:0xf
  s_waitcnt vmcnt(55)
  v_mfma_f32_16x16x16_bf16 v[8:11], v[212:213], v[18:19], v[8:11]
  v_mfma_f32_16x16x16_bf16 v[12:15], v[214:215], v[18:19], v[12:15]
  s_bitcmp1_b32 s99, 0
  s_cbranch_scc1 L_th_785
  s_waitcnt vmcnt(5)
L_th_785:
  buffer_load_dwordx4 a[164:167], v3, s[12:15], s59 offen offset:2048
  v_and_b32_dpp v18, v48, v20 quad_perm:[0,0,0,0] row_mask:0xf bank_mask:0xf
  v_and_b32_dpp v19, v48, v21 quad_perm:[0,0,0,0] row_mask:0xf bank_mask:0xf
  s_waitcnt vmcnt(55)
  v_mfma_f32_16x16x16_bf16 v[8:11], v[216:217], v[16:17], v[8:11]
  v_mfma_f32_16x16x16_bf16 v[12:15], v[218:219], v[16:17], v[12:15]
  s_bitcmp1_b32 s99, 0
  s_cbranch_scc1 L_th_787
  s_waitcnt vmcnt(5)
L_th_787:
  buffer_load_dwordx4 a[168:171], v3, s[12:15], s59 offen offset:1024
  v_and_b32_dpp v16, v47, v20 quad_perm:[3,3,3,3] row_mask:0xf bank_mask:0xf
  v_and_b32_dpp v17, v47, v21 quad_perm:[3,3,3,3] row_mask:0xf bank_mask:0xf
  s_waitcnt vmcnt(55)
  v_mfma_f32_16x16x16_bf16 v[8:11], v[220:221], v[18:19], v[8:11]
  v_mfma_f32_16x16x16_bf16 v[12:15], v[222:223], v[18:19], v[12:15]
  s_bitcmp1_b32 s99, 0
  s_cbranch_scc1 L_th_789
  s_waitcnt vmcnt(5)
L_th_789:
  buffer_load_dwordx4 a[172:175], v3, s[12:15], s59 offen offset:0
  v_and_b32_dpp v18, v47, v20 quad_perm:[2,2,2,2] row_mask:0xf bank_mask:0xf
  v_and_b32_dpp v19, v47, v21 quad_perm:[2,2,2,2] row_mask:0xf bank_mask:0xf
  s_waitcnt vmcnt(55)
  v_mfma_f32_16x16x16_bf16 v[8:11], v[224:225], v[16:17], v[8:11]
  v_mfma_f32_16x16x16_bf16 v[12:15], v[226:227], v[16:17], v[12:15]
  s_mov_b32 s59, 0x1000
  s_bitcmp1_b32 s99, 0
  s_cbranch_scc1 L_th_791
  s_waitcnt vmcnt(5)
L_th_791:
  buffer_load_dwordx4 a[176:179], v3, s[12:15], s59 offen offset:3072
  v_and_b32_dpp v16, v47, v20 quad_perm:[1,1,1,1] row_mask:0xf bank_mask:0xf
  v_and_b32_dpp v17, v47, v21 quad_perm:[1,1,1,1] row_mask:0xf bank_mask:0xf
  s_waitcnt vmcnt(55)
  v_mfma_f32_16x16x16_bf16 v[8:11], v[228:229], v[18:19], v[8:11]
  v_mfma_f32_16x16x16_bf16 v[12:15], v[230:231], v[18:19], v[12:15]
  s_bitcmp1_b32 s99, 0
  s_cbranch_scc1 L_th_793
  s_waitcnt vmcnt(5)
L_th_793:
  buffer_load_dwordx4 a[180:183], v3, s[12:15], s59 offen offset:2048
  v_and_b32_dpp v18, v47, v20 quad_perm:[0,0,0,0] row_mask:0xf bank_mask:0xf
  v_and_b32_dpp v19, v47, v21 quad_perm:[0,0,0,0] row_mask:0xf bank_mask:0xf
  s_waitcnt vmcnt(55)
  v_mfma_f32_16x16x16_bf16 v[8:11], v[232:233], v[16:17], v[8:11]
  v_mfma_f32_16x16x16_bf16 v[12:15], v[234:235], v[16:17], v[12:15]
  s_bitcmp1_b32 s99, 0
  s_cbranch_scc1 L_th_795
  s_waitcnt vmcnt(5)
L_th_795:
  buffer_load_dwordx4 a[184:187], v3, s[12:15], s59 offen offset:1024
  v_and_b32_dpp v16, v46, v20 quad_perm:[3,3,3,3] row_mask:0xf bank_mask:0xf
  v_and_b32_dpp v17, v46, v21 quad_perm:[3,3,3,3] row_mask:0xf bank_mask:0xf
  s_waitcnt vmcnt(55)
  v_mfma_f32_16x16x16_bf16 v[8:11], v[236:237], v[18:19], v[8:11]
  v_mfma_f32_16x16x16_bf16 v[12:15], v[238:239], v[18:19], v[12:15]
  s_bitcmp1_b32 s99, 0
  s_cbranch_scc1 L_th_797
  s_waitcnt vmcnt(5)
L_th_797:
  buffer_load_dwordx4 a[188:191], v3, s[12:15], s59 offen offset:0
  v_and_b32_dpp v18, v46, v20 quad_perm:[2,2,2,2] row_mask:0xf bank_mask:0xf
  v_and_b32_dpp v19, v46, v21 quad_perm:[2,2,2,2] row_mask:0xf bank_mask:0xf
  s_waitcnt vmcnt(55)
  v_mfma_f32_16x16x16_bf16 v[8:11], v[240:241], v[16:17], v[8:11]
  v_mfma_f32_16x16x16_bf16 v[12:15], v[242:243], v[16:17], v[12:15]
  s_mov_b32 s59, 0x0
  s_bitcmp1_b32 s99, 0
  s_cbranch_scc1 L_th_799
  s_waitcnt vmcnt(5)
L_th_799:
  buffer_load_dwordx4 a[192:195], v3, s[12:15], s59 offen offset:3072
  v_and_b32_dpp v16, v46, v20 quad_perm:[1,1,1,1] row_mask:0xf bank_mask:0xf
  v_and_b32_dpp v17, v46, v21 quad_perm:[1,1,1,1] row_mask:0xf bank_mask:0xf
  s_waitcnt vmcnt(55)
  v_mfma_f32_16x16x16_bf16 v[8:11], a[0:1], v[18:19], v[8:11]
  v_mfma_f32_16x16x16_bf16 v[12:15], a[2:3], v[18:19], v[12:15]
  s_bitcmp1_b32 s99, 0
  s_cbranch_scc1 L_th_801
  s_waitcnt vmcnt(5)
L_th_801:
  buffer_load_dwordx4 a[196:199], v3, s[12:15], s59 offen offset:2048
  v_and_b32_dpp v18, v46, v20 quad_perm:[0,0,0,0] row_mask:0xf bank_mask:0xf
  v_and_b32_dpp v19, v46, v21 quad_perm:[0,0,0,0] row_mask:0xf bank_mask:0xf
  s_waitcnt vmcnt(55)
  v_mfma_f32_16x16x16_bf16 v[8:11], a[4:5], v[16:17], v[8:11]
  v_mfma_f32_16x16x16_bf16 v[12:15], a[6:7], v[16:17], v[12:15]
  s_bitcmp1_b32 s99, 0
  s_cbranch_scc1 L_th_803
  s_waitcnt vmcnt(5)
L_th_803:
  buffer_load_dwordx4 a[200:203], v3, s[12:15], s59 offen offset:1024
  v_and_b32_dpp v16, v45, v20 quad_perm:[3,3,3,3] row_mask:0xf bank_mask:0xf
  v_and_b32_dpp v17, v45, v21 quad_perm:[3,3,3,3] row_mask:0xf bank_mask:0xf
  s_waitcnt vmcnt(55)
  v_mfma_f32_16x16x16_bf16 v[8:11], a[8:9], v[18:19], v[8:11]
  v_mfma_f32_16x16x16_bf16 v[12:15], a[10:11], v[18:19], v[12:15]
  s_bitcmp1_b32 s99, 0
  s_cbranch_scc1 L_th_805
  s_waitcnt vmcnt(5)
L_th_805:
  buffer_load_dwordx4 a[204:207], v3, s[12:15], s59 offen offset:0
  v_and_b32_dpp v18, v45, v20 quad_perm:[2,2,2,2] row_mask:0xf bank_mask:0xf
  v_and_b32_dpp v19, v45, v21 quad_perm:[2,2,2,2] row_mask:0xf bank_mask:0xf
  s_waitcnt vmcnt(55)
  v_mfma_f32_16x16x16_bf16 v[8:11], a[12:13], v[16:17], v[8:11]
  v_mfma_f32_16x16x16_bf16 v[12:15], a[14:15], v[16:17], v[12:15]
  v_and_b32_dpp v16, v45, v20 quad_perm:[1,1,1,1] row_mask:0xf bank_mask:0xf
  v_and_b32_dpp v17, v45, v21 quad_perm:[1,1,1,1] row_mask:0xf bank_mask:0xf
  s_waitcnt vmcnt(54)
  v_mfma_f32_16x16x16_bf16 v[8:11], a[16:17], v[18:19], v[8:11]
  v_mfma_f32_16x16x16_bf16 v[12:15], a[18:19], v[18:19], v[12:15]
  v_and_b32_dpp v18, v45, v20 quad_perm:[0,0,0,0] row_mask:0xf bank_mask:0xf
  v_and_b32_dpp v19, v45, v21 quad_perm:[0,0,0,0] row_mask:0xf bank_mask:0xf
  s_waitcnt vmcnt(53)
  v_mfma_f32_16x16x16_bf16 v[8:11], a[20:21], v[16:17], v[8:11]
  v_mfma_f32_16x16x16_bf16 v[12:15], a[22:23], v[16:17], v[12:15]
  v_and_b32_dpp v16, v44, v20 quad_perm:[3,3,3,3] row_mask:0xf bank_mask:0xf
  v_and_b32_dpp v17, v44, v21 quad_perm:[3,3,3,3] row_mask:0xf bank_mask:0xf
  s_waitcnt vmcnt(52)
  v_mfma_f32_16x16x16_bf16 v[8:11], a[24:25], v[18:19], v[8:11]
  v_mfma_f32_16x16x16_bf16 v[12:15], a[26:27], v[18:19], v[12:15]
  v_and_b32_dpp v18, v44, v20 quad_perm:[2,2,2,2] row_mask:0xf bank_mask:0xf
  v_and_b32_dpp v19, v44, v21 quad_perm:[2,2,2,2] row_mask:0xf bank_mask:0xf
  s_waitcnt vmcnt(51)
  v_mfma_f32_16x16x16_bf16 v[8:11], a[28:29], v[16:17], v[8:11]
  v_mfma_f32_16x16x16_bf16 v[12:15], a[30:31], v[16:17], v[12:15]
  v_and_b32_dpp v16, v44, v20 quad_perm:[1,1,1,1] row_mask:0xf bank_mask:0xf
  v_and_b32_dpp v17, v44, v21 quad_perm:[1,1,1,1] row_mask:0xf bank_mask:0xf
  s_waitcnt vmcnt(50)
  v_mfma_f32_16x16x16_bf16 v[8:11], a[32:33], v[18:19], v[8:11]
  v_mfma_f32_16x16x16_bf16 v[12:15], a[34:35], v[18:19], v[12:15]
  v_and_b32_dpp v18, v44, v20 quad_perm:[0,0,0,0] row_mask:0xf bank_mask:0xf
  v_and_b32_dpp v19, v44, v21 quad_perm:[0,0,0,0] row_mask:0xf bank_mask:0xf
  s_waitcnt vmcnt(49)
  v_mfma_f32_16x16x16_bf16 v[8:11], a[36:37], v[16:17], v[8:11]
  v_mfma_f32_16x16x16_bf16 v[12:15], a[38:39], v[16:17], v[12:15]
  v_and_b32_dpp v16, v43, v20 quad_perm:[3,3,3,3] row_mask:0xf bank_mask:0xf
  v_and_b32_dpp v17, v43, v21 quad_perm:[3,3,3,3] row_mask:0xf bank_mask:0xf
  s_waitcnt vmcnt(48)
  v_mfma_f32_16x16x16_bf16 v[8:11], a[40:41], v[18:19], v[8:11]
  v_mfma_f32_16x16x16_bf16 v[12:15], a[42:43], v[18:19], v[12:15]
  v_and_b32_dpp v18, v43, v20 quad_perm:[2,2,2,2] row_mask:0xf bank_mask:0xf
  v_and_b32_dpp v19, v43, v21 quad_perm:[2,2,2,2] row_mask:0xf bank_mask:0xf
  s_waitcnt vmcnt(47)
  v_mfma_f32_16x16x16_bf16 v[8:11], a[44:45], v[16:17], v[8:11]
  v_mfma_f32_16x16x16_bf16 v[12:15], a[46:47], v[16:17], v[12:15]
  v_and_b32_dpp v16, v43, v20 quad_perm:[1,1,1,1] row_mask:0xf bank_mask:0xf
  v_and_b32_dpp v17, v43, v21 quad_perm:[1,1,1,1] row_mask:0xf bank_mask:0xf
  s_waitcnt vmcnt(46)
  v_mfma_f32_16x16x16_bf16 v[8:11], a[48:49], v[18:19], v[8:11]
  v_mfma_f32_16x16x16_bf16 v[12:15], a[50:51], v[18:19], v[12:15]
  v_and_b32_dpp v18, v43, v20 quad_perm:[0,0,0,0] row_mask:0xf bank_mask:0xf
  v_and_b32_dpp v19, v43, v21 quad_perm:[0,0,0,0] row_mask:0xf bank_mask:0xf
  s_waitcnt vmcnt(45)
  v_mfma_f32_16x16x16_bf16 v[8:11], a[52:53], v[16:17], v[8:11]
  v_mfma_f32_16x16x16_bf16 v[12:15], a[54:55], v[16:17], v[12:15]
  v_and_b32_dpp v16, v42, v20 quad_perm:[3,3,3,3] row_mask:0xf bank_mask:0xf
  v_and_b32_dpp v17, v42, v21 quad_perm:[3,3,3,3] row_mask:0xf bank_mask:0xf
  s_waitcnt vmcnt(44)
  v_mfma_f32_16x16x16_bf16 v[8:11], a[56:57], v[18:19], v[8:11]
  v_mfma_f32_16x16x16_bf16 v[12:15], a[58:59], v[18:19], v[12:15]
  v_and_b32_dpp v18, v42, v20 quad_perm:[2,2,2,2] row_mask:0xf bank_mask:0xf
  v_and_b32_dpp v19, v42, v21 quad_perm:[2,2,2,2] row_mask:0xf bank_mask:0xf
  s_waitcnt vmcnt(43)
  v_mfma_f32_16x16x16_bf16 v[8:11], a[60:61], v[16:17], v[8:11]
  v_mfma_f32_16x16x16_bf16 v[12:15], a[62:63], v[16:17], v[12:15]
  v_and_b32_dpp v16, v42, v20 quad_perm:[1,1,1,1] row_mask:0xf bank_mask:0xf
  v_and_b32_dpp v17, v42, v21 quad_perm:[1,1,1,1] row_mask:0xf bank_mask:0xf
  s_waitcnt vmcnt(42)
  v_mfma_f32_16x16x16_bf16 v[8:11], a[64:65], v[18:19], v[8:11]
  v_mfma_f32_16x16x16_bf16 v[12:15], a[66:67], v[18:19], v[12:15]
  v_and_b32_dpp v18, v42, v20 quad_perm:[0,0,0,0] row_mask:0xf bank_mask:0xf
  v_and_b32_dpp v19, v42, v21 quad_perm:[0,0,0,0] row_mask:0xf bank_mask:0xf
  s_waitcnt vmcnt(41)
  v_mfma_f32_16x16x16_bf16 v[8:11], a[68:69], v[16:17], v[8:11]
  v_mfma_f32_16x16x16_bf16 v[12:15], a[70:71], v[16:17], v[12:15]
  v_and_b32_dpp v16, v41, v20 quad_perm:[3,3,3,3] row_mask:0xf bank_mask:0xf
  v_and_b32_dpp v17, v41, v21 quad_perm:[3,3,3,3] row_mask:0xf bank_mask:0xf
  s_waitcnt vmcnt(40)
  v_mfma_f32_16x16x16_bf16 v[8:11], a[72:73], v[18:19], v[8:11]
  v_mfma_f32_16x16x16_bf16 v[12:15], a[74:75], v[18:19], v[12:15]
  v_and_b32_dpp v18, v41, v20 quad_perm:[2,2,2,2] row_mask:0xf bank_mask:0xf
  v_and_b32_dpp v19, v41, v21 quad_perm:[2,2,2,2] row_mask:0xf bank_mask:0xf
  s_waitcnt vmcnt(39)
  v_mfma_f32_16x16x16_bf16 v[8:11], a[76:77], v[16:17], v[8:11]
  v_mfma_f32_16x16x16_bf16 v[12:15], a[78:79], v[16:17], v[12:15]
  v_and_b32_dpp v16, v41, v20 quad_perm:[1,1,1,1] row_mask:0xf bank_mask:0xf
  v_and_b32_dpp v17, v41, v21 quad_perm:[1,1,1,1] row_mask:0xf bank_mask:0xf
  s_waitcnt vmcnt(38)
  v_mfma_f32_16x16x16_bf16 v[8:11], a[80:81], v[18:19], v[8:11]
  v_mfma_f32_16x16x16_bf16 v[12:15], a[82:83], v[18:19], v[12:15]
  v_and_b32_dpp v18, v41, v20 quad_perm:[0,0,0,0] row_mask:0xf bank_mask:0xf
  v_and_b32_dpp v19, v41, v21 quad_perm:[0,0,0,0] row_mask:0xf bank_mask:0xf
  s_waitcnt vmcnt(37)
  v_mfma_f32_16x16x16_bf16 v[8:11], a[84:85], v[16:17], v[8:11]
  v_mfma_f32_16x16x16_bf16 v[12:15], a[86:87], v[16:17], v[12:15]
  v_and_b32_dpp v16, v40, v20 quad_perm:[3,3,3,3] row_mask:0xf bank_mask:0xf
  v_and_b32_dpp v17, v40, v21 quad_perm:[3,3,3,3] row_mask:0xf bank_mask:0xf
  s_waitcnt vmcnt(36)
  v_mfma_f32_16x16x16_bf16 v[8:11], a[88:89], v[18:19], v[8:11]
  v_mfma_f32_16x16x16_bf16 v[12:15], a[90:91], v[18:19], v[12:15]
  v_and_b32_dpp v18, v40, v20 quad_perm:[2,2,2,2] row_mask:0xf bank_mask:0xf
  v_and_b32_dpp v19, v40, v21 quad_perm:[2,2,2,2] row_mask:0xf bank_mask:0xf
  s_waitcnt vmcnt(35)
  v_mfma_f32_16x16x16_bf16 v[8:11], a[92:93], v[16:17], v[8:11]
  v_mfma_f32_16x16x16_bf16 v[12:15], a[94:95], v[16:17], v[12:15]
  v_and_b32_dpp v16, v40, v20 quad_perm:[1,1,1,1] row_mask:0xf bank_mask:0xf
  v_and_b32_dpp v17, v40, v21 quad_perm:[1,1,1,1] row_mask:0xf bank_mask:0xf
  s_waitcnt vmcnt(34)
  v_mfma_f32_16x16x16_bf16 v[8:11], a[96:97], v[18:19], v[8:11]
  v_mfma_f32_16x16x16_bf16 v[12:15], a[98:99], v[18:19], v[12:15]
  v_and_b32_dpp v18, v40, v20 quad_perm:[0,0,0,0] row_mask:0xf bank_mask:0xf
  v_and_b32_dpp v19, v40, v21 quad_perm:[0,0,0,0] row_mask:0xf bank_mask:0xf
  s_waitcnt vmcnt(33)
  v_mfma_f32_16x16x16_bf16 v[8:11], a[100:101], v[16:17], v[8:11]
  v_mfma_f32_16x16x16_bf16 v[12:15], a[102:103], v[16:17], v[12:15]
  v_and_b32_dpp v16, v39, v20 quad_perm:[3,3,3,3] row_mask:0xf bank_mask:0xf
  v_and_b32_dpp v17, v39, v21 quad_perm:[3,3,3,3] row_mask:0xf bank_mask:0xf
  s_waitcnt vmcnt(32)
  v_mfma_f32_16x16x16_bf16 v[8:11], a[104:105], v[18:19], v[8:11]
  v_mfma_f32_16x16x16_bf16 v[12:15], a[106:107], v[18:19], v[12:15]
  v_and_b32_dpp v18, v39, v20 quad_perm:[2,2,2,2] row_mask:0xf bank_mask:0xf
  v_and_b32_dpp v19, v39, v21 quad_perm:[2,2,2,2] row_mask:0xf bank_mask:0xf
  s_waitcnt vmcnt(31)
  v_mfma_f32_16x16x16_bf16 v[8:11], a[108:109], v[16:17], v[8:11]
  v_mfma_f32_16x16x16_bf16 v[12:15], a[110:111], v[16:17], v[12:15]
  v_and_b32_dpp v16, v39, v20 quad_perm:[1,1,1,1] row_mask:0xf bank_mask:0xf
  v_and_b32_dpp v17, v39, v21 quad_perm:[1,1,1,1] row_mask:0xf bank_mask:0xf
  s_waitcnt vmcnt(30)
  v_mfma_f32_16x16x16_bf16 v[8:11], v[252:253], v[18:19], v[8:11]
  v_mfma_f32_16x16x16_bf16 v[12:15], v[254:255], v[18:19], v[12:15]
  v_and_b32_dpp v18, v39, v20 quad_perm:[0,0,0,0] row_mask:0xf bank_mask:0xf
  v_and_b32_dpp v19, v39, v21 quad_perm:[0,0,0,0] row_mask:0xf bank_mask:0xf
  s_waitcnt vmcnt(29)
  v_mfma_f32_16x16x16_bf16 v[8:11], v[248:249], v[16:17], v[8:11]
  v_mfma_f32_16x16x16_bf16 v[12:15], v[250:251], v[16:17], v[12:15]
  v_and_b32_dpp v16, v38, v20 quad_perm:[3,3,3,3] row_mask:0xf bank_mask:0xf
  v_and_b32_dpp v17, v38, v21 quad_perm:[3,3,3,3] row_mask:0xf bank_mask:0xf
  s_waitcnt vmcnt(28)
  v_mfma_f32_16x16x16_bf16 v[8:11], v[244:245], v[18:19], v[8:11]
  v_mfma_f32_16x16x16_bf16 v[12:15], v[246:247], v[18:19], v[12:15]
  v_and_b32_dpp v18, v38, v20 quad_perm:[2,2,2,2] row_mask:0xf bank_mask:0xf
  v_and_b32_dpp v19, v38, v21 quad_perm:[2,2,2,2] row_mask:0xf bank_mask:0xf
  s_waitcnt vmcnt(27)
  v_mfma_f32_16x16x16_bf16 v[8:11], v[76:77], v[16:17], v[8:11]
  v_mfma_f32_16x16x16_bf16 v[12:15], v[78:79], v[16:17], v[12:15]
  v_and_b32_dpp v16, v38, v20 quad_perm:[1,1,1,1] row_mask:0xf bank_mask:0xf
  v_and_b32_dpp v17, v38, v21 quad_perm:[1,1,1,1] row_mask:0xf bank_mask:0xf
  s_waitcnt vmcnt(26)
  v_mfma_f32_16x16x16_bf16 v[8:11], v[72:73], v[18:19], v[8:11]
  v_mfma_f32_16x16x16_bf16 v[12:15], v[74:75], v[18:19], v[12:15]
  v_and_b32_dpp v18, v38, v20 quad_perm:[0,0,0,0] row_mask:0xf bank_mask:0xf
  v_and_b32_dpp v19, v38, v21 quad_perm:[0,0,0,0] row_mask:0xf bank_mask:0xf
  s_waitcnt vmcnt(25)
  v_mfma_f32_16x16x16_bf16 v[8:11], v[68:69], v[16:17], v[8:11]
  v_mfma_f32_16x16x16_bf16 v[12:15], v[70:71], v[16:17], v[12:15]
  v_and_b32_dpp v16, v37, v20 quad_perm:[3,3,3,3] row_mask:0xf bank_mask:0xf
  v_and_b32_dpp v17, v37, v21 quad_perm:[3,3,3,3] row_mask:0xf bank_mask:0xf
  s_waitcnt vmcnt(24)
  v_mfma_f32_16x16x16_bf16 v[8:11], v[64:65], v[18:19], v[8:11]
  v_mfma_f32_16x16x16_bf16 v[12:15], v[66:67], v[18:19], v[12:15]
  v_and_b32_dpp v18, v37, v20 quad_perm:[2,2,2,2] row_mask:0xf bank_mask:0xf
  v_and_b32_dpp v19, v37, v21 quad_perm:[2,2,2,2] row_mask:0xf bank_mask:0xf
  s_waitcnt vmcnt(23)
  v_mfma_f32_16x16x16_bf16 v[8:11], a[112:113], v[16:17], v[8:11]
  v_mfma_f32_16x16x16_bf16 v[12:15], a[114:115], v[16:17], v[12:15]
  v_lshlrev_b32 v26, 4, v1
  v_lshrrev_b32 v27, 2, v1
  v_lshlrev_b32 v27, 4, v27
  s_lshl_b32 s55, s52, 8
  v_add_u32 v27, s55, v27
  s_lshl_b32 s66, s53, 12
  s_lshr_b32 s55, s54, 3
  s_lshl_b32 s55, s55, 10
  s_add_u32 s66, s66, s55
  s_add_u32 s66, s66, 0x29c000
  v_mov_b32 v80, -1
  v_mov_b32 v81, -1
  v_mov_b32 v82, -1
  v_mov_b32 v83, -1
  v_mov_b32 v84, -1
  v_mov_b32 v85, -1
  v_mov_b32 v86, -1
  v_mov_b32 v87, -1
  buffer_load_dwordx4 v[80:83], v26, s[48:51], s66 offen sc1
  buffer_load_dwordx4 v[84:87], v27, s[48:51], s66 offen sc1
  v_and_b32_dpp v16, v37, v20 quad_perm:[1,1,1,1] row_mask:0xf bank_mask:0xf
  v_and_b32_dpp v17, v37, v21 quad_perm:[1,1,1,1] row_mask:0xf bank_mask:0xf
  s_waitcnt vmcnt(22)
  v_mfma_f32_16x16x16_bf16 v[8:11], a[116:117], v[18:19], v[8:11]
  v_mfma_f32_16x16x16_bf16 v[12:15], a[118:119], v[18:19], v[12:15]
  v_and_b32_dpp v18, v37, v20 quad_perm:[0,0,0,0] row_mask:0xf bank_mask:0xf
  v_and_b32_dpp v19, v37, v21 quad_perm:[0,0,0,0] row_mask:0xf bank_mask:0xf
  s_waitcnt vmcnt(21)
  v_mfma_f32_16x16x16_bf16 v[8:11], a[120:121], v[16:17], v[8:11]
  v_mfma_f32_16x16x16_bf16 v[12:15], a[122:123], v[16:17], v[12:15]
  v_and_b32_dpp v16, v36, v20 quad_perm:[3,3,3,3] row_mask:0xf bank_mask:0xf
  v_and_b32_dpp v17, v36, v21 quad_perm:[3,3,3,3] row_mask:0xf bank_mask:0xf
  s_waitcnt vmcnt(20)
  v_mfma_f32_16x16x16_bf16 v[8:11], a[124:125], v[18:19], v[8:11]
  v_mfma_f32_16x16x16_bf16 v[12:15], a[126:127], v[18:19], v[12:15]
  v_and_b32_dpp v18, v36, v20 quad_perm:[2,2,2,2] row_mask:0xf bank_mask:0xf
  v_and_b32_dpp v19, v36, v21 quad_perm:[2,2,2,2] row_mask:0xf bank_mask:0xf
  s_waitcnt vmcnt(19)
  v_mfma_f32_16x16x16_bf16 v[8:11], a[128:129], v[16:17], v[8:11]
  v_mfma_f32_16x16x16_bf16 v[12:15], a[130:131], v[16:17], v[12:15]
  v_and_b32_dpp v16, v36, v20 quad_perm:[1,1,1,1] row_mask:0xf bank_mask:0xf
  v_and_b32_dpp v17, v36, v21 quad_perm:[1,1,1,1] row_mask:0xf bank_mask:0xf
  s_waitcnt vmcnt(18)
  v_mfma_f32_16x16x16_bf16 v[8:11], a[132:133], v[18:19], v[8:11]
  v_mfma_f32_16x16x16_bf16 v[12:15], a[134:135], v[18:19], v[12:15]
  v_and_b32_dpp v18, v36, v20 quad_perm:[0,0,0,0] row_mask:0xf bank_mask:0xf
  v_and_b32_dpp v19, v36, v21 quad_perm:[0,0,0,0] row_mask:0xf bank_mask:0xf
  s_waitcnt vmcnt(17)
  v_mfma_f32_16x16x16_bf16 v[8:11], a[136:137], v[16:17], v[8:11]
  v_mfma_f32_16x16x16_bf16 v[12:15], a[138:139], v[16:17], v[12:15]
  v_and_b32_dpp v16, v35, v20 quad_perm:[3,3,3,3] row_mask:0xf bank_mask:0xf
  v_and_b32_dpp v17, v35, v21 quad_perm:[3,3,3,3] row_mask:0xf bank_mask:0xf
  s_waitcnt vmcnt(16)
  v_mfma_f32_16x16x16_bf16 v[8:11], a[140:141], v[18:19], v[8:11]
  v_mfma_f32_16x16x16_bf16 v[12:15], a[142:143], v[18:19], v[12:15]
  v_and_b32_dpp v18, v35, v20 quad_perm:[2,2,2,2] row_mask:0xf bank_mask:0xf
  v_and_b32_dpp v19, v35, v21 quad_perm:[2,2,2,2] row_mask:0xf bank_mask:0xf
  s_waitcnt vmcnt(15)
  v_mfma_f32_16x16x16_bf16 v[8:11], a[144:145], v[16:17], v[8:11]
  v_mfma_f32_16x16x16_bf16 v[12:15], a[146:147], v[16:17], v[12:15]
  v_and_b32_dpp v16, v35, v20 quad_perm:[1,1,1,1] row_mask:0xf bank_mask:0xf
  v_and_b32_dpp v17, v35, v21 quad_perm:[1,1,1,1] row_mask:0xf bank_mask:0xf
  s_waitcnt vmcnt(14)
  v_mfma_f32_16x16x16_bf16 v[8:11], a[148:149], v[18:19], v[8:11]
  v_mfma_f32_16x16x16_bf16 v[12:15], a[150:151], v[18:19], v[12:15]
  v_and_b32_dpp v18, v35, v20 quad_perm:[0,0,0,0] row_mask:0xf bank_mask:0xf
  v_and_b32_dpp v19, v35, v21 quad_perm:[0,0,0,0] row_mask:0xf bank_mask:0xf
  s_waitcnt vmcnt(13)
  v_mfma_f32_16x16x16_bf16 v[8:11], a[152:153], v[16:17], v[8:11]
  v_mfma_f32_16x16x16_bf16 v[12:15], a[154:155], v[16:17], v[12:15]
  v_and_b32_dpp v16, v34, v20 quad_perm:[3,3,3,3] row_mask:0xf bank_mask:0xf
  v_and_b32_dpp v17, v34, v21 quad_perm:[3,3,3,3] row_mask:0xf bank_mask:0xf
  s_waitcnt vmcnt(12)
  v_mfma_f32_16x16x16_bf16 v[8:11], a[156:157], v[18:19], v[8:11]
  v_mfma_f32_16x16x16_bf16 v[12:15], a[158:159], v[18:19], v[12:15]
  v_and_b32_dpp v18, v34, v20 quad_perm:[2,2,2,2] row_mask:0xf bank_mask:0xf
  v_and_b32_dpp v19, v34, v21 quad_perm:[2,2,2,2] row_mask:0xf bank_mask:0xf
  s_waitcnt vmcnt(11)
  v_mfma_f32_16x16x16_bf16 v[8:11], a[160:161], v[16:17], v[8:11]
  v_mfma_f32_16x16x16_bf16 v[12:15], a[162:163], v[16:17], v[12:15]
  v_and_b32_dpp v16, v34, v20 quad_perm:[1,1,1,1] row_mask:0xf bank_mask:0xf
  v_and_b32_dpp v17, v34, v21 quad_perm:[1,1,1,1] row_mask:0xf bank_mask:0xf
  s_waitcnt vmcnt(10)
  v_mfma_f32_16x16x16_bf16 v[8:11], a[164:165], v[18:19], v[8:11]
  v_mfma_f32_16x16x16_bf16 v[12:15], a[166:167], v[18:19], v[12:15]
  v_and_b32_dpp v18, v34, v20 quad_perm:[0,0,0,0] row_mask:0xf bank_mask:0xf
  v_and_b32_dpp v19, v34, v21 quad_perm:[0,0,0,0] row_mask:0xf bank_mask:0xf
  s_waitcnt vmcnt(9)
  v_mfma_f32_16x16x16_bf16 v[8:11], a[168:169], v[16:17], v[8:11]
  v_mfma_f32_16x16x16_bf16 v[12:15], a[170:171], v[16:17], v[12:15]
  v_and_b32_dpp v16, v33, v20 quad_perm:[3,3,3,3] row_mask:0xf bank_mask:0xf
  v_and_b32_dpp v17, v33, v21 quad_perm:[3,3,3,3] row_mask:0xf bank_mask:0xf
  s_waitcnt vmcnt(8)
  v_mfma_f32_16x16x16_bf16 v[8:11], a[172:173], v[18:19], v[8:11]
  v_mfma_f32_16x16x16_bf16 v[12:15], a[174:175], v[18:19], v[12:15]
  v_and_b32_dpp v18, v33, v20 quad_perm:[2,2,2,2] row_mask:0xf bank_mask:0xf
  v_and_b32_dpp v19, v33, v21 quad_perm:[2,2,2,2] row_mask:0xf bank_mask:0xf
  s_waitcnt vmcnt(7)
  v_mfma_f32_16x16x16_bf16 v[8:11], a[176:177], v[16:17], v[8:11]
  v_mfma_f32_16x16x16_bf16 v[12:15], a[178:179], v[16:17], v[12:15]
  s_waitcnt vmcnt(0)
  v_max3_u32 v28, v80, v81, v82
  v_max3_u32 v28, v28, v83, v84
  v_max3_u32 v28, v28, v85, v86
  v_max_u32 v28, v28, v87
  v_cmp_eq_u32 vcc, -1, v28
  s_mov_b32 s98, 0
  s_cbranch_vccnz L_mlt_807
  v_max_f32 v28, v80, v82
  s_nop 1
  v_max_f32_dpp v28, v28, v28 row_ror:8 row_mask:0xf bank_mask:0xf
  s_nop 1
  v_max_f32_dpp v28, v28, v28 row_ror:4 row_mask:0xf bank_mask:0xf
  s_nop 1
  v_max_f32_dpp v28, v28, v28 row_ror:2 row_mask:0xf bank_mask:0xf
  s_nop 1
  v_max_f32_dpp v28, v28, v28 row_ror:1 row_mask:0xf bank_mask:0xf
  v_mov_b32 v30, v28
  s_nop 1
  v_permlane32_swap_b32 v28, v30
  s_nop 0
  v_max_f32 v28, v28, v30
  v_mov_b32 v30, v28
  s_nop 1
  v_permlane16_swap_b32 v28, v30
  s_nop 0
  v_max_f32 v28, v28, v30
  v_mul_f32 v28, s96, v28
  v_fma_f32 v80, v80, s96, -v28
  v_fma_f32 v82, v82, s96, -v28
  v_fma_f32 v84, v84, s96, -v28
  v_fma_f32 v86, v86, s96, -v28
  v_exp_f32 v80, v80
  v_exp_f32 v82, v82
  v_exp_f32 v84, v84
  v_exp_f32 v86, v86
  s_nop 0
  v_mul_f32 v29, v80, v81
  v_fmac_f32 v29, v82, v83
  s_nop 1
  v_add_f32_dpp v29, v29, v29 row_ror:8 row_mask:0xf bank_mask:0xf
  s_nop 1
  v_add_f32_dpp v29, v29, v29 row_ror:4 row_mask:0xf bank_mask:0xf
  s_nop 1
  v_add_f32_dpp v29, v29, v29 row_ror:2 row_mask:0xf bank_mask:0xf
  s_nop 1
  v_add_f32_dpp v29, v29, v29 row_ror:1 row_mask:0xf bank_mask:0xf
  v_mov_b32 v30, v29
  s_nop 1
  v_permlane32_swap_b32 v29, v30
  s_nop 0
  v_add_f32 v29, v29, v30
  v_mov_b32 v30, v29
  s_nop 1
  v_permlane16_swap_b32 v29, v30
  s_nop 0
  v_add_f32 v29, v29, v30
  v_rcp_f32 v29, v29
  s_nop 0
  v_mul_f32 v80, v84, v29
  v_mul_f32 v81, v86, v29
  s_mov_b32 s98, 1
L_mlt_807:
  v_bfe_u32 v82, v1, 2, 2
  v_lshlrev_b32 v82, 16, v82
  v_lshrrev_b32 v83, 4, v1
  v_lshl_add_u32 v82, v83, 14, v82
  v_and_b32 v83, 3, v1
  v_lshl_add_u32 v82, v83, 4, v82
  s_lshl_b32 s97, s53, 18
  s_lshl_b32 s56, s54, 8
  s_add_u32 s97, s97, s56
  s_lshl_b32 s56, s52, 6
  s_add_u32 s97, s97, s56
  s_add_u32 s97, s97, 0x2c8000
  v_and_b32_dpp v16, v33, v20 quad_perm:[1,1,1,1] row_mask:0xf bank_mask:0xf
  v_and_b32_dpp v17, v33, v21 quad_perm:[1,1,1,1] row_mask:0xf bank_mask:0xf
  s_waitcnt vmcnt(6)
  v_mfma_f32_16x16x16_bf16 v[8:11], a[180:181], v[18:19], v[8:11]
  v_mfma_f32_16x16x16_bf16 v[12:15], a[182:183], v[18:19], v[12:15]
  v_and_b32_dpp v18, v33, v20 quad_perm:[0,0,0,0] row_mask:0xf bank_mask:0xf
  v_and_b32_dpp v19, v33, v21 quad_perm:[0,0,0,0] row_mask:0xf bank_mask:0xf
  s_waitcnt vmcnt(5)
  v_mfma_f32_16x16x16_bf16 v[8:11], a[184:185], v[16:17], v[8:11]
  v_mfma_f32_16x16x16_bf16 v[12:15], a[186:187], v[16:17], v[12:15]
  v_and_b32_dpp v16, v32, v20 quad_perm:[3,3,3,3] row_mask:0xf bank_mask:0xf
  v_and_b32_dpp v17, v32, v21 quad_perm:[3,3,3,3] row_mask:0xf bank_mask:0xf
  s_waitcnt vmcnt(4)
  v_mfma_f32_16x16x16_bf16 v[8:11], a[188:189], v[18:19], v[8:11]
  v_mfma_f32_16x16x16_bf16 v[12:15], a[190:191], v[18:19], v[12:15]
  v_and_b32_dpp v18, v32, v20 quad_perm:[2,2,2,2] row_mask:0xf bank_mask:0xf
  v_and_b32_dpp v19, v32, v21 quad_perm:[2,2,2,2] row_mask:0xf bank_mask:0xf
  s_waitcnt vmcnt(3)
  v_mfma_f32_16x16x16_bf16 v[8:11], a[192:193], v[16:17], v[8:11]
  v_mfma_f32_16x16x16_bf16 v[12:15], a[194:195], v[16:17], v[12:15]
  v_and_b32_dpp v16, v32, v20 quad_perm:[1,1,1,1] row_mask:0xf bank_mask:0xf
  v_and_b32_dpp v17, v32, v21 quad_perm:[1,1,1,1] row_mask:0xf bank_mask:0xf
  s_waitcnt vmcnt(2)
  v_mfma_f32_16x16x16_bf16 v[8:11], a[196:197], v[18:19], v[8:11]
  v_mfma_f32_16x16x16_bf16 v[12:15], a[198:199], v[18:19], v[12:15]
  v_and_b32_dpp v18, v32, v20 quad_perm:[0,0,0,0] row_mask:0xf bank_mask:0xf
  v_and_b32_dpp v19, v32, v21 quad_perm:[0,0,0,0] row_mask:0xf bank_mask:0xf
  s_waitcnt vmcnt(1)
  v_mfma_f32_16x16x16_bf16 v[8:11], a[200:201], v[16:17], v[8:11]
  v_mfma_f32_16x16x16_bf16 v[12:15], a[202:203], v[16:17], v[12:15]
  s_nop 1
  s_waitcnt vmcnt(0)
  v_mfma_f32_16x16x16_bf16 v[8:11], a[204:205], v[18:19], v[8:11]
  v_mfma_f32_16x16x16_bf16 v[12:15], a[206:207], v[18:19], v[12:15]
  s_nop 7
  v_min_u32 v8, -2, v8
  v_min_u32 v9, -2, v9
  v_min_u32 v10, -2, v10
  v_min_u32 v11, -2, v11
  v_min_u32 v12, -2, v12
  v_min_u32 v13, -2, v13
  v_min_u32 v14, -2, v14
  v_min_u32 v15, -2, v15
  s_add_u32 s55, s97, 8192
  buffer_store_dwordx4 v[8:11], v82, s[48:51], s97 offen sc1
  buffer_store_dwordx4 v[12:15], v82, s[48:51], s55 offen sc1
  s_barrier
  v_mov_b32 v30, 0x7d0
  s_cmp_lg_u32 s52, 0
  s_cbranch_scc1 L_w0_809
  s_mov_b64 exec, 0x1
  buffer_store_dword v30, v1, s[48:51], s93 offen
  s_mov_b64 exec, -1
L_w0_809:
  v_and_b32 v30, 31, v1
  v_lshl_add_u32 v30, v30, 2, s92
  s_mov_b32 s57, 60
  s_mov_b32 s95, 1
L_hd_808:
  buffer_load_dword v31, v30, s[48:51], 0 offen sc1
  s_waitcnt vmcnt(0)
  v_cmp_gt_i32 vcc, 0x7d0, v31
  s_cbranch_vccz L_hd_808_ok
  s_sub_u32 s57, s57, 1
  s_cmp_gt_i32 s57, 0
  s_cbranch_scc1 L_hd_808
  s_mov_b32 s95, 0
L_hd_808_ok:
  s_cmp_eq_u32 s98, 1
  s_cbranch_scc1 L_mls_810
  v_lshlrev_b32 v26, 4, v1
  v_lshrrev_b32 v27, 2, v1
  v_lshlrev_b32 v27, 4, v27
  s_lshl_b32 s55, s52, 8
  v_add_u32 v27, s55, v27
  s_lshl_b32 s66, s53, 12
  s_lshr_b32 s55, s54, 3
  s_lshl_b32 s55, s55, 10
  s_add_u32 s66, s66, s55
  s_add_u32 s66, s66, 0x29c000
  buffer_load_dwordx4 v[80:83], v26, s[48:51], s66 offen sc1
  buffer_load_dwordx4 v[84:87], v27, s[48:51], s66 offen sc1
  s_waitcnt vmcnt(0)
  v_max3_u32 v28, v80, v81, v82
  v_max3_u32 v28, v28, v83, v84
  v_max3_u32 v28, v28, v85, v86
  v_max_u32 v28, v28, v87
  v_cmp_eq_u32 vcc, -1, v28
  s_cbranch_vccz L_ml_811_ok
  s_mov_b64 s[76:77], -1
  s_mov_b64 s[78:79], -1
L_ml_811:
  s_mov_b64 exec, s[76:77]
  s_cbranch_execz L_ml_811_c0
  v_max3_u32 v28, v80, v81, v82
  v_max_u32 v28, v28, v83
  v_cmp_eq_u32 vcc, -1, v28
  s_mov_b64 s[76:77], vcc
L_ml_811_c0:
  s_mov_b64 exec, s[78:79]
  s_cbranch_execz L_ml_811_c1
  v_max3_u32 v28, v84, v85, v86
  v_max_u32 v28, v28, v87
  v_cmp_eq_u32 vcc, -1, v28
  s_mov_b64 s[78:79], vcc
L_ml_811_c1:
  s_mov_b64 s[60:61], s[76:77]
  s_or_b64 s[60:61], s[60:61], s[78:79]
  s_cmp_eq_u64 s[60:61], 0
  s_cbranch_scc1 L_ml_811_x
  s_mov_b64 exec, s[76:77]
  s_cbranch_execz L_ml_811_l0
  buffer_load_dwordx4 v[80:83], v26, s[48:51], s66 offen sc1
L_ml_811_l0:
  s_mov_b64 exec, s[78:79]
  s_cbranch_execz L_ml_811_l1
  buffer_load_dwordx4 v[84:87], v27, s[48:51], s66 offen sc1
L_ml_811_l1:
  s_waitcnt vmcnt(0)
  s_sub_u32 s58, s58, 1
  s_cmp_gt_i32 s58, 0
  s_cbranch_scc1 L_ml_811
L_ml_811_x:
  s_mov_b64 exec, -1
L_ml_811_ok:
  v_max_f32 v28, v80, v82
  s_nop 1
  v_max_f32_dpp v28, v28, v28 row_ror:8 row_mask:0xf bank_mask:0xf
  s_nop 1
  v_max_f32_dpp v28, v28, v28 row_ror:4 row_mask:0xf bank_mask:0xf
  s_nop 1
  v_max_f32_dpp v28, v28, v28 row_ror:2 row_mask:0xf bank_mask:0xf
  s_nop 1
  v_max_f32_dpp v28, v28, v28 row_ror:1 row_mask:0xf bank_mask:0xf
  v_mov_b32 v30, v28
  s_nop 1
  v_permlane32_swap_b32 v28, v30
  s_nop 0
  v_max_f32 v28, v28, v30
  v_mov_b32 v30, v28
  s_nop 1
  v_permlane16_swap_b32 v28, v30
  s_nop 0
  v_max_f32 v28, v28, v30
  v_mul_f32 v28, s96, v28
  v_fma_f32 v80, v80, s96, -v28
  v_fma_f32 v82, v82, s96, -v28
  v_fma_f32 v84, v84, s96, -v28
  v_fma_f32 v86, v86, s96, -v28
  v_exp_f32 v80, v80
  v_exp_f32 v82, v82
  v_exp_f32 v84, v84
  v_exp_f32 v86, v86
  s_nop 0
  v_mul_f32 v29, v80, v81
  v_fmac_f32 v29, v82, v83
  s_nop 1
  v_add_f32_dpp v29, v29, v29 row_ror:8 row_mask:0xf bank_mask:0xf
  s_nop 1
  v_add_f32_dpp v29, v29, v29 row_ror:4 row_mask:0xf bank_mask:0xf
  s_nop 1
  v_add_f32_dpp v29, v29, v29 row_ror:2 row_mask:0xf bank_mask:0xf
  s_nop 1
  v_add_f32_dpp v29, v29, v29 row_ror:1 row_mask:0xf bank_mask:0xf
  v_mov_b32 v30, v29
  s_nop 1
  v_permlane32_swap_b32 v29, v30
  s_nop 0
  v_add_f32 v29, v29, v30
  v_mov_b32 v30, v29
  s_nop 1
  v_permlane16_swap_b32 v29, v30
  s_nop 0
  v_add_f32 v29, v29, v30
  v_rcp_f32 v29, v29
  s_nop 0
  v_mul_f32 v80, v84, v29
  v_mul_f32 v81, v86, v29
L_mls_810:
  v_lshrrev_b32 v26, 2, v1
  v_lshlrev_b32 v26, 7, v26
  v_and_b32 v27, 3, v1
  v_lshlrev_b32 v27, 4, v27
  v_add_u32 v26, v26, v27
  s_lshl_b32 s65, s53, 5
  s_add_u32 s65, s65, s54
  s_lshl_b32 s65, s65, 13
  s_lshl_b32 s55, s52, 11
  s_add_u32 s65, s65, s55
  s_add_u32 s65, s65, 0x2c8000
  s_lshl_b32 s97, s53, 13
  s_add_u32 s97, s97, s55
  s_lshl_b32 s56, s54, 6
  s_add_u32 s97, s97, s56
  s_add_u32 s97, s97, 0x282000
  s_sleep 2
  buffer_load_dwordx4 v[32:35], v26, s[48:51], s65 offen sc1
  buffer_load_dwordx4 v[36:39], v26, s[48:51], s65 offen offset:64 sc1
  s_waitcnt vmcnt(0)
  v_max3_u32 v28, v32, v33, v34
  v_max3_u32 v28, v28, v35, v36
  v_max3_u32 v28, v28, v37, v38
  v_max_u32 v28, v28, v39
  v_cmp_eq_u32 vcc, -1, v28
  s_cbranch_vccz L_a1_812_ok
  s_mov_b64 s[76:77], -1
  s_mov_b64 s[78:79], -1
L_a1_812:
  s_mov_b64 exec, s[76:77]
  s_cbranch_execz L_a1_812_c0
  v_max3_u32 v28, v32, v33, v34
  v_max_u32 v28, v28, v35
  v_cmp_eq_u32 vcc, -1, v28
  s_mov_b64 s[76:77], vcc
L_a1_812_c0:
  s_mov_b64 exec, s[78:79]
  s_cbranch_execz L_a1_812_c1
  v_max3_u32 v28, v36, v37, v38
  v_max_u32 v28, v28, v39
  v_cmp_eq_u32 vcc, -1, v28
  s_mov_b64 s[78:79], vcc
L_a1_812_c1:
  s_mov_b64 s[60:61], s[76:77]
  s_or_b64 s[60:61], s[60:61], s[78:79]
  s_cmp_eq_u64 s[60:61], 0
  s_cbranch_scc1 L_a1_812_x
  s_mov_b64 exec, s[76:77]
  s_cbranch_execz L_a1_812_l0
  buffer_load_dwordx4 v[32:35], v26, s[48:51], s65 offen sc1
L_a1_812_l0:
  s_mov_b64 exec, s[78:79]
  s_cbranch_execz L_a1_812_l1
  buffer_load_dwordx4 v[36:39], v26, s[48:51], s65 offen offset:64 sc1
L_a1_812_l1:
  s_waitcnt vmcnt(0)
  s_sub_u32 s58, s58, 1
  s_cmp_gt_i32 s58, 0
  s_cbranch_scc1 L_a1_812
L_a1_812_x:
  s_mov_b64 exec, -1
L_a1_812_ok:
  v_mul_f32 v32, v80, v32
  v_mul_f32 v33, v80, v33
  v_mul_f32 v34, v80, v34
  v_mul_f32 v35, v80, v35
  v_fmac_f32 v32, v81, v36
  v_fmac_f32 v33, v81, v37
  v_fmac_f32 v34, v81, v38
  v_fmac_f32 v35, v81, v39
  v_add_f32_dpp v32, v32, v32 row_ror:8 row_mask:0xf bank_mask:0xf
  v_add_f32_dpp v33, v33, v33 row_ror:8 row_mask:0xf bank_mask:0xf
  v_add_f32_dpp v34, v34, v34 row_ror:8 row_mask:0xf bank_mask:0xf
  v_add_f32_dpp v35, v35, v35 row_ror:8 row_mask:0xf bank_mask:0xf
  v_add_f32_dpp v32, v32, v32 row_ror:4 row_mask:0xf bank_mask:0xf
  v_add_f32_dpp v33, v33, v33 row_ror:4 row_mask:0xf bank_mask:0xf
  v_add_f32_dpp v34, v34, v34 row_ror:4 row_mask:0xf bank_mask:0xf
  v_add_f32_dpp v35, v35, v35 row_ror:4 row_mask:0xf bank_mask:0xf
  v_mov_b32 v36, v32
  v_mov_b32 v37, v33
  v_mov_b32 v38, v34
  v_mov_b32 v39, v35
  v_permlane32_swap_b32 v32, v36
  v_permlane32_swap_b32 v33, v37
  v_permlane32_swap_b32 v34, v38
  v_permlane32_swap_b32 v35, v39
  v_add_f32 v32, v32, v36
  v_add_f32 v33, v33, v37
  v_add_f32 v34, v34, v38
  v_add_f32 v35, v35, v39
  v_mov_b32 v36, v32
  v_mov_b32 v37, v33
  v_mov_b32 v38, v34
  v_mov_b32 v39, v35
  v_permlane16_swap_b32 v32, v36
  v_permlane16_swap_b32 v33, v37
  v_permlane16_swap_b32 v34, v38
  v_permlane16_swap_b32 v35, v39
  v_add_f32 v32, v32, v36
  v_add_f32 v33, v33, v37
  v_add_f32 v34, v34, v38
  v_add_f32 v35, v35, v39
  v_min_u32 v32, -2, v32
  v_min_u32 v33, -2, v33
  v_min_u32 v34, -2, v34
  v_min_u32 v35, -2, v35
  s_mov_b64 exec, 0xf
  s_add_u32 s55, s97, 0x36000
  buffer_store_dwordx4 v[32:35], v27, s[48:51], s55 offen
  s_mov_b32 s74, s97
  s_mov_b64 exec, -1
  v_lshrrev_b32 v30, 1, v1
  v_lshlrev_b32 v30, 4, v30
  s_lshl_b32 s65, s53, 13
  s_lshl_b32 s56, s52, 9
  s_add_u32 s65, s65, s56
  s_add_u32 s65, s65, 0x282000
  s_add_u32 s66, s65, 4096
  v_and_b32 v28, 1, v1
  v_lshlrev_b32 v28, 5, v28
  v_lshrrev_b32 v29, 4, v1
  v_lshl_add_u32 v28, v29, 3, v28
  s_lshl_b32 s55, s52, 6
  v_add_u32 v28, s55, v28
  v_and_b32 v29, 7, v1
  v_lshlrev_b32 v29, 3, v29
  s_lshl_b32 s97, s53, 11
  s_lshl_b32 s56, s54, 6
  s_add_u32 s97, s97, s56
  s_add_u32 s97, s97, 0x292000
  s_add_u32 s72, s65, 0x36000
  s_add_u32 s73, s66, 0x36000
  s_cmp_eq_u32 s95, 0
  s_cbranch_scc1 L_ob_813_g
  s_mov_b32 s57, 40
L_ob_813_l:
  buffer_load_dwordx4 v[8:11], v30, s[48:51], s72 offen offset:0 sc1
  buffer_load_dwordx4 v[12:15], v30, s[48:51], s72 offen offset:2048 sc1
  buffer_load_dwordx4 v[80:83], v30, s[48:51], s73 offen offset:0 sc1
  buffer_load_dwordx4 v[84:87], v30, s[48:51], s73 offen offset:2048 sc1
  s_waitcnt vmcnt(0)
  v_max3_u32 v26, v8, v9, v10
  v_max3_u32 v26, v26, v11, v12
  v_max3_u32 v26, v26, v13, v14
  v_max3_u32 v26, v26, v15, v80
  v_max3_u32 v26, v26, v81, v82
  v_max3_u32 v26, v26, v83, v84
  v_max3_u32 v26, v26, v85, v86
  v_max_u32 v26, v26, v87
  v_cmp_eq_u32 vcc, -1, v26
  s_cbranch_vccz L_ob_813_lok
  s_sub_u32 s57, s57, 1
  s_cmp_gt_i32 s57, 0
  s_cbranch_scc1 L_ob_813_l
L_ob_813_g:
  s_mov_b64 exec, 0xf
  buffer_store_dwordx4 v[32:35], v27, s[48:51], s74 offen sc1
  s_mov_b64 exec, -1
  s_sleep 14
  buffer_load_dwordx4 v[8:11], v30, s[48:51], s65 offen offset:0 sc1
  buffer_load_dwordx4 v[12:15], v30, s[48:51], s65 offen offset:2048 sc1
  buffer_load_dwordx4 v[80:83], v30, s[48:51], s66 offen offset:0 sc1
  buffer_load_dwordx4 v[84:87], v30, s[48:51], s66 offen offset:2048 sc1
  s_waitcnt vmcnt(0)
  v_max3_u32 v26, v8, v9, v10
  v_max3_u32 v26, v26, v11, v12
  v_max3_u32 v26, v26, v13, v14
  v_max3_u32 v26, v26, v15, v80
  v_max3_u32 v26, v26, v81, v82
  v_max3_u32 v26, v26, v83, v84
  v_max3_u32 v26, v26, v85, v86
  v_max_u32 v26, v26, v87
  v_cmp_eq_u32 vcc, -1, v26
  s_cbranch_vccz L_ob_813_ok
  s_mov_b64 s[76:77], -1
  s_mov_b64 s[78:79], -1
  s_mov_b64 s[80:81], -1
  s_mov_b64 s[82:83], -1
L_ob_813:
  s_mov_b64 exec, s[76:77]
  s_cbranch_execz L_ob_813_c0
  v_max3_u32 v26, v8, v9, v10
  v_max_u32 v26, v26, v11
  v_cmp_eq_u32 vcc, -1, v26
  s_mov_b64 s[76:77], vcc
L_ob_813_c0:
  s_mov_b64 exec, s[78:79]
  s_cbranch_execz L_ob_813_c1
  v_max3_u32 v26, v12, v13, v14
  v_max_u32 v26, v26, v15
  v_cmp_eq_u32 vcc, -1, v26
  s_mov_b64 s[78:79], vcc
L_ob_813_c1:
  s_mov_b64 exec, s[80:81]
  s_cbranch_execz L_ob_813_c2
  v_max3_u32 v26, v80, v81, v82
  v_max_u32 v26, v26, v83
  v_cmp_eq_u32 vcc, -1, v26
  s_mov_b64 s[80:81], vcc
L_ob_813_c2:
  s_mov_b64 exec, s[82:83]
  s_cbranch_execz L_ob_813_c3
  v_max3_u32 v26, v84, v85, v86
  v_max_u32 v26, v26, v87
  v_cmp_eq_u32 vcc, -1, v26
  s_mov_b64 s[82:83], vcc
L_ob_813_c3:
  s_mov_b64 s[60:61], s[76:77]
  s_or_b64 s[60:61], s[60:61], s[78:79]
  s_or_b64 s[60:61], s[60:61], s[80:81]
  s_or_b64 s[60:61], s[60:61], s[82:83]
  s_cmp_eq_u64 s[60:61], 0
  s_cbranch_scc1 L_ob_813_x
  s_mov_b64 exec, s[76:77]
  s_cbranch_execz L_ob_813_l0
  buffer_load_dwordx4 v[8:11], v30, s[48:51], s65 offen offset:0 sc1
L_ob_813_l0:
  s_mov_b64 exec, s[78:79]
  s_cbranch_execz L_ob_813_l1
  buffer_load_dwordx4 v[12:15], v30, s[48:51], s65 offen offset:2048 sc1
L_ob_813_l1:
  s_mov_b64 exec, s[80:81]
  s_cbranch_execz L_ob_813_l2
  buffer_load_dwordx4 v[80:83], v30, s[48:51], s66 offen offset:0 sc1
L_ob_813_l2:
  s_mov_b64 exec, s[82:83]
  s_cbranch_execz L_ob_813_l3
  buffer_load_dwordx4 v[84:87], v30, s[48:51], s66 offen offset:2048 sc1
L_ob_813_l3:
  s_waitcnt vmcnt(0)
  s_sub_u32 s58, s58, 1
  s_cmp_gt_i32 s58, 0
  s_cbranch_scc1 L_ob_813
L_ob_813_x:
  s_mov_b64 exec, -1
  s_branch L_ob_813_ok
L_ob_813_lok:
  s_mov_b64 exec, 0xf
  buffer_store_dwordx4 v[32:35], v27, s[48:51], s74 offen sc1
  s_mov_b64 exec, -1
L_ob_813_ok:
  v_pk_add_f32 v[8:9], v[8:9], v[12:13]
  v_pk_add_f32 v[80:81], v[80:81], v[84:85]
  v_pk_add_f32 v[10:11], v[10:11], v[14:15]
  v_pk_add_f32 v[82:83], v[82:83], v[86:87]
  v_pk_add_f32 v[8:9], v[8:9], v[80:81]
  v_pk_add_f32 v[10:11], v[10:11], v[82:83]
  v_cvt_pk_bf16_f32 v26, v8, v9
  v_lshlrev_b32 v16, 16, v26
  v_and_b32 v17, 0xffff0000, v26
  v_cvt_pk_bf16_f32 v26, v10, v11
  v_lshlrev_b32 v18, 16, v26
  v_and_b32 v19, 0xffff0000, v26
  v_lshrrev_b32 v80, 16, v16
  v_lshrrev_b32 v81, 16, v17
  v_lshrrev_b32 v82, 16, v18
  v_lshrrev_b32 v83, 16, v19
  v_dot2_f32_bf16 v8, v104, v80, 0
  v_dot2_f32_bf16 v9, v104, v16, 0
  v_dot2_f32_bf16 v10, v105, v80, 0
  v_dot2_f32_bf16 v11, v105, v16, 0
  v_dot2_f32_bf16 v12, v106, v80, 0
  v_dot2_f32_bf16 v13, v106, v16, 0
  v_dot2_f32_bf16 v14, v107, v80, 0
  v_dot2_f32_bf16 v15, v107, v16, 0
  v_dot2c_f32_bf16 v8, v108, v81
  v_dot2c_f32_bf16 v9, v108, v17
  v_dot2c_f32_bf16 v10, v109, v81
  v_dot2c_f32_bf16 v11, v109, v17
  v_dot2c_f32_bf16 v12, v110, v81
  v_dot2c_f32_bf16 v13, v110, v17
  v_dot2c_f32_bf16 v14, v111, v81
  v_dot2c_f32_bf16 v15, v111, v17
  v_dot2c_f32_bf16 v8, v112, v82
  v_dot2c_f32_bf16 v9, v112, v18
  v_dot2c_f32_bf16 v10, v113, v82
  v_dot2c_f32_bf16 v11, v113, v18
  v_dot2c_f32_bf16 v12, v114, v82
  v_dot2c_f32_bf16 v13, v114, v18
  v_dot2c_f32_bf16 v14, v115, v82
  v_dot2c_f32_bf16 v15, v115, v18
  v_dot2c_f32_bf16 v8, v116, v83
  v_dot2c_f32_bf16 v9, v116, v19
  v_dot2c_f32_bf16 v10, v117, v83
  v_dot2c_f32_bf16 v11, v117, v19
  v_dot2c_f32_bf16 v12, v118, v83
  v_dot2c_f32_bf16 v13, v118, v19
  v_dot2c_f32_bf16 v14, v119, v83
  v_dot2c_f32_bf16 v15, v119, v19
  s_nop 2
  v_permlane32_swap_b32 v8, v12
  v_permlane32_swap_b32 v9, v13
  v_permlane32_swap_b32 v10, v14
  v_permlane32_swap_b32 v11, v15
  s_nop 0
  v_add_f32 v8, v8, v12
  v_add_f32 v9, v9, v13
  v_add_f32 v10, v10, v14
  v_add_f32 v11, v11, v15
  s_nop 0
  v_permlane16_swap_b32 v8, v10
  v_permlane16_swap_b32 v9, v11
  s_nop 0
  v_add_f32 v8, v8, v10
  v_add_f32 v9, v9, v11
  s_nop 0
  v_add_f32_dpp v8, v8, v8 row_ror:8 row_mask:0xf bank_mask:0xf
  v_add_f32_dpp v9, v9, v9 row_ror:8 row_mask:0xf bank_mask:0xf
  s_nop 0
  v_add_f32_dpp v8, v8, v8 row_ror:4 row_mask:0xf bank_mask:0xf
  v_add_f32_dpp v9, v9, v9 row_ror:4 row_mask:0xf bank_mask:0xf
  s_nop 0
  v_add_f32_dpp v8, v8, v8 row_ror:2 row_mask:0xf bank_mask:0xf
  v_add_f32_dpp v9, v9, v9 row_ror:2 row_mask:0xf bank_mask:0xf
  ds_write_b64 v28, v[8:9] offset:2304
  s_waitcnt lgkmcnt(0)
  s_barrier
  ds_read_b64 v[8:9], v29 offset:2304
  ds_read_b64 v[10:11], v29 offset:2368
  ds_read_b64 v[12:13], v29 offset:2432
  ds_read_b64 v[14:15], v29 offset:2496
  s_waitcnt lgkmcnt(0)
  v_pk_add_f32 v[8:9], v[8:9], v[10:11]
  v_pk_add_f32 v[12:13], v[12:13], v[14:15]
  v_pk_add_f32 v[80:81], v[8:9], v[12:13]
  v_min_u32 v80, -2, v80
  v_min_u32 v81, -2, v81
  s_cmp_lg_u32 s52, 0
  s_cbranch_scc1 L_w0_814
  s_mov_b64 exec, 0xff
  buffer_store_dwordx2 v[80:81], v29, s[48:51], s97 offen sc1
  s_mov_b64 exec, -1
L_w0_814:
  v_lshlrev_b32 v30, 3, v0
  s_mov_b32 s72, 0x292000
  s_mov_b32 s73, 0x293000
  s_mov_b32 s74, 0x294000
  s_mov_b32 s75, 0x295000
  s_sleep 16
  buffer_load_dwordx2 v[8:9], v30, s[48:51], s72 offen offset:0 sc1
  buffer_load_dwordx2 v[10:11], v30, s[48:51], s72 offen offset:2048 sc1
  buffer_load_dwordx2 v[12:13], v30, s[48:51], s73 offen offset:0 sc1
  buffer_load_dwordx2 v[14:15], v30, s[48:51], s73 offen offset:2048 sc1
  buffer_load_dwordx2 v[80:81], v30, s[48:51], s74 offen offset:0 sc1
  buffer_load_dwordx2 v[82:83], v30, s[48:51], s74 offen offset:2048 sc1
  buffer_load_dwordx2 v[84:85], v30, s[48:51], s75 offen offset:0 sc1
  buffer_load_dwordx2 v[86:87], v30, s[48:51], s75 offen offset:2048 sc1
  s_waitcnt vmcnt(0)
  v_max3_u32 v26, v8, v9, v10
  v_max3_u32 v26, v26, v11, v12
  v_max3_u32 v26, v26, v13, v14
  v_max3_u32 v26, v26, v15, v80
  v_max3_u32 v26, v26, v81, v82
  v_max3_u32 v26, v26, v83, v84
  v_max3_u32 v26, v26, v85, v86
  v_max_u32 v26, v26, v87
  v_cmp_eq_u32 vcc, -1, v26
  s_cbranch_vccz L_xg_815_ok
  s_mov_b64 s[76:77], -1
  s_mov_b64 s[78:79], -1
  s_mov_b64 s[80:81], -1
  s_mov_b64 s[82:83], -1
  s_mov_b64 s[84:85], -1
  s_mov_b64 s[86:87], -1
  s_mov_b64 s[88:89], -1
  s_mov_b64 s[90:91], -1
L_xg_815:
  s_mov_b64 exec, s[76:77]
  s_cbranch_execz L_xg_815_c0
  v_max_u32 v26, v8, v9
  v_cmp_eq_u32 vcc, -1, v26
  s_mov_b64 s[76:77], vcc
L_xg_815_c0:
  s_mov_b64 exec, s[78:79]
  s_cbranch_execz L_xg_815_c1
  v_max_u32 v26, v10, v11
  v_cmp_eq_u32 vcc, -1, v26
  s_mov_b64 s[78:79], vcc
L_xg_815_c1:
  s_mov_b64 exec, s[80:81]
  s_cbranch_execz L_xg_815_c2
  v_max_u32 v26, v12, v13
  v_cmp_eq_u32 vcc, -1, v26
  s_mov_b64 s[80:81], vcc
L_xg_815_c2:
  s_mov_b64 exec, s[82:83]
  s_cbranch_execz L_xg_815_c3
  v_max_u32 v26, v14, v15
  v_cmp_eq_u32 vcc, -1, v26
  s_mov_b64 s[82:83], vcc
L_xg_815_c3:
  s_mov_b64 exec, s[84:85]
  s_cbranch_execz L_xg_815_c4
  v_max_u32 v26, v80, v81
  v_cmp_eq_u32 vcc, -1, v26
  s_mov_b64 s[84:85], vcc
L_xg_815_c4:
  s_mov_b64 exec, s[86:87]
  s_cbranch_execz L_xg_815_c5
  v_max_u32 v26, v82, v83
  v_cmp_eq_u32 vcc, -1, v26
  s_mov_b64 s[86:87], vcc
L_xg_815_c5:
  s_mov_b64 exec, s[88:89]
  s_cbranch_execz L_xg_815_c6
  v_max_u32 v26, v84, v85
  v_cmp_eq_u32 vcc, -1, v26
  s_mov_b64 s[88:89], vcc
L_xg_815_c6:
  s_mov_b64 exec, s[90:91]
  s_cbranch_execz L_xg_815_c7
  v_max_u32 v26, v86, v87
  v_cmp_eq_u32 vcc, -1, v26
  s_mov_b64 s[90:91], vcc
L_xg_815_c7:
  s_mov_b64 s[60:61], s[76:77]
  s_or_b64 s[60:61], s[60:61], s[78:79]
  s_or_b64 s[60:61], s[60:61], s[80:81]
  s_or_b64 s[60:61], s[60:61], s[82:83]
  s_or_b64 s[60:61], s[60:61], s[84:85]
  s_or_b64 s[60:61], s[60:61], s[86:87]
  s_or_b64 s[60:61], s[60:61], s[88:89]
  s_or_b64 s[60:61], s[60:61], s[90:91]
  s_cmp_eq_u64 s[60:61], 0
  s_cbranch_scc1 L_xg_815_x
  s_mov_b64 exec, s[76:77]
  s_cbranch_execz L_xg_815_l0
  buffer_load_dwordx2 v[8:9], v30, s[48:51], s72 offen offset:0 sc1
L_xg_815_l0:
  s_mov_b64 exec, s[78:79]
  s_cbranch_execz L_xg_815_l1
  buffer_load_dwordx2 v[10:11], v30, s[48:51], s72 offen offset:2048 sc1
L_xg_815_l1:
  s_mov_b64 exec, s[80:81]
  s_cbranch_execz L_xg_815_l2
  buffer_load_dwordx2 v[12:13], v30, s[48:51], s73 offen offset:0 sc1
L_xg_815_l2:
  s_mov_b64 exec, s[82:83]
  s_cbranch_execz L_xg_815_l3
  buffer_load_dwordx2 v[14:15], v30, s[48:51], s73 offen offset:2048 sc1
L_xg_815_l3:
  s_mov_b64 exec, s[84:85]
  s_cbranch_execz L_xg_815_l4
  buffer_load_dwordx2 v[80:81], v30, s[48:51], s74 offen offset:0 sc1
L_xg_815_l4:
  s_mov_b64 exec, s[86:87]
  s_cbranch_execz L_xg_815_l5
  buffer_load_dwordx2 v[82:83], v30, s[48:51], s74 offen offset:2048 sc1
L_xg_815_l5:
  s_mov_b64 exec, s[88:89]
  s_cbranch_execz L_xg_815_l6
  buffer_load_dwordx2 v[84:85], v30, s[48:51], s75 offen offset:0 sc1
L_xg_815_l6:
  s_mov_b64 exec, s[90:91]
  s_cbranch_execz L_xg_815_l7
  buffer_load_dwordx2 v[86:87], v30, s[48:51], s75 offen offset:2048 sc1
L_xg_815_l7:
  s_waitcnt vmcnt(0)
  s_sub_u32 s58, s58, 1
  s_cmp_gt_i32 s58, 0
  s_cbranch_scc1 L_xg_815
L_xg_815_x:
  s_mov_b64 exec, -1
L_xg_815_ok:
  v_pk_add_f32 v[8:9], v[8:9], v[10:11]
  v_pk_add_f32 v[12:13], v[12:13], v[14:15]
  v_pk_add_f32 v[80:81], v[80:81], v[82:83]
  v_pk_add_f32 v[84:85], v[84:85], v[86:87]
  v_pk_add_f32 v[8:9], v[8:9], v[12:13]
  v_pk_add_f32 v[80:81], v[80:81], v[84:85]
  v_pk_add_f32 v[8:9], v[8:9], v[80:81]
  v_cvt_pk_bf16_f32 v26, v8, v9
  v_lshlrev_b32 v8, 16, v26
  v_and_b32 v9, 0xffff0000, v26
  v_pk_add_f32 v[22:23], v[22:23], v[8:9]
  v_cvt_pk_bf16_f32 v26, v22, v23
  v_lshlrev_b32 v22, 16, v26
  v_and_b32 v23, 0xffff0000, v26
  v_lshlrev_b32 v30, 3, v0
  ds_write_b64 v30, v[22:23] offset:0
  v_subrev_f32 v26, s70, v22
  v_subrev_f32 v27, s70, v23
  v_add_f32 v28, v26, v27
  v_mul_f32 v29, v26, v26
  v_fmac_f32 v29, v27, v27
  v_lshrrev_b32 v30, 4, v0
  v_lshlrev_b32 v30, 3, v30
  s_nop 0
  v_add_f32_dpp v28, v28, v28 row_ror:8 row_mask:0xf bank_mask:0xf
  v_add_f32_dpp v29, v29, v29 row_ror:8 row_mask:0xf bank_mask:0xf
  s_nop 0
  v_add_f32_dpp v28, v28, v28 row_ror:4 row_mask:0xf bank_mask:0xf
  v_add_f32_dpp v29, v29, v29 row_ror:4 row_mask:0xf bank_mask:0xf
  s_nop 0
  v_add_f32_dpp v28, v28, v28 row_ror:2 row_mask:0xf bank_mask:0xf
  v_add_f32_dpp v29, v29, v29 row_ror:2 row_mask:0xf bank_mask:0xf
  s_nop 0
  v_add_f32_dpp v28, v28, v28 row_ror:1 row_mask:0xf bank_mask:0xf
  v_add_f32_dpp v29, v29, v29 row_ror:1 row_mask:0xf bank_mask:0xf
  ds_write_b64 v30, v[28:29] offset:2944
  s_waitcnt lgkmcnt(0)
  s_barrier
  v_and_b32 v26, 15, v1
  v_lshlrev_b32 v26, 3, v26
  ds_read_b64 v[80:81], v26 offset:2944
  v_lshrrev_b32 v27, 2, v1
  v_lshlrev_b32 v27, 3, v27
  s_lshl_b32 s55, s100, 2
  s_add_u32 s55, s55, s52
  s_lshl_b32 s55, s55, 7
  v_add_u32 v27, s55, v27
  ds_read_b64 v[16:17], v27 offset:0
  v_lshrrev_b32 v28, 5, v1
  v_lshlrev_b32 v28, 7, v28
  v_and_b32 v29, 3, v1
  v_lshl_add_u32 v28, v29, 5, v28
  v_bfe_u32 v29, v1, 4, 1
  v_lshl_add_u32 v28, v29, 4, v28
  s_lshl_b32 s55, s52, 8
  v_add_u32 v28, s55, v28
  v_and_b32 v29, 1, v1
  v_lshlrev_b32 v29, 7, v29
  v_lshrrev_b32 v30, 1, v1
  v_lshl_add_u32 v29, v30, 2, v29
  v_lshlrev_b32 v31, 2, v1
  s_mul_i32 s97, s100, 14336
  s_lshl_b32 s55, s62, 8
  s_add_u32 s97, s97, s55
  s_add_u32 s97, s97, 0x2a4000
  s_waitcnt lgkmcnt(0)
  s_nop 0
  v_add_f32_dpp v80, v80, v80 row_ror:8 row_mask:0xf bank_mask:0xf
  v_add_f32_dpp v81, v81, v81 row_ror:8 row_mask:0xf bank_mask:0xf
  s_nop 0
  v_add_f32_dpp v80, v80, v80 row_ror:4 row_mask:0xf bank_mask:0xf
  v_add_f32_dpp v81, v81, v81 row_ror:4 row_mask:0xf bank_mask:0xf
  s_nop 0
  v_add_f32_dpp v80, v80, v80 row_ror:2 row_mask:0xf bank_mask:0xf
  v_add_f32_dpp v81, v81, v81 row_ror:2 row_mask:0xf bank_mask:0xf
  s_nop 0
  v_add_f32_dpp v80, v80, v80 row_ror:1 row_mask:0xf bank_mask:0xf
  v_add_f32_dpp v81, v81, v81 row_ror:1 row_mask:0xf bank_mask:0xf
  v_mul_f32 v80, 0x3b000000, v80
  v_mul_f32 v81, 0x3b000000, v81
  v_fma_f32 v81, -v80, v80, v81
  v_max_f32 v81, 0, v81
  v_add_f32 v80, s70, v80
  v_cvt_pk_bf16_f32 v82, v80, v81
  v_lshlrev_b32 v80, 16, v82
  v_and_b32 v81, 0xffff0000, v82
  v_add_f32 v81, 0x3727c5ac, v81
  v_cvt_pk_bf16_f32 v82, v81, v81
  v_lshlrev_b32 v81, 16, v82
  v_sqrt_f32 v81, v81
  v_sub_f32 v16, v16, v80
  v_sub_f32 v17, v17, v80
  v_cvt_pk_bf16_f32 v82, v81, v81
  v_lshlrev_b32 v81, 16, v82
  v_rcp_f32 v81, v81
  v_cvt_pk_bf16_f32 v82, v16, v17
  v_lshlrev_b32 v16, 16, v82
  v_and_b32 v17, 0xffff0000, v82
  v_mul_f32 v16, v16, v81
  v_mul_f32 v17, v17, v81
  v_cvt_pk_bf16_f32 v82, v16, v17
  v_lshlrev_b32 v16, 16, v82
  v_and_b32 v17, 0xffff0000, v82
  v_lshrrev_b32 v18, 16, v16
  v_lshrrev_b32 v19, 16, v17
  v_dot2_f32_bf16 v32, v120, v18, 0
  v_dot2_f32_bf16 v33, v120, v16, 0
  v_dot2_f32_bf16 v34, v121, v18, 0
  v_dot2_f32_bf16 v35, v121, v16, 0
  v_dot2_f32_bf16 v36, v122, v18, 0
  v_dot2_f32_bf16 v37, v122, v16, 0
  v_dot2_f32_bf16 v38, v123, v18, 0
  v_dot2_f32_bf16 v39, v123, v16, 0
  v_dot2c_f32_bf16 v32, v124, v19
  v_dot2c_f32_bf16 v33, v124, v17
  v_dot2c_f32_bf16 v34, v125, v19
  v_dot2c_f32_bf16 v35, v125, v17
  v_dot2c_f32_bf16 v36, v126, v19
  v_dot2c_f32_bf16 v37, v126, v17
  v_dot2c_f32_bf16 v38, v127, v19
  v_dot2c_f32_bf16 v39, v127, v17
  v_lshrrev_b32 v18, 16, v16
  v_lshrrev_b32 v19, 16, v17
  v_dot2_f32_bf16 v8, v128, v18, 0
  v_dot2_f32_bf16 v9, v128, v16, 0
  v_dot2_f32_bf16 v10, v129, v18, 0
  v_dot2_f32_bf16 v11, v129, v16, 0
  v_dot2_f32_bf16 v12, v130, v18, 0
  v_dot2_f32_bf16 v13, v130, v16, 0
  v_dot2_f32_bf16 v14, v131, v18, 0
  v_dot2_f32_bf16 v15, v131, v16, 0
  v_dot2c_f32_bf16 v8, v132, v19
  v_dot2c_f32_bf16 v9, v132, v17
  v_dot2c_f32_bf16 v10, v133, v19
  v_dot2c_f32_bf16 v11, v133, v17
  v_dot2c_f32_bf16 v12, v134, v19
  v_dot2c_f32_bf16 v13, v134, v17
  v_dot2c_f32_bf16 v14, v135, v19
  v_dot2c_f32_bf16 v15, v135, v17
  s_nop 2
  v_permlane32_swap_b32 v32, v8
  v_permlane32_swap_b32 v33, v9
  v_permlane32_swap_b32 v34, v10
  v_permlane32_swap_b32 v35, v11
  v_permlane32_swap_b32 v36, v12
  v_permlane32_swap_b32 v37, v13
  v_permlane32_swap_b32 v38, v14
  v_permlane32_swap_b32 v39, v15
  v_pk_add_f32 v[32:33], v[32:33], v[8:9]
  v_pk_add_f32 v[34:35], v[34:35], v[10:11]
  v_pk_add_f32 v[36:37], v[36:37], v[12:13]
  v_pk_add_f32 v[38:39], v[38:39], v[14:15]
  s_nop 0
  v_permlane16_swap_b32 v32, v36
  v_permlane16_swap_b32 v33, v37
  v_permlane16_swap_b32 v34, v38
  v_permlane16_swap_b32 v35, v39
  s_nop 0
  v_pk_add_f32 v[32:33], v[32:33], v[36:37]
  v_pk_add_f32 v[34:35], v[34:35], v[38:39]
  s_nop 0
  v_add_f32_dpp v32, v32, v32 row_ror:8 row_mask:0xf bank_mask:0xf
  v_add_f32_dpp v33, v33, v33 row_ror:8 row_mask:0xf bank_mask:0xf
  v_add_f32_dpp v34, v34, v34 row_ror:8 row_mask:0xf bank_mask:0xf
  v_add_f32_dpp v35, v35, v35 row_ror:8 row_mask:0xf bank_mask:0xf
  v_add_f32_dpp v32, v32, v32 row_ror:4 row_mask:0xf bank_mask:0xf
  v_add_f32_dpp v33, v33, v33 row_ror:4 row_mask:0xf bank_mask:0xf
  v_add_f32_dpp v34, v34, v34 row_ror:4 row_mask:0xf bank_mask:0xf
  v_add_f32_dpp v35, v35, v35 row_ror:4 row_mask:0xf bank_mask:0xf
  ds_write_b128 v28, v[32:35] offset:3072
  s_waitcnt lgkmcnt(0)
  s_barrier
  ds_read_b32 v8, v29 offset:3072
  ds_read_b32 v9, v29 offset:3328
  ds_read_b32 v10, v29 offset:3584
  ds_read_b32 v11, v29 offset:3840
  s_waitcnt lgkmcnt(0)
  v_pk_add_f32 v[8:9], v[8:9], v[10:11]
  v_add_f32 v8, v8, v9
  v_min_u32 v8, -2, v8
  s_mov_b32 s66, s97
  s_add_u32 s57, s97, 0x22c000
  s_cmp_lg_u32 s52, 0
  s_cbranch_scc1 L_w0_816
  s_cmp_ge_u32 s54, 28
  s_cbranch_scc1 L_w0_816
  buffer_store_dword v8, v31, s[48:51], s57 offen
  s_mov_b64 exec, -1
L_w0_816:
  v_lshrrev_b32 v30, 1, v1
  v_min_u32 v30, 27, v30
  v_lshlrev_b32 v30, 4, v30
  v_add_u32 v27, 0x22c000, v30
  s_mul_i32 s65, s63, 1792
  s_mul_i32 s56, s52, 448
  s_add_u32 s65, s65, s56
  s_add_u32 s72, s65, 0x2a4000
  s_add_u32 s73, s72, 14336
  s_add_u32 s74, s73, 14336
  s_add_u32 s75, s74, 14336
  v_and_b32 v28, 1, v1
  v_lshlrev_b32 v28, 5, v28
  v_lshrrev_b32 v29, 4, v1
  v_lshl_add_u32 v28, v29, 3, v28
  s_lshl_b32 s55, s52, 6
  v_add_u32 v28, s55, v28
  v_and_b32 v29, 7, v1
  v_lshlrev_b32 v29, 3, v29
  s_lshl_b32 s97, s63, 11
  s_lshl_b32 s56, s64, 6
  s_add_u32 s97, s97, s56
  s_add_u32 s97, s97, 0x298000
  s_cmp_eq_u32 s95, 0
  s_cbranch_scc1 L_hb_817_g
  s_mov_b32 s57, 40
L_hb_817_l:
  buffer_load_dwordx4 v[32:35], v27, s[48:51], s72 offen sc1
  buffer_load_dwordx4 v[36:39], v27, s[48:51], s73 offen sc1
  buffer_load_dwordx4 v[80:83], v27, s[48:51], s74 offen sc1
  buffer_load_dwordx4 v[84:87], v27, s[48:51], s75 offen sc1
  s_waitcnt vmcnt(0)
  v_max3_u32 v26, v32, v33, v34
  v_max3_u32 v26, v26, v35, v36
  v_max3_u32 v26, v26, v37, v38
  v_max3_u32 v26, v26, v39, v80
  v_max3_u32 v26, v26, v81, v82
  v_max3_u32 v26, v26, v83, v84
  v_max3_u32 v26, v26, v85, v86
  v_max_u32 v26, v26, v87
  v_cmp_eq_u32 vcc, -1, v26
  s_cbranch_vccz L_hb_817_lok
  s_sub_u32 s57, s57, 1
  s_cmp_gt_i32 s57, 0
  s_cbranch_scc1 L_hb_817_l
L_hb_817_g:
  s_cmp_lg_u32 s52, 0
  s_cbranch_scc1 L_w0_818
  s_cmp_ge_u32 s54, 28
  s_cbranch_scc1 L_w0_818
  buffer_store_dword v8, v31, s[48:51], s66 offen sc1
  s_mov_b64 exec, -1
L_w0_818:
  s_sleep 16
  buffer_load_dwordx4 v[32:35], v30, s[48:51], s72 offen sc1
  buffer_load_dwordx4 v[36:39], v30, s[48:51], s73 offen sc1
  buffer_load_dwordx4 v[80:83], v30, s[48:51], s74 offen sc1
  buffer_load_dwordx4 v[84:87], v30, s[48:51], s75 offen sc1
  s_waitcnt vmcnt(0)
  v_max3_u32 v26, v32, v33, v34
  v_max3_u32 v26, v26, v35, v36
  v_max3_u32 v26, v26, v37, v38
  v_max3_u32 v26, v26, v39, v80
  v_max3_u32 v26, v26, v81, v82
  v_max3_u32 v26, v26, v83, v84
  v_max3_u32 v26, v26, v85, v86
  v_max_u32 v26, v26, v87
  v_cmp_eq_u32 vcc, -1, v26
  s_cbranch_vccz L_hb_817_ok
  s_mov_b64 s[76:77], -1
  s_mov_b64 s[78:79], -1
  s_mov_b64 s[80:81], -1
  s_mov_b64 s[82:83], -1
L_hb_817:
  s_mov_b64 exec, s[76:77]
  s_cbranch_execz L_hb_817_c0
  v_max3_u32 v26, v32, v33, v34
  v_max_u32 v26, v26, v35
  v_cmp_eq_u32 vcc, -1, v26
  s_mov_b64 s[76:77], vcc
L_hb_817_c0:
  s_mov_b64 exec, s[78:79]
  s_cbranch_execz L_hb_817_c1
  v_max3_u32 v26, v36, v37, v38
  v_max_u32 v26, v26, v39
  v_cmp_eq_u32 vcc, -1, v26
  s_mov_b64 s[78:79], vcc
L_hb_817_c1:
  s_mov_b64 exec, s[80:81]
  s_cbranch_execz L_hb_817_c2
  v_max3_u32 v26, v80, v81, v82
  v_max_u32 v26, v26, v83
  v_cmp_eq_u32 vcc, -1, v26
  s_mov_b64 s[80:81], vcc
L_hb_817_c2:
  s_mov_b64 exec, s[82:83]
  s_cbranch_execz L_hb_817_c3
  v_max3_u32 v26, v84, v85, v86
  v_max_u32 v26, v26, v87
  v_cmp_eq_u32 vcc, -1, v26
  s_mov_b64 s[82:83], vcc
L_hb_817_c3:
  s_mov_b64 s[60:61], s[76:77]
  s_or_b64 s[60:61], s[60:61], s[78:79]
  s_or_b64 s[60:61], s[60:61], s[80:81]
  s_or_b64 s[60:61], s[60:61], s[82:83]
  s_cmp_eq_u64 s[60:61], 0
  s_cbranch_scc1 L_hb_817_x
  s_mov_b64 exec, s[76:77]
  s_cbranch_execz L_hb_817_l0
  buffer_load_dwordx4 v[32:35], v30, s[48:51], s72 offen sc1
L_hb_817_l0:
  s_mov_b64 exec, s[78:79]
  s_cbranch_execz L_hb_817_l1
  buffer_load_dwordx4 v[36:39], v30, s[48:51], s73 offen sc1
L_hb_817_l1:
  s_mov_b64 exec, s[80:81]
  s_cbranch_execz L_hb_817_l2
  buffer_load_dwordx4 v[80:83], v30, s[48:51], s74 offen sc1
L_hb_817_l2:
  s_mov_b64 exec, s[82:83]
  s_cbranch_execz L_hb_817_l3
  buffer_load_dwordx4 v[84:87], v30, s[48:51], s75 offen sc1
L_hb_817_l3:
  s_waitcnt vmcnt(0)
  s_sub_u32 s58, s58, 1
  s_cmp_gt_i32 s58, 0
  s_cbranch_scc1 L_hb_817
L_hb_817_x:
  s_mov_b64 exec, -1
  s_branch L_hb_817_ok
L_hb_817_lok:
  s_cmp_lg_u32 s52, 0
  s_cbranch_scc1 L_w0_819
  s_cmp_ge_u32 s54, 28
  s_cbranch_scc1 L_w0_819
  buffer_store_dword v8, v31, s[48:51], s66 offen sc1
  s_mov_b64 exec, -1
L_w0_819:
L_hb_817_ok:
  v_pk_add_f32 v[32:33], v[32:33], v[36:37]
  v_pk_add_f32 v[80:81], v[80:81], v[84:85]
  v_pk_add_f32 v[34:35], v[34:35], v[38:39]
  v_pk_add_f32 v[82:83], v[82:83], v[86:87]
  v_pk_add_f32 v[32:33], v[32:33], v[80:81]
  v_pk_add_f32 v[34:35], v[34:35], v[82:83]
  v_cvt_pk_bf16_f32 v80, v32, v33
  v_cvt_pk_bf16_f32 v81, v34, v35
  v_lshlrev_b32 v32, 16, v80
  v_lshlrev_b32 v34, 16, v81
  v_and_b32 v33, 0xffff0000, v80
  v_and_b32 v35, 0xffff0000, v81
  v_mul_f32 v80, 0xbfb8aa3b, v32
  v_mul_f32 v81, 0xbfb8aa3b, v34
  v_exp_f32 v80, v80
  v_exp_f32 v81, v81
  s_nop 0
  v_add_f32 v80, 1.0, v80
  v_add_f32 v81, 1.0, v81
  v_rcp_f32 v80, v80
  v_rcp_f32 v81, v81
  s_nop 0
  v_mul_f32 v32, v32, v80
  v_mul_f32 v34, v34, v81
  v_cvt_pk_bf16_f32 v80, v32, v34
  v_lshlrev_b32 v32, 16, v80
  v_and_b32 v34, 0xffff0000, v80
  v_mul_f32 v32, v32, v33
  v_mul_f32 v34, v34, v35
  v_cvt_pk_bf16_f32 v80, v32, v34
  v_cmp_gt_u32 vcc, 56, v1
  s_nop 1
  v_cndmask_b32 v80, 0, v80, vcc
  v_lshlrev_b32 v16, 16, v80
  v_and_b32 v17, 0xffff0000, v80
  v_lshrrev_b32 v18, 16, v16
  v_lshrrev_b32 v19, 16, v17
  v_dot2_f32_bf16 v8, v136, v18, 0
  v_dot2_f32_bf16 v9, v136, v16, 0
  v_dot2_f32_bf16 v10, v137, v18, 0
  v_dot2_f32_bf16 v11, v137, v16, 0
  v_dot2_f32_bf16 v12, v138, v18, 0
  v_dot2_f32_bf16 v13, v138, v16, 0
  v_dot2_f32_bf16 v14, v139, v18, 0
  v_dot2_f32_bf16 v15, v139, v16, 0
  v_dot2c_f32_bf16 v8, v140, v19
  v_dot2c_f32_bf16 v9, v140, v17
  v_dot2c_f32_bf16 v10, v141, v19
  v_dot2c_f32_bf16 v11, v141, v17
  v_dot2c_f32_bf16 v12, v142, v19
  v_dot2c_f32_bf16 v13, v142, v17
  v_dot2c_f32_bf16 v14, v143, v19
  v_dot2c_f32_bf16 v15, v143, v17
  s_nop 2
  v_permlane32_swap_b32 v8, v12
  v_permlane32_swap_b32 v9, v13
  v_permlane32_swap_b32 v10, v14
  v_permlane32_swap_b32 v11, v15
  s_nop 0
  v_add_f32 v8, v8, v12
  v_add_f32 v9, v9, v13
  v_add_f32 v10, v10, v14
  v_add_f32 v11, v11, v15
  s_nop 0
  v_permlane16_swap_b32 v8, v10
  v_permlane16_swap_b32 v9, v11
  s_nop 0
  v_add_f32 v8, v8, v10
  v_add_f32 v9, v9, v11
  s_nop 0
  v_add_f32_dpp v8, v8, v8 row_ror:8 row_mask:0xf bank_mask:0xf
  v_add_f32_dpp v9, v9, v9 row_ror:8 row_mask:0xf bank_mask:0xf
  s_nop 0
  v_add_f32_dpp v8, v8, v8 row_ror:4 row_mask:0xf bank_mask:0xf
  v_add_f32_dpp v9, v9, v9 row_ror:4 row_mask:0xf bank_mask:0xf
  s_nop 0
  v_add_f32_dpp v8, v8, v8 row_ror:2 row_mask:0xf bank_mask:0xf
  v_add_f32_dpp v9, v9, v9 row_ror:2 row_mask:0xf bank_mask:0xf
  ds_write_b64 v28, v[8:9] offset:2560
  s_waitcnt lgkmcnt(0)
  s_barrier
  ds_read_b64 v[8:9], v29 offset:2560
  ds_read_b64 v[10:11], v29 offset:2624
  ds_read_b64 v[12:13], v29 offset:2688
  ds_read_b64 v[14:15], v29 offset:2752
  s_waitcnt lgkmcnt(0)
  v_pk_add_f32 v[8:9], v[8:9], v[10:11]
  v_pk_add_f32 v[12:13], v[12:13], v[14:15]
  v_pk_add_f32 v[80:81], v[8:9], v[12:13]
  v_min_u32 v80, -2, v80
  v_min_u32 v81, -2, v81
  s_cmp_lg_u32 s52, 0
  s_cbranch_scc1 L_w0_820
  s_mov_b64 exec, 0xff
  buffer_store_dwordx2 v[80:81], v29, s[48:51], s97 offen sc1
  s_mov_b64 exec, -1
L_w0_820:
  s_cmp_lg_u32 s2, 0
  s_cbranch_scc1 L_end
  v_lshlrev_b32 v30, 3, v0
  s_mov_b32 s72, 0x298000
  s_mov_b32 s73, 0x299000
  s_mov_b32 s74, 0x29a000
  s_mov_b32 s75, 0x29b000
  s_sleep 14
  buffer_load_dwordx2 v[8:9], v30, s[48:51], s72 offen offset:0 sc1
  buffer_load_dwordx2 v[10:11], v30, s[48:51], s72 offen offset:2048 sc1
  buffer_load_dwordx2 v[12:13], v30, s[48:51], s73 offen offset:0 sc1
  buffer_load_dwordx2 v[14:15], v30, s[48:51], s73 offen offset:2048 sc1
  buffer_load_dwordx2 v[80:81], v30, s[48:51], s74 offen offset:0 sc1
  buffer_load_dwordx2 v[82:83], v30, s[48:51], s74 offen offset:2048 sc1
  buffer_load_dwordx2 v[84:85], v30, s[48:51], s75 offen offset:0 sc1
  buffer_load_dwordx2 v[86:87], v30, s[48:51], s75 offen offset:2048 sc1
  s_waitcnt vmcnt(0)
  v_max3_u32 v26, v8, v9, v10
  v_max3_u32 v26, v26, v11, v12
  v_max3_u32 v26, v26, v13, v14
  v_max3_u32 v26, v26, v15, v80
  v_max3_u32 v26, v26, v81, v82
  v_max3_u32 v26, v26, v83, v84
  v_max3_u32 v26, v26, v85, v86
  v_max_u32 v26, v26, v87
  v_cmp_eq_u32 vcc, -1, v26
  s_cbranch_vccz L_xg_821_ok
  s_mov_b64 s[76:77], -1
  s_mov_b64 s[78:79], -1
  s_mov_b64 s[80:81], -1
  s_mov_b64 s[82:83], -1
  s_mov_b64 s[84:85], -1
  s_mov_b64 s[86:87], -1
  s_mov_b64 s[88:89], -1
  s_mov_b64 s[90:91], -1
L_xg_821:
  s_mov_b64 exec, s[76:77]
  s_cbranch_execz L_xg_821_c0
  v_max_u32 v26, v8, v9
  v_cmp_eq_u32 vcc, -1, v26
  s_mov_b64 s[76:77], vcc
L_xg_821_c0:
  s_mov_b64 exec, s[78:79]
  s_cbranch_execz L_xg_821_c1
  v_max_u32 v26, v10, v11
  v_cmp_eq_u32 vcc, -1, v26
  s_mov_b64 s[78:79], vcc
L_xg_821_c1:
  s_mov_b64 exec, s[80:81]
  s_cbranch_execz L_xg_821_c2
  v_max_u32 v26, v12, v13
  v_cmp_eq_u32 vcc, -1, v26
  s_mov_b64 s[80:81], vcc
L_xg_821_c2:
  s_mov_b64 exec, s[82:83]
  s_cbranch_execz L_xg_821_c3
  v_max_u32 v26, v14, v15
  v_cmp_eq_u32 vcc, -1, v26
  s_mov_b64 s[82:83], vcc
L_xg_821_c3:
  s_mov_b64 exec, s[84:85]
  s_cbranch_execz L_xg_821_c4
  v_max_u32 v26, v80, v81
  v_cmp_eq_u32 vcc, -1, v26
  s_mov_b64 s[84:85], vcc
L_xg_821_c4:
  s_mov_b64 exec, s[86:87]
  s_cbranch_execz L_xg_821_c5
  v_max_u32 v26, v82, v83
  v_cmp_eq_u32 vcc, -1, v26
  s_mov_b64 s[86:87], vcc
L_xg_821_c5:
  s_mov_b64 exec, s[88:89]
  s_cbranch_execz L_xg_821_c6
  v_max_u32 v26, v84, v85
  v_cmp_eq_u32 vcc, -1, v26
  s_mov_b64 s[88:89], vcc
L_xg_821_c6:
  s_mov_b64 exec, s[90:91]
  s_cbranch_execz L_xg_821_c7
  v_max_u32 v26, v86, v87
  v_cmp_eq_u32 vcc, -1, v26
  s_mov_b64 s[90:91], vcc
L_xg_821_c7:
  s_mov_b64 s[60:61], s[76:77]
  s_or_b64 s[60:61], s[60:61], s[78:79]
  s_or_b64 s[60:61], s[60:61], s[80:81]
  s_or_b64 s[60:61], s[60:61], s[82:83]
  s_or_b64 s[60:61], s[60:61], s[84:85]
  s_or_b64 s[60:61], s[60:61], s[86:87]
  s_or_b64 s[60:61], s[60:61], s[88:89]
  s_or_b64 s[60:61], s[60:61], s[90:91]
  s_cmp_eq_u64 s[60:61], 0
  s_cbranch_scc1 L_xg_821_x
  s_mov_b64 exec, s[76:77]
  s_cbranch_execz L_xg_821_l0
  buffer_load_dwordx2 v[8:9], v30, s[48:51], s72 offen offset:0 sc1
L_xg_821_l0:
  s_mov_b64 exec, s[78:79]
  s_cbranch_execz L_xg_821_l1
  buffer_load_dwordx2 v[10:11], v30, s[48:51], s72 offen offset:2048 sc1
L_xg_821_l1:
  s_mov_b64 exec, s[80:81]
  s_cbranch_execz L_xg_821_l2
  buffer_load_dwordx2 v[12:13], v30, s[48:51], s73 offen offset:0 sc1
L_xg_821_l2:
  s_mov_b64 exec, s[82:83]
  s_cbranch_execz L_xg_821_l3
  buffer_load_dwordx2 v[14:15], v30, s[48:51], s73 offen offset:2048 sc1
L_xg_821_l3:
  s_mov_b64 exec, s[84:85]
  s_cbranch_execz L_xg_821_l4
  buffer_load_dwordx2 v[80:81], v30, s[48:51], s74 offen offset:0 sc1
L_xg_821_l4:
  s_mov_b64 exec, s[86:87]
  s_cbranch_execz L_xg_821_l5
  buffer_load_dwordx2 v[82:83], v30, s[48:51], s74 offen offset:2048 sc1
L_xg_821_l5:
  s_mov_b64 exec, s[88:89]
  s_cbranch_execz L_xg_821_l6
  buffer_load_dwordx2 v[84:85], v30, s[48:51], s75 offen offset:0 sc1
L_xg_821_l6:
  s_mov_b64 exec, s[90:91]
  s_cbranch_execz L_xg_821_l7
  buffer_load_dwordx2 v[86:87], v30, s[48:51], s75 offen offset:2048 sc1
L_xg_821_l7:
  s_waitcnt vmcnt(0)
  s_sub_u32 s58, s58, 1
  s_cmp_gt_i32 s58, 0
  s_cbranch_scc1 L_xg_821
L_xg_821_x:
  s_mov_b64 exec, -1
L_xg_821_ok:
  v_pk_add_f32 v[8:9], v[8:9], v[10:11]
  v_pk_add_f32 v[12:13], v[12:13], v[14:15]
  v_pk_add_f32 v[80:81], v[80:81], v[82:83]
  v_pk_add_f32 v[84:85], v[84:85], v[86:87]
  v_pk_add_f32 v[8:9], v[8:9], v[12:13]
  v_pk_add_f32 v[80:81], v[80:81], v[84:85]
  v_pk_add_f32 v[8:9], v[8:9], v[80:81]
  v_cvt_pk_bf16_f32 v26, v8, v9
  v_lshlrev_b32 v8, 16, v26
  v_and_b32 v9, 0xffff0000, v26
  v_pk_add_f32 v[22:23], v[22:23], v[8:9]
  v_cvt_pk_bf16_f32 v26, v22, v23
  v_lshlrev_b32 v22, 16, v26
  v_and_b32 v23, 0xffff0000, v26
  v_lshlrev_b32 v27, 2, v0
  buffer_store_dword v26, v27, s[40:43], 0 offen
L_end:
  s_endpgm
.section .rodata,"a"
.p2align 6
.amdhsa_kernel interleave_layers__gqa_block_cached__glu_gated_swiglu__decode_kernel
  .amdhsa_next_free_vgpr 512
  .amdhsa_next_free_sgpr 102
  .amdhsa_accum_offset 256
  .amdhsa_group_segment_fixed_size 0
  .amdhsa_kernarg_size 96
  .amdhsa_user_sgpr_count 2
  .amdhsa_user_sgpr_kernarg_segment_ptr 1
  .amdhsa_system_sgpr_workgroup_id_x 1
.end_amdhsa_kernel
```
